```python
import torch

def _softmax(x, axis=-1):
    return torch.softmax(x, dim=axis)
def _gelu(x):
    return torch.nn.functional.gelu(x, approximate="tanh")
def _silu(x):
    return torch.nn.functional.silu(x)
def _sigmoid(x):
    return torch.sigmoid(x)
def _layernorm(x, axis=-1, eps=1e-5):
    m = x.mean(dim=axis, keepdim=True)
    v = x.var(dim=axis, keepdim=True, unbiased=False)
    return (x - m) / torch.sqrt(v + eps)
def _scatter_add(tgt, idx, src, axis=0):
    return tgt.clone().index_add_(axis, idx, src)
def _segment_sum(src, seg, n):
    out = torch.zeros((n,) + src.shape[1:], dtype=src.dtype)
    return out.index_add_(0, seg, src)
def _pad(x, pw):
    flat = tuple(v for pair in reversed(pw) for v in pair)
    return torch.nn.functional.pad(x, flat)

kernel_name = 'standalone__modern_conv_block_slak__vision'

def setup_inputs():

    _w = (lambda a: (lambda t: t.to(torch.bfloat16) if t.is_floating_point() else t)(torch.as_tensor(a)))
    H = W = 256
    C = 384
    K = 1
    return {
        "x": _w((lambda *s: torch.randn(*s, dtype=torch.bfloat16) * 0.05)(1, H, W, C)),
        "dw": _w((lambda *s: torch.randn(*s, dtype=torch.bfloat16) * 0.05)(K, K, C)),
        "w1": _w((lambda *s: torch.randn(*s, dtype=torch.bfloat16) * 0.05)(C, 4 * C)),
        "w2": _w((lambda *s: torch.randn(*s, dtype=torch.bfloat16) * 0.05)(4 * C, C)),
        "grn_g": _w((lambda *s: torch.randn(*s, dtype=torch.bfloat16) * 0.05)(4 * C)),
        "grn_b": _w((lambda *s: torch.randn(*s, dtype=torch.bfloat16) * 0.05)(4 * C)),
    }

def reference(x, dw, w1, w2, grn_g, grn_b):
    B, H, W, C = x.shape
    K = dw.shape[0]
    pad = K // 2
    xp = _pad(x, ((0,0),(pad,pad),(pad,pad),(0,0)))
    out = torch.zeros_like(x)
    for i in range(K):
        for j in range(K):
            out = out + xp[:, i:i+H, j:j+W, :] * dw[i, j][None, None, None, :]
    h = _layernorm(out, axis=-1)
    h = _gelu(h @ w1)
    gx = torch.sqrt((h * h).sum(axis=(1, 2), keepdims=True) + 1e-6)
    nx = gx / (gx.mean(axis=-1, keepdims=True) + 1e-6)
    h = grn_g[None, None, None, :] * (h * nx) + grn_b[None, None, None, :] + h
    return x + h @ w2
```

```asm
; @launch grid=(256,1,1) block=(256,1,1) lds=163840
.amdgcn_target "amdgcn-amd-amdhsa--gfx950"
.text
.globl standalone__modern_conv_block_slak__vision_kernel
.p2align 8
.type standalone__modern_conv_block_slak__vision_kernel,@function
standalone__modern_conv_block_slak__vision_kernel:
    s_cmp_ge_u32 s2, 256
    s_cbranch_scc1 L_end
    s_load_dwordx16 s[4:19], s[0:1], 0
    s_load_dwordx2 s[20:21], s[0:1], 64
    s_getpc_b64 s[22:23]
    v_lshlrev_b32 v110, 7, v0
    v_mov_b32 v111, s23
    v_add_co_u32 v110, vcc, s22, v110
    s_nop 1
    v_addc_co_u32_e64 v111, vcc, 0, v111, vcc
    global_load_dword v110, v[110:111], off
    v_lshrrev_b32 v8, 6, v0
    v_and_b32 v9, 63, v0
    v_readfirstlane_b32 s3, v8
    v_lshlrev_b32 v100, 4, v9
    v_add_u32_e64 v12, 0, v9
    v_mul_u32_u24 v13, 1366, v12
    v_lshrrev_b32 v13, 16, v13
    v_xor_b32 v12, v9, v13
    v_lshlrev_b32 v112, 4, v12
    v_add_u32 v12, 64, v9
    v_mul_u32_u24 v13, 1366, v12
    v_lshrrev_b32 v13, 16, v13
    v_xor_b32 v12, v9, v13
    v_lshlrev_b32_e64 v113, 4, v12
    v_add_u32 v12, 128, v9
    v_mul_u32_u24 v13, 1366, v12
    v_lshrrev_b32 v13, 16, v13
    v_xor_b32 v12, v9, v13
    v_lshlrev_b32 v114, 4, v12
    v_xor_b32 v115, 64, v112
    v_xor_b32 v116, 64, v113
    v_xor_b32 v117, 64, v114
    v_xor_b32 v118, 128, v112
    v_xor_b32 v119, 128, v113
    v_xor_b32 v120, 128, v114
    v_xor_b32 v121, 192, v112
    v_xor_b32 v122, 192, v113
    v_xor_b32 v123, 192, v114
    s_lshl_b32 s70, s2, 2
    s_add_u32 s70, s70, s3
    s_mul_i32 s55, s70, 49152
    s_mul_i32 s71, s3, 12288
    s_lshl_b32 s69, s3, 10
    s_add_u32 s69, s69, 147456
    s_mov_b32 m0, s69
    v_mov_b32 v104, 0
    v_mov_b32 v105, 0
    v_mov_b32 v106, 0
    v_mov_b32 v107, 0
    s_waitcnt lgkmcnt(0)
    s_mov_b32 s24, s4
    s_and_b32 s25, s5, 0xffff
    s_mov_b32 s26, 0x03000000
    s_mov_b32 s27, 0x20000
    s_mov_b32 s44, s6
    s_and_b32 s45, s7, 0xffff
    s_mov_b32 s46, 0x00000300
    s_mov_b32 s47, 0x20000
    buffer_load_dwordx4 v100, s[44:47], 0 offen lds
    s_add_u32 m0, s71, 98304
    s_add_u32 s67, s55, 0
    buffer_load_dwordx4 v112, s[24:27], s67 offen offset:0 nt lds
    buffer_load_dwordx4 v113, s[24:27], s67 offen offset:1024 nt lds
    buffer_load_dwordx4 v114, s[24:27], s67 offen offset:2048 nt lds
    buffer_load_dwordx4 v115, s[24:27], s67 offen offset:3072 nt lds
    s_add_u32 m0, s71, 102400
    s_add_u32 s67, s55, 4096
    buffer_load_dwordx4 v116, s[24:27], s67 offen offset:0 nt lds
    buffer_load_dwordx4 v117, s[24:27], s67 offen offset:1024 nt lds
    buffer_load_dwordx4 v118, s[24:27], s67 offen offset:2048 nt lds
    buffer_load_dwordx4 v119, s[24:27], s67 offen offset:3072 nt lds
    s_add_u32 m0, s71, 106496
    s_add_u32 s67, s55, 8192
    buffer_load_dwordx4 v120, s[24:27], s67 offen offset:0 nt lds
    buffer_load_dwordx4 v121, s[24:27], s67 offen offset:1024 nt lds
    buffer_load_dwordx4 v122, s[24:27], s67 offen offset:2048 nt lds
    buffer_load_dwordx4 v123, s[24:27], s67 offen offset:3072 nt lds
    s_add_u32 s36, s20, 0x0d600000
    s_addc_u32 s37, s21, 0
    s_and_b32 s37, s37, 0xffff
    s_mov_b32 s38, 0x00004800
    s_mov_b32 s39, 0x20000
    s_lshl_b32 s67, s3, 8
    s_add_u32 s67, s67, s2
    s_cmp_lt_u32 s67, 18
    s_cselect_b32 s38, s38, 0
    s_cselect_b32 s62, 4, 0
    s_cselect_b32 s67, s67, 0
    s_lshl_b32 s67, s67, 10
    buffer_store_dwordx4 v[104:107], v100, s[36:39], s67 offen sc1
    s_mov_b32 s28, s8
    s_and_b32 s29, s9, 0xffff
    s_mov_b32 s30, 0x00120000
    s_mov_b32 s31, 0x20000
    s_mov_b32 s32, s20
    s_and_b32 s33, s21, 0xffff
    s_mov_b32 s34, 0x0d000000
    s_mov_b32 s35, 0x20000
    s_mov_b32 s40, s18
    s_and_b32 s41, s19, 0xffff
    s_mov_b32 s42, 0x00000100
    s_mov_b32 s43, 0x20000
    s_mov_b32 s42, s62
    v_and_b32 v10, 15, v9
    v_lshrrev_b32 v11, 4, v9
    v_bfe_u32 v12, v9, 1, 2
    v_bfe_u32 v13, v9, 3, 1
    v_lshl_add_u32 v12, v13, 3, v12
    v_mul_u32_u24 v12, 3072, v12
    v_and_b32_e64 v13, 1, v9
    v_lshl_add_u32 v12, v13, 4, v12
    v_lshl_add_u32 v1, v11, 5, v12
    v_add_u32 v6, 11264, v1
    v_add_u32 v7, 47104, v1
    v_add_u32 v14, 58368, v1
    s_mul_i32 s64, s70, 200704
    s_and_b32 s65, s70, 1
    s_mul_i32 s65, s65, 6144
    s_mul_i32 s66, s3, 294912
    s_and_b32 s74, s2, 7
    s_lshr_b32 s67, s2, 3
    s_mul_i32 s76, s74, 18
    s_add_u32 s76, s76, s67
    s_mul_i32 s74, s74, 3
    s_mul_i32 s63, s67, 43
    s_lshr_b32 s63, s63, 8
    s_mul_i32 s75, s63, 6
    s_sub_u32 s75, s67, s75
    s_sub_u32 s22, s67, 9
    s_mul_i32 s22, s22, 86
    s_lshr_b32 s22, s22, 8
    s_cmp_lt_u32 s67, 18
    s_cselect_b32 s76, s76, -1
    s_cselect_b32 s75, s75, 0
    s_cselect_b32 s63, s63, s22
    s_add_u32 s63, s63, s74
    s_cmp_ge_u32 s63, 24
    s_cselect_b32 s22, 24, 0
    s_sub_u32 s63, s63, s22
    s_add_u32 s74, s2, 3
    s_and_b32 s74, s74, 7
    s_lshl_b32 s68, s63, 7
    s_add_u32 m0, s71, 0
    s_add_u32 s67, s55, 12288
    buffer_load_dwordx4 v112, s[24:27], s67 offen offset:0 nt lds
    buffer_load_dwordx4 v113, s[24:27], s67 offen offset:1024 nt lds
    buffer_load_dwordx4 v114, s[24:27], s67 offen offset:2048 nt lds
    buffer_load_dwordx4 v115, s[24:27], s67 offen offset:3072 nt lds
    s_mov_b32 s52, 0x409d30fc
    s_mov_b32 s53, 0x3eeff558
    s_mov_b32 s54, 0xffff0000
    v_lshlrev_b32 v2, 2, v11
    v_xor_b32 v2, v2, v9
    v_lshlrev_b32 v2, 4, v2
    v_and_b32 v12, 31, v9
    v_lshrrev_b32 v13, 5, v9
    v_lshlrev_b32 v13, 11, v13
    v_lshl_add_u32 v5, v12, 3, v13
    v_xor_b32 v12, v10, v11
    v_lshlrev_b32 v12, 4, v12
    v_mul_u32_u24 v13, 768, v10
    v_add_u32 v13, s71, v13
    v_xor_b32 v124, 0, v12
    v_add_u32 v124, v124, v13
    v_xor_b32 v125, 64, v12
    v_add_u32_e64 v125, v125, v13
    v_xor_b32 v126, 128, v12
    v_add_u32_e64 v126, v126, v13
    v_xor_b32 v127, 192, v12
    v_add_u32 v127, v127, v13
    v_lshrrev_b32 v12, 2, v10
    v_cmp_eq_u32 vcc, v12, v11
    v_and_b32 v13, 1, v10
    v_lshlrev_b32_e64 v13, 4, v13
    v_mov_b32 v12, 0xffff
    v_lshlrev_b32 v13, v13, v12
    v_cndmask_b32 v13, 0, v13, vcc
    v_and_b32 v12, 2, v10
    v_cmp_eq_u32 vcc, 0, v12
    s_nop 1
    v_cndmask_b32 v102, 0, v13, vcc
    v_sub_u32_e64 v103, v13, v102
    v_lshl_add_u32 v101, v11, 4, s69
    v_lshlrev_b32 v3, 2, v9
    s_mov_b32 s44, s10
    s_and_b32 s45, s11, 0xffff
    s_mov_b32 s46, 0x00120000
    s_mov_b32 s47, 0x20000
    s_mov_b32 s48, s14
    s_and_b32 s49, s15, 0xffff
    s_mov_b32 s50, 0x00000c00
    s_mov_b32 s51, 0x20000
    s_lshl_b32 s72, s76, 2
    s_add_u32 s72, s72, s3
    s_cmp_lt_u32 s76, 144
    s_cselect_b32 s46, s46, 0
    s_cselect_b32 s72, s72, 0
    s_mul_hi_u32 s23, s72, 0x15555556
    s_mul_i32 s22, s23, 12
    s_sub_u32 s5, s72, s22
    s_lshl_b32 s5, s5, 12
    s_lshr_b32 s22, s23, 1
    s_mul_i32 s22, s22, 49152
    s_add_u32 s5, s5, s22
    s_and_b32 s22, s23, 1
    s_lshl_b32 s22, s22, 10
    s_add_u32 s5, s5, s22
    s_add_u32 s5, s5, 2097152
    s_mul_i32 s22, s23, 12
    s_sub_u32 s22, s72, s22
    s_lshl_b32 s6, s22, 7
    s_and_b32 s7, s23, 1
    s_lshl_b32 s7, s7, 11
    s_add_u32 s6, s6, s7
    s_add_u32 s6, s6, 6303744
    s_lshl_b32 s22, s22, 6
    s_mul_i32 s69, s23, 24576
    s_add_u32 s69, s69, s22
    s_lshl_b32 s7, s23, 6
    s_lshl_b32 s75, s75, 2
    s_add_u32 s75, s75, s3
    s_mul_i32 s22, s75, 43
    s_lshr_b32 s22, s22, 8
    s_mul_i32 s23, s22, 6
    s_sub_u32 s23, s75, s23
    s_lshl_b32 s22, s22, 8
    s_lshl_b32 s23, s23, 13
    s_add_u32 s56, s22, s23
    s_mul_i32 s4, s63, 49152
    s_lshl_b32 s22, s75, 11
    s_add_u32 s4, s4, s22
    s_cmp_eq_u32 s63, 0
    s_cselect_b32 s22, 24, s63
    s_lshl_b32 s57, s22, 13
    s_add_u32 s57, s57, s64
    s_sub_u32 s57, s57, 4096
    s_mov_b32 s58, 0
    s_mov_b32 s38, 0
    s_mov_b32 s61, 0
    s_mov_b32 s60, 98304
    s_mov_b32 s62, 24
    s_mov_b32 s73, 3072
    v_mov_b32 v4, v5
    s_waitcnt vmcnt(17)
    ds_read_b128 v[208:211], v101 offset:0
    ds_read_b128 v[212:215], v101 offset:64
    ds_read_b128 v[216:219], v101 offset:128
    ds_read_b128 v[220:223], v101 offset:192
    ds_read_b128 v[224:227], v101 offset:256
    ds_read_b128 v[228:231], v101 offset:320
    ds_read_b128 v[232:235], v101 offset:384
    ds_read_b128 v[236:239], v101 offset:448
    ds_read_b128 v[240:243], v101 offset:512
    ds_read_b128 v[244:247], v101 offset:576
    ds_read_b128 v[248:251], v101 offset:640
    ds_read_b128 v[252:255], v101 offset:704
    s_add_u32 m0, s71, 4096
    s_add_u32 s67, s55, 16384
    buffer_load_dwordx4 v116, s[24:27], s67 offen offset:0 nt lds
    buffer_load_dwordx4 v117, s[24:27], s67 offen offset:1024 nt lds
    buffer_load_dwordx4 v118, s[24:27], s67 offen offset:2048 nt lds
    buffer_load_dwordx4 v119, s[24:27], s67 offen offset:3072 nt lds
    s_waitcnt lgkmcnt(0)
    v_and_b32 v208, v102, v208
    v_and_b32 v209, v103, v209
    v_and_b32 v210, v102, v210
    v_and_b32 v211, v103, v211
    v_and_b32 v212, v102, v212
    v_and_b32 v213, v103, v213
    v_and_b32 v214, v102, v214
    v_and_b32 v215, v103, v215
    v_and_b32 v216, v102, v216
    v_and_b32 v217, v103, v217
    v_and_b32 v218, v102, v218
    v_and_b32 v219, v103, v219
    v_and_b32 v220, v102, v220
    v_and_b32 v221, v103, v221
    v_and_b32 v222, v102, v222
    v_and_b32 v223, v103, v223
    v_and_b32 v224, v102, v224
    v_and_b32 v225, v103, v225
    v_and_b32 v226, v102, v226
    v_and_b32 v227, v103, v227
    v_and_b32 v228, v102, v228
    v_and_b32 v229, v103, v229
    v_and_b32 v230, v102, v230
    v_and_b32 v231, v103, v231
    v_and_b32 v232, v102, v232
    v_and_b32 v233, v103, v233
    v_and_b32 v234, v102, v234
    v_and_b32 v235, v103, v235
    v_and_b32 v236, v102, v236
    v_and_b32 v237, v103, v237
    v_and_b32 v238, v102, v238
    v_and_b32 v239, v103, v239
    v_and_b32 v240, v102, v240
    v_and_b32 v241, v103, v241
    v_and_b32 v242, v102, v242
    v_and_b32 v243, v103, v243
    v_and_b32 v244, v102, v244
    v_and_b32 v245, v103, v245
    v_and_b32 v246, v102, v246
    v_and_b32 v247, v103, v247
    v_and_b32 v248, v102, v248
    v_and_b32 v249, v103, v249
    v_and_b32 v250, v102, v250
    v_and_b32 v251, v103, v251
    v_and_b32 v252, v102, v252
    v_and_b32 v253, v103, v253
    v_and_b32 v254, v102, v254
    v_and_b32 v255, v103, v255
    s_add_u32 m0, s71, 8192
    s_add_u32 s67, s55, 20480
    buffer_load_dwordx4 v120, s[24:27], s67 offen offset:0 nt lds
    buffer_load_dwordx4 v121, s[24:27], s67 offen offset:1024 nt lds
    buffer_load_dwordx4 v122, s[24:27], s67 offen offset:2048 nt lds
    buffer_load_dwordx4 v123, s[24:27], s67 offen offset:3072 nt lds
    v_add_u32 v108, 98304, v124
    v_add_u32 v109, 98304, v125
    v_add_u32 v110, 98304, v126
    v_add_u32 v111, 98304, v127
    s_waitcnt vmcnt(12)
    ds_read_b128 a[0:3], v108 offset:0
    ds_read_b128 a[4:7], v109 offset:0
    ds_read_b128 a[8:11], v110 offset:0
    ds_read_b128 a[12:15], v111 offset:0
    ds_read_b128 a[16:19], v108 offset:256
    ds_read_b128 a[20:23], v109 offset:256
    ds_read_b128 a[24:27], v110 offset:256
    ds_read_b128 a[28:31], v111 offset:256
    ds_read_b128 a[32:35], v108 offset:512
    ds_read_b128 a[36:39], v109 offset:512
    ds_read_b128 a[40:43], v110 offset:512
    ds_read_b128 a[44:47], v111 offset:512
    v_mov_b32 v12, 1
    buffer_atomic_add v12, v3, s[40:43], 0 offen sc1
    s_mov_b32 s42, 256
    s_waitcnt lgkmcnt(10)
    v_mfma_f32_16x16x16_bf16 v[16:19], v[208:209], a[0:1], 0
    v_mfma_f32_16x16x16_bf16 v[20:23], v[210:211], a[2:3], 0
    v_mfma_f32_16x16x16_bf16 v[24:27], v[212:213], a[4:5], 0
    v_mfma_f32_16x16x16_bf16 v[28:31], v[214:215], a[6:7], 0
    s_waitcnt lgkmcnt(8)
    v_mfma_f32_16x16x16_bf16 v[32:35], v[216:217], a[8:9], 0
    v_mfma_f32_16x16x16_bf16 v[36:39], v[218:219], a[10:11], 0
    v_mfma_f32_16x16x16_bf16 v[40:43], v[220:221], a[12:13], 0
    v_mfma_f32_16x16x16_bf16 v[44:47], v[222:223], a[14:15], 0
    s_waitcnt lgkmcnt(6)
    v_mfma_f32_16x16x16_bf16 v[48:51], v[224:225], a[16:17], 0
    v_mov_b32 v8, v16
    v_mul_f32_e64 v10, v16, v16
    v_mfma_f32_16x16x16_bf16 v[52:55], v[226:227], a[18:19], 0
    v_mov_b32 v9, v17
    v_mul_f32 v11, v17, v17
    v_mfma_f32_16x16x16_bf16 v[56:59], v[228:229], a[20:21], 0
    v_add_f32 v8, v8, v18
    v_fmac_f32 v10, v18, v18
    v_mfma_f32_16x16x16_bf16 v[60:63], v[230:231], a[22:23], 0
    v_add_f32 v9, v9, v19
    v_fmac_f32 v11, v19, v19
    s_waitcnt lgkmcnt(4)
    v_mfma_f32_16x16x16_bf16 v[64:67], v[232:233], a[24:25], 0
    v_add_f32 v8, v8, v20
    v_fmac_f32_e64 v10, v20, v20
    v_mfma_f32_16x16x16_bf16 v[68:71], v[234:235], a[26:27], 0
    v_add_f32 v9, v9, v21
    v_fmac_f32 v11, v21, v21
    v_mfma_f32_16x16x16_bf16 v[72:75], v[236:237], a[28:29], 0
    v_add_f32 v8, v8, v22
    v_fmac_f32 v10, v22, v22
    v_mfma_f32_16x16x16_bf16 v[76:79], v[238:239], a[30:31], 0
    v_add_f32 v9, v9, v23
    v_fmac_f32 v11, v23, v23
    s_waitcnt lgkmcnt(2)
    v_mfma_f32_16x16x16_bf16 v[80:83], v[240:241], a[32:33], 0
    v_add_f32 v8, v8, v24
    v_fmac_f32_e64 v10, v24, v24
    v_mfma_f32_16x16x16_bf16 v[84:87], v[242:243], a[34:35], 0
    v_add_f32 v9, v9, v25
    v_fmac_f32 v11, v25, v25
    v_mfma_f32_16x16x16_bf16 v[88:91], v[244:245], a[36:37], 0
    v_add_f32 v8, v8, v26
    v_fmac_f32 v10, v26, v26
    v_mfma_f32_16x16x16_bf16 v[92:95], v[246:247], a[38:39], 0
    v_add_f32 v9, v9, v27
    v_fmac_f32 v11, v27, v27
    s_waitcnt lgkmcnt(0)
    v_mfma_f32_16x16x16_bf16 v[96:99], v[248:249], a[40:41], 0
    v_add_f32 v8, v8, v28
    v_fmac_f32_e64 v10, v28, v28
    v_mfma_f32_16x16x16_bf16 v[100:103], v[250:251], a[42:43], 0
    v_add_f32 v9, v9, v29
    v_fmac_f32 v11, v29, v29
    v_mfma_f32_16x16x16_bf16 v[104:107], v[252:253], a[44:45], 0
    v_add_f32 v8, v8, v30
    v_fmac_f32 v10, v30, v30
    v_mfma_f32_16x16x16_bf16 v[108:111], v[254:255], a[46:47], 0
    v_add_f32 v9, v9, v31
    v_fmac_f32 v11, v31, v31
    v_pk_add_f32 v[8:9], v[8:9], v[32:33]
    s_add_u32 m0, s71, 49152
    s_add_u32 s67, s55, 24576
    buffer_load_dwordx4 v112, s[24:27], s67 offen offset:0 nt lds
    v_pk_fma_f32 v[10:11], v[32:33], v[32:33], v[10:11]
    v_pk_add_f32 v[8:9], v[8:9], v[34:35]
    v_pk_fma_f32 v[10:11], v[34:35], v[34:35], v[10:11]
    v_pk_add_f32 v[8:9], v[8:9], v[36:37]
    v_pk_fma_f32 v[10:11], v[36:37], v[36:37], v[10:11]
    v_pk_add_f32 v[8:9], v[8:9], v[38:39]
    v_pk_fma_f32 v[10:11], v[38:39], v[38:39], v[10:11]
    v_pk_add_f32 v[8:9], v[8:9], v[40:41]
    v_pk_fma_f32 v[10:11], v[40:41], v[40:41], v[10:11]
    v_pk_add_f32 v[8:9], v[8:9], v[42:43]
    v_pk_fma_f32 v[10:11], v[42:43], v[42:43], v[10:11]
    v_pk_add_f32 v[8:9], v[8:9], v[44:45]
    v_pk_fma_f32 v[10:11], v[44:45], v[44:45], v[10:11]
    v_pk_add_f32 v[8:9], v[8:9], v[46:47]
    v_pk_fma_f32 v[10:11], v[46:47], v[46:47], v[10:11]
    v_pk_add_f32 v[8:9], v[8:9], v[48:49]
    v_pk_fma_f32 v[10:11], v[48:49], v[48:49], v[10:11]
    v_pk_add_f32 v[8:9], v[8:9], v[50:51]
    buffer_load_dwordx4 v113, s[24:27], s67 offen offset:1024 nt lds
    v_pk_fma_f32 v[10:11], v[50:51], v[50:51], v[10:11]
    v_pk_add_f32 v[8:9], v[8:9], v[52:53]
    v_pk_fma_f32 v[10:11], v[52:53], v[52:53], v[10:11]
    v_pk_add_f32 v[8:9], v[8:9], v[54:55]
    v_pk_fma_f32 v[10:11], v[54:55], v[54:55], v[10:11]
    v_pk_add_f32 v[8:9], v[8:9], v[56:57]
    v_pk_fma_f32 v[10:11], v[56:57], v[56:57], v[10:11]
    v_pk_add_f32 v[8:9], v[8:9], v[58:59]
    v_pk_fma_f32 v[10:11], v[58:59], v[58:59], v[10:11]
    v_pk_add_f32 v[8:9], v[8:9], v[60:61]
    v_pk_fma_f32 v[10:11], v[60:61], v[60:61], v[10:11]
    v_pk_add_f32 v[8:9], v[8:9], v[62:63]
    v_pk_fma_f32 v[10:11], v[62:63], v[62:63], v[10:11]
    v_pk_add_f32 v[8:9], v[8:9], v[64:65]
    v_pk_fma_f32 v[10:11], v[64:65], v[64:65], v[10:11]
    v_pk_add_f32 v[8:9], v[8:9], v[66:67]
    v_pk_fma_f32 v[10:11], v[66:67], v[66:67], v[10:11]
    v_pk_add_f32 v[8:9], v[8:9], v[68:69]
    v_pk_fma_f32 v[10:11], v[68:69], v[68:69], v[10:11]
    buffer_load_dwordx4 v114, s[24:27], s67 offen offset:2048 nt lds
    v_pk_add_f32 v[8:9], v[8:9], v[70:71]
    v_pk_fma_f32 v[10:11], v[70:71], v[70:71], v[10:11]
    v_pk_add_f32 v[8:9], v[8:9], v[72:73]
    v_pk_fma_f32 v[10:11], v[72:73], v[72:73], v[10:11]
    v_pk_add_f32 v[8:9], v[8:9], v[74:75]
    v_pk_fma_f32 v[10:11], v[74:75], v[74:75], v[10:11]
    v_pk_add_f32 v[8:9], v[8:9], v[76:77]
    v_pk_fma_f32 v[10:11], v[76:77], v[76:77], v[10:11]
    v_pk_add_f32 v[8:9], v[8:9], v[78:79]
    v_pk_fma_f32 v[10:11], v[78:79], v[78:79], v[10:11]
    v_pk_add_f32 v[8:9], v[8:9], v[80:81]
    v_pk_fma_f32 v[10:11], v[80:81], v[80:81], v[10:11]
    v_pk_add_f32 v[8:9], v[8:9], v[82:83]
    v_pk_fma_f32 v[10:11], v[82:83], v[82:83], v[10:11]
    v_pk_add_f32 v[8:9], v[8:9], v[84:85]
    v_pk_fma_f32 v[10:11], v[84:85], v[84:85], v[10:11]
    v_pk_add_f32 v[8:9], v[8:9], v[86:87]
    v_pk_fma_f32 v[10:11], v[86:87], v[86:87], v[10:11]
    v_pk_add_f32 v[8:9], v[8:9], v[88:89]
    buffer_load_dwordx4 v115, s[24:27], s67 offen offset:3072 nt lds
    v_pk_fma_f32 v[10:11], v[88:89], v[88:89], v[10:11]
    v_pk_add_f32 v[8:9], v[8:9], v[90:91]
    v_pk_fma_f32 v[10:11], v[90:91], v[90:91], v[10:11]
    v_pk_add_f32 v[8:9], v[8:9], v[92:93]
    v_pk_fma_f32 v[10:11], v[92:93], v[92:93], v[10:11]
    v_pk_add_f32 v[8:9], v[8:9], v[94:95]
    v_pk_fma_f32 v[10:11], v[94:95], v[94:95], v[10:11]
    v_pk_add_f32 v[8:9], v[8:9], v[96:97]
    v_pk_fma_f32 v[10:11], v[96:97], v[96:97], v[10:11]
    v_pk_add_f32 v[8:9], v[8:9], v[98:99]
    v_pk_fma_f32 v[10:11], v[98:99], v[98:99], v[10:11]
    v_pk_add_f32 v[8:9], v[8:9], v[100:101]
    v_pk_fma_f32 v[10:11], v[100:101], v[100:101], v[10:11]
    v_pk_add_f32 v[8:9], v[8:9], v[102:103]
    v_pk_fma_f32 v[10:11], v[102:103], v[102:103], v[10:11]
    v_pk_add_f32 v[8:9], v[8:9], v[104:105]
    v_pk_fma_f32 v[10:11], v[104:105], v[104:105], v[10:11]
    v_pk_add_f32 v[8:9], v[8:9], v[106:107]
    s_add_u32 m0, s71, 53248
    s_add_u32 s67, s55, 28672
    buffer_load_dwordx4 v116, s[24:27], s67 offen offset:0 nt lds
    v_pk_fma_f32 v[10:11], v[106:107], v[106:107], v[10:11]
    v_pk_add_f32 v[8:9], v[8:9], v[108:109]
    v_pk_fma_f32 v[10:11], v[108:109], v[108:109], v[10:11]
    v_pk_add_f32 v[8:9], v[8:9], v[110:111]
    v_pk_fma_f32 v[10:11], v[110:111], v[110:111], v[10:11]
    v_add_f32 v8, v8, v9
    v_add_f32 v10, v10, v11
    v_mov_b32 v9, v8
    v_mov_b32 v11, v10
    s_nop 0
    v_permlane32_swap_b32 v9, v8
    v_permlane32_swap_b32 v11, v10
    v_add_f32 v8, v8, v9
    v_add_f32 v10, v10, v11
    v_mov_b32 v9, v8
    v_mov_b32 v11, v10
    s_nop 0
    v_permlane16_swap_b32 v9, v8
    v_permlane16_swap_b32 v11, v10
    buffer_load_dwordx4 v117, s[24:27], s67 offen offset:1024 nt lds
    v_add_f32 v8, v8, v9
    v_add_f32 v10, v10, v11
    v_mul_f32 v9, 0xbb2aaaab, v8
    v_mul_f32 v10, 0x3b2aaaab, v10
    v_fma_f32 v10, -v9, v9, v10
    v_max_f32_e64 v10, 0, v10
    v_add_f32 v10, 0x3727c5ac, v10
    v_rsq_f32 v8, v10
    s_nop 0
    v_mul_f32 v8, s53, v8
    v_mul_f32 v9, v9, v8
    v_pk_fma_f32 v[16:17], v[16:17], v[8:9], v[8:9] op_sel:[0,0,1] op_sel_hi:[1,0,1]
    v_pk_fma_f32 v[18:19], v[18:19], v[8:9], v[8:9] op_sel:[0,0,1] op_sel_hi:[1,0,1]
    v_pk_fma_f32 v[20:21], v[20:21], v[8:9], v[8:9] op_sel:[0,0,1] op_sel_hi:[1,0,1]
    v_pk_fma_f32 v[22:23], v[22:23], v[8:9], v[8:9] op_sel:[0,0,1] op_sel_hi:[1,0,1]
    v_cvt_pk_bf16_f32 v16, v16, v17
    v_cvt_pk_bf16_f32 v18, v18, v19
    v_cvt_pk_bf16_f32 v20, v20, v21
    v_cvt_pk_bf16_f32 v22, v22, v23
    buffer_load_dwordx4 v118, s[24:27], s67 offen offset:2048 nt lds
    v_accvgpr_write_b32 a192, v16
    v_accvgpr_write_b32 a193, v18
    v_accvgpr_write_b32 a194, v20
    v_accvgpr_write_b32 a195, v22
    v_pk_fma_f32 v[24:25], v[24:25], v[8:9], v[8:9] op_sel:[0,0,1] op_sel_hi:[1,0,1]
    v_pk_fma_f32 v[26:27], v[26:27], v[8:9], v[8:9] op_sel:[0,0,1] op_sel_hi:[1,0,1]
    v_pk_fma_f32 v[28:29], v[28:29], v[8:9], v[8:9] op_sel:[0,0,1] op_sel_hi:[1,0,1]
    v_pk_fma_f32 v[30:31], v[30:31], v[8:9], v[8:9] op_sel:[0,0,1] op_sel_hi:[1,0,1]
    v_cvt_pk_bf16_f32 v24, v24, v25
    v_cvt_pk_bf16_f32 v26, v26, v27
    v_cvt_pk_bf16_f32 v28, v28, v29
    v_cvt_pk_bf16_f32 v30, v30, v31
    v_accvgpr_write_b32 a196, v24
    v_accvgpr_write_b32 a197, v26
    v_accvgpr_write_b32 a198, v28
    v_accvgpr_write_b32 a199, v30
    v_pk_fma_f32 v[32:33], v[32:33], v[8:9], v[8:9] op_sel:[0,0,1] op_sel_hi:[1,0,1]
    v_pk_fma_f32 v[34:35], v[34:35], v[8:9], v[8:9] op_sel:[0,0,1] op_sel_hi:[1,0,1]
    buffer_load_dwordx4 v119, s[24:27], s67 offen offset:3072 nt lds
    v_pk_fma_f32 v[36:37], v[36:37], v[8:9], v[8:9] op_sel:[0,0,1] op_sel_hi:[1,0,1]
    v_pk_fma_f32 v[38:39], v[38:39], v[8:9], v[8:9] op_sel:[0,0,1] op_sel_hi:[1,0,1]
    v_cvt_pk_bf16_f32 v32, v32, v33
    v_cvt_pk_bf16_f32 v34, v34, v35
    v_cvt_pk_bf16_f32 v36, v36, v37
    v_cvt_pk_bf16_f32 v38, v38, v39
    v_accvgpr_write_b32 a200, v32
    v_accvgpr_write_b32 a201, v34
    v_accvgpr_write_b32 a202, v36
    v_accvgpr_write_b32 a203, v38
    v_pk_fma_f32 v[40:41], v[40:41], v[8:9], v[8:9] op_sel:[0,0,1] op_sel_hi:[1,0,1]
    v_pk_fma_f32 v[42:43], v[42:43], v[8:9], v[8:9] op_sel:[0,0,1] op_sel_hi:[1,0,1]
    v_pk_fma_f32 v[44:45], v[44:45], v[8:9], v[8:9] op_sel:[0,0,1] op_sel_hi:[1,0,1]
    v_pk_fma_f32 v[46:47], v[46:47], v[8:9], v[8:9] op_sel:[0,0,1] op_sel_hi:[1,0,1]
    v_cvt_pk_bf16_f32 v40, v40, v41
    v_cvt_pk_bf16_f32 v42, v42, v43
    v_cvt_pk_bf16_f32 v44, v44, v45
    v_cvt_pk_bf16_f32 v46, v46, v47
    v_accvgpr_write_b32 a204, v40
    s_add_u32 m0, s71, 57344
    s_add_u32 s67, s55, 32768
    buffer_load_dwordx4 v120, s[24:27], s67 offen offset:0 nt lds
    v_accvgpr_write_b32 a205, v42
    v_accvgpr_write_b32 a206, v44
    v_accvgpr_write_b32 a207, v46
    v_pk_fma_f32 v[48:49], v[48:49], v[8:9], v[8:9] op_sel:[0,0,1] op_sel_hi:[1,0,1]
    v_pk_fma_f32 v[50:51], v[50:51], v[8:9], v[8:9] op_sel:[0,0,1] op_sel_hi:[1,0,1]
    v_pk_fma_f32 v[52:53], v[52:53], v[8:9], v[8:9] op_sel:[0,0,1] op_sel_hi:[1,0,1]
    v_pk_fma_f32 v[54:55], v[54:55], v[8:9], v[8:9] op_sel:[0,0,1] op_sel_hi:[1,0,1]
    v_cvt_pk_bf16_f32 v48, v48, v49
    v_cvt_pk_bf16_f32 v50, v50, v51
    v_cvt_pk_bf16_f32 v52, v52, v53
    v_cvt_pk_bf16_f32 v54, v54, v55
    v_accvgpr_write_b32 a208, v48
    v_accvgpr_write_b32 a209, v50
    v_accvgpr_write_b32 a210, v52
    v_accvgpr_write_b32 a211, v54
    v_pk_fma_f32 v[56:57], v[56:57], v[8:9], v[8:9] op_sel:[0,0,1] op_sel_hi:[1,0,1]
    v_pk_fma_f32 v[58:59], v[58:59], v[8:9], v[8:9] op_sel:[0,0,1] op_sel_hi:[1,0,1]
    v_pk_fma_f32 v[60:61], v[60:61], v[8:9], v[8:9] op_sel:[0,0,1] op_sel_hi:[1,0,1]
    v_pk_fma_f32 v[62:63], v[62:63], v[8:9], v[8:9] op_sel:[0,0,1] op_sel_hi:[1,0,1]
    buffer_load_dwordx4 v121, s[24:27], s67 offen offset:1024 nt lds
    v_cvt_pk_bf16_f32 v56, v56, v57
    v_cvt_pk_bf16_f32 v58, v58, v59
    v_cvt_pk_bf16_f32 v60, v60, v61
    v_cvt_pk_bf16_f32 v62, v62, v63
    v_accvgpr_write_b32 a212, v56
    v_accvgpr_write_b32 a213, v58
    v_accvgpr_write_b32 a214, v60
    v_accvgpr_write_b32 a215, v62
    v_pk_fma_f32 v[64:65], v[64:65], v[8:9], v[8:9] op_sel:[0,0,1] op_sel_hi:[1,0,1]
    v_pk_fma_f32 v[66:67], v[66:67], v[8:9], v[8:9] op_sel:[0,0,1] op_sel_hi:[1,0,1]
    v_pk_fma_f32 v[68:69], v[68:69], v[8:9], v[8:9] op_sel:[0,0,1] op_sel_hi:[1,0,1]
    v_pk_fma_f32 v[70:71], v[70:71], v[8:9], v[8:9] op_sel:[0,0,1] op_sel_hi:[1,0,1]
    v_cvt_pk_bf16_f32 v64, v64, v65
    v_cvt_pk_bf16_f32 v66, v66, v67
    v_cvt_pk_bf16_f32 v68, v68, v69
    v_cvt_pk_bf16_f32 v70, v70, v71
    v_accvgpr_write_b32 a216, v64
    v_accvgpr_write_b32 a217, v66
    buffer_load_dwordx4 v122, s[24:27], s67 offen offset:2048 nt lds
    v_accvgpr_write_b32 a218, v68
    v_accvgpr_write_b32 a219, v70
    v_pk_fma_f32 v[72:73], v[72:73], v[8:9], v[8:9] op_sel:[0,0,1] op_sel_hi:[1,0,1]
    v_pk_fma_f32 v[74:75], v[74:75], v[8:9], v[8:9] op_sel:[0,0,1] op_sel_hi:[1,0,1]
    v_pk_fma_f32 v[76:77], v[76:77], v[8:9], v[8:9] op_sel:[0,0,1] op_sel_hi:[1,0,1]
    v_pk_fma_f32 v[78:79], v[78:79], v[8:9], v[8:9] op_sel:[0,0,1] op_sel_hi:[1,0,1]
    v_cvt_pk_bf16_f32 v72, v72, v73
    v_cvt_pk_bf16_f32 v74, v74, v75
    v_cvt_pk_bf16_f32 v76, v76, v77
    v_cvt_pk_bf16_f32 v78, v78, v79
    v_accvgpr_write_b32 a220, v72
    v_accvgpr_write_b32 a221, v74
    v_accvgpr_write_b32 a222, v76
    v_accvgpr_write_b32 a223, v78
    v_pk_fma_f32 v[80:81], v[80:81], v[8:9], v[8:9] op_sel:[0,0,1] op_sel_hi:[1,0,1]
    v_pk_fma_f32 v[82:83], v[82:83], v[8:9], v[8:9] op_sel:[0,0,1] op_sel_hi:[1,0,1]
    v_pk_fma_f32 v[84:85], v[84:85], v[8:9], v[8:9] op_sel:[0,0,1] op_sel_hi:[1,0,1]
    v_pk_fma_f32 v[86:87], v[86:87], v[8:9], v[8:9] op_sel:[0,0,1] op_sel_hi:[1,0,1]
    v_cvt_pk_bf16_f32 v80, v80, v81
    buffer_load_dwordx4 v123, s[24:27], s67 offen offset:3072 nt lds
    v_cvt_pk_bf16_f32 v82, v82, v83
    v_cvt_pk_bf16_f32 v84, v84, v85
    v_cvt_pk_bf16_f32 v86, v86, v87
    v_accvgpr_write_b32 a224, v80
    v_accvgpr_write_b32 a225, v82
    v_accvgpr_write_b32 a226, v84
    v_accvgpr_write_b32 a227, v86
    v_pk_fma_f32 v[88:89], v[88:89], v[8:9], v[8:9] op_sel:[0,0,1] op_sel_hi:[1,0,1]
    v_pk_fma_f32 v[90:91], v[90:91], v[8:9], v[8:9] op_sel:[0,0,1] op_sel_hi:[1,0,1]
    v_pk_fma_f32 v[92:93], v[92:93], v[8:9], v[8:9] op_sel:[0,0,1] op_sel_hi:[1,0,1]
    v_pk_fma_f32 v[94:95], v[94:95], v[8:9], v[8:9] op_sel:[0,0,1] op_sel_hi:[1,0,1]
    v_cvt_pk_bf16_f32 v88, v88, v89
    v_cvt_pk_bf16_f32 v90, v90, v91
    v_cvt_pk_bf16_f32 v92, v92, v93
    v_cvt_pk_bf16_f32 v94, v94, v95
    v_accvgpr_write_b32 a228, v88
    v_accvgpr_write_b32 a229, v90
    v_accvgpr_write_b32 a230, v92
    v_accvgpr_write_b32 a231, v94
    v_pk_fma_f32 v[96:97], v[96:97], v[8:9], v[8:9] op_sel:[0,0,1] op_sel_hi:[1,0,1]
    v_pk_fma_f32 v[98:99], v[98:99], v[8:9], v[8:9] op_sel:[0,0,1] op_sel_hi:[1,0,1]
    v_pk_fma_f32 v[100:101], v[100:101], v[8:9], v[8:9] op_sel:[0,0,1] op_sel_hi:[1,0,1]
    v_pk_fma_f32 v[102:103], v[102:103], v[8:9], v[8:9] op_sel:[0,0,1] op_sel_hi:[1,0,1]
    v_cvt_pk_bf16_f32 v96, v96, v97
    v_cvt_pk_bf16_f32 v98, v98, v99
    v_cvt_pk_bf16_f32 v100, v100, v101
    v_cvt_pk_bf16_f32 v102, v102, v103
    v_accvgpr_write_b32 a232, v96
    v_accvgpr_write_b32 a233, v98
    v_accvgpr_write_b32 a234, v100
    v_accvgpr_write_b32 a235, v102
    v_pk_fma_f32 v[104:105], v[104:105], v[8:9], v[8:9] op_sel:[0,0,1] op_sel_hi:[1,0,1]
    v_pk_fma_f32 v[106:107], v[106:107], v[8:9], v[8:9] op_sel:[0,0,1] op_sel_hi:[1,0,1]
    v_pk_fma_f32 v[108:109], v[108:109], v[8:9], v[8:9] op_sel:[0,0,1] op_sel_hi:[1,0,1]
    v_pk_fma_f32 v[110:111], v[110:111], v[8:9], v[8:9] op_sel:[0,0,1] op_sel_hi:[1,0,1]
    v_cvt_pk_bf16_f32 v104, v104, v105
    v_cvt_pk_bf16_f32 v106, v106, v107
    v_cvt_pk_bf16_f32 v108, v108, v109
    v_cvt_pk_bf16_f32 v110, v110, v111
    v_accvgpr_write_b32 a236, v104
    v_accvgpr_write_b32 a237, v106
    v_accvgpr_write_b32 a238, v108
    v_accvgpr_write_b32 a239, v110
    s_waitcnt vmcnt(13)
    ds_read_b128 a[48:51], v124 offset:0
    ds_read_b128 a[52:55], v125 offset:0
    ds_read_b128 a[56:59], v126 offset:0
    ds_read_b128 a[60:63], v127 offset:0
    ds_read_b128 a[64:67], v124 offset:256
    ds_read_b128 a[68:71], v125 offset:256
    ds_read_b128 a[72:75], v126 offset:256
    ds_read_b128 a[76:79], v127 offset:256
    ds_read_b128 a[80:83], v124 offset:512
    ds_read_b128 a[84:87], v125 offset:512
    ds_read_b128 a[88:91], v126 offset:512
    ds_read_b128 a[92:95], v127 offset:512
    s_waitcnt lgkmcnt(10)
    v_mfma_f32_16x16x16_bf16 v[16:19], v[208:209], a[48:49], 0
    v_mfma_f32_16x16x16_bf16 v[20:23], v[210:211], a[50:51], 0
    v_mfma_f32_16x16x16_bf16 v[24:27], v[212:213], a[52:53], 0
    v_mfma_f32_16x16x16_bf16 v[28:31], v[214:215], a[54:55], 0
    s_waitcnt lgkmcnt(8)
    v_mfma_f32_16x16x16_bf16 v[32:35], v[216:217], a[56:57], 0
    v_mfma_f32_16x16x16_bf16 v[36:39], v[218:219], a[58:59], 0
    v_mfma_f32_16x16x16_bf16 v[40:43], v[220:221], a[60:61], 0
    v_mfma_f32_16x16x16_bf16 v[44:47], v[222:223], a[62:63], 0
    s_waitcnt lgkmcnt(6)
    v_mfma_f32_16x16x16_bf16 v[48:51], v[224:225], a[64:65], 0
    v_mov_b32 v8, v16
    v_mul_f32 v10, v16, v16
    v_mfma_f32_16x16x16_bf16 v[52:55], v[226:227], a[66:67], 0
    v_mov_b32 v9, v17
    v_mul_f32 v11, v17, v17
    v_mfma_f32_16x16x16_bf16 v[56:59], v[228:229], a[68:69], 0
    v_add_f32 v8, v8, v18
    v_fmac_f32 v10, v18, v18
    v_mfma_f32_16x16x16_bf16 v[60:63], v[230:231], a[70:71], 0
    v_add_f32 v9, v9, v19
    v_fmac_f32 v11, v19, v19
    s_waitcnt lgkmcnt(4)
    v_mfma_f32_16x16x16_bf16 v[64:67], v[232:233], a[72:73], 0
    v_add_f32 v8, v8, v20
    v_fmac_f32_e64 v10, v20, v20
    v_mfma_f32_16x16x16_bf16 v[68:71], v[234:235], a[74:75], 0
    v_add_f32 v9, v9, v21
    v_fmac_f32 v11, v21, v21
    v_mfma_f32_16x16x16_bf16 v[72:75], v[236:237], a[76:77], 0
    v_add_f32 v8, v8, v22
    v_fmac_f32 v10, v22, v22
    v_mfma_f32_16x16x16_bf16 v[76:79], v[238:239], a[78:79], 0
    v_add_f32 v9, v9, v23
    v_fmac_f32 v11, v23, v23
    s_waitcnt lgkmcnt(2)
    v_mfma_f32_16x16x16_bf16 v[80:83], v[240:241], a[80:81], 0
    v_add_f32 v8, v8, v24
    v_fmac_f32_e64 v10, v24, v24
    v_mfma_f32_16x16x16_bf16 v[84:87], v[242:243], a[82:83], 0
    v_add_f32 v9, v9, v25
    v_fmac_f32 v11, v25, v25
    v_mfma_f32_16x16x16_bf16 v[88:91], v[244:245], a[84:85], 0
    v_add_f32 v8, v8, v26
    v_fmac_f32 v10, v26, v26
    v_mfma_f32_16x16x16_bf16 v[92:95], v[246:247], a[86:87], 0
    v_add_f32 v9, v9, v27
    v_fmac_f32 v11, v27, v27
    s_waitcnt lgkmcnt(0)
    v_mfma_f32_16x16x16_bf16 v[96:99], v[248:249], a[88:89], 0
    v_add_f32 v8, v8, v28
    v_fmac_f32_e64 v10, v28, v28
    v_mfma_f32_16x16x16_bf16 v[100:103], v[250:251], a[90:91], 0
    v_add_f32 v9, v9, v29
    v_fmac_f32 v11, v29, v29
    v_mfma_f32_16x16x16_bf16 v[104:107], v[252:253], a[92:93], 0
    v_add_f32 v8, v8, v30
    v_fmac_f32 v10, v30, v30
    v_mfma_f32_16x16x16_bf16 v[108:111], v[254:255], a[94:95], 0
    v_add_f32 v9, v9, v31
    v_fmac_f32 v11, v31, v31
    v_pk_add_f32 v[8:9], v[8:9], v[32:33]
    s_lshl_b32 s22, s3, 11
    s_add_u32 m0, s22, 151552
    v_bfe_u32 v12, v0, 2, 4
    v_mul_u32_u24 v12, 768, v12
    v_and_b32 v13, 3, v0
    v_lshl_add_u32 v12, v13, 4, v12
    buffer_load_dwordx4 v12, s[44:47], s69 offen nt lds
    s_add_u32 s69, s69, 11264
    buffer_load_dwordx4 v12, s[44:47], s69 offen offset:1024 nt lds
    v_pk_fma_f32 v[10:11], v[32:33], v[32:33], v[10:11]
    v_pk_add_f32 v[8:9], v[8:9], v[34:35]
    v_pk_fma_f32 v[10:11], v[34:35], v[34:35], v[10:11]
    v_pk_add_f32 v[8:9], v[8:9], v[36:37]
    v_pk_fma_f32 v[10:11], v[36:37], v[36:37], v[10:11]
    v_pk_add_f32 v[8:9], v[8:9], v[38:39]
    v_pk_fma_f32 v[10:11], v[38:39], v[38:39], v[10:11]
    v_pk_add_f32 v[8:9], v[8:9], v[40:41]
    v_pk_fma_f32 v[10:11], v[40:41], v[40:41], v[10:11]
    v_pk_add_f32 v[8:9], v[8:9], v[42:43]
    v_pk_fma_f32 v[10:11], v[42:43], v[42:43], v[10:11]
    v_pk_add_f32 v[8:9], v[8:9], v[44:45]
    v_pk_fma_f32 v[10:11], v[44:45], v[44:45], v[10:11]
    s_lshl_b32 s22, s3, 8
    s_add_u32 m0, s22, 159744
    v_and_b32 v12, 63, v0
    v_lshl_add_u32 v12, v12, 2, s7
    buffer_load_dword v12, s[48:51], 0 offen lds
    v_pk_add_f32 v[8:9], v[8:9], v[46:47]
    v_pk_fma_f32 v[10:11], v[46:47], v[46:47], v[10:11]
    v_pk_add_f32 v[8:9], v[8:9], v[48:49]
    v_pk_fma_f32 v[10:11], v[48:49], v[48:49], v[10:11]
    v_pk_add_f32 v[8:9], v[8:9], v[50:51]
    v_pk_fma_f32 v[10:11], v[50:51], v[50:51], v[10:11]
    v_pk_add_f32 v[8:9], v[8:9], v[52:53]
    v_pk_fma_f32 v[10:11], v[52:53], v[52:53], v[10:11]
    v_pk_add_f32 v[8:9], v[8:9], v[54:55]
    v_pk_fma_f32 v[10:11], v[54:55], v[54:55], v[10:11]
    v_pk_add_f32 v[8:9], v[8:9], v[56:57]
    v_pk_fma_f32 v[10:11], v[56:57], v[56:57], v[10:11]
    v_pk_add_f32 v[8:9], v[8:9], v[58:59]
    s_mov_b32 s48, s12
    s_and_b32 s49, s13, 0xffff
    s_mov_b32 s50, 0x00000c00
    s_mov_b32 s51, 0x20000
    s_lshl_b32 s22, s3, 10
    s_add_u32 m0, s22, 160768
    v_lshlrev_b32_e64 v12, 4, v0
    buffer_load_dwordx4 v12, s[48:51], 0 offen lds
    s_add_u32 s48, s20, 0x0d000000
    s_addc_u32 s49, s21, 0
    s_and_b32 s49, s49, 0xffff
    s_mov_b32 s50, 0x00800000
    s_mov_b32 s51, 0x20000
    s_cmp_lt_u32 s76, 144
    s_cselect_b32 s50, s50, 0
    s_and_b32 s22, s2, 7
    s_lshl_b32 s22, s22, 7
    s_add_u32 s22, s22, 0x0d604400
    s_add_u32 s44, s20, s22
    s_addc_u32 s45, s21, 0
    s_and_b32 s45, s45, 0xffff
    s_cmp_lt_u32 s76, 144
    s_cselect_b32 s46, 4, 0
    s_cmp_eq_u32 s3, 0
    s_cselect_b32 s46, s46, 0
    v_pk_fma_f32 v[10:11], v[58:59], v[58:59], v[10:11]
    v_pk_add_f32 v[8:9], v[8:9], v[60:61]
    v_pk_fma_f32 v[10:11], v[60:61], v[60:61], v[10:11]
    v_pk_add_f32 v[8:9], v[8:9], v[62:63]
    v_pk_fma_f32 v[10:11], v[62:63], v[62:63], v[10:11]
    v_pk_add_f32 v[8:9], v[8:9], v[64:65]
    v_pk_fma_f32 v[10:11], v[64:65], v[64:65], v[10:11]
    v_pk_add_f32 v[8:9], v[8:9], v[66:67]
    v_pk_fma_f32 v[10:11], v[66:67], v[66:67], v[10:11]
    v_pk_add_f32 v[8:9], v[8:9], v[68:69]
    v_pk_fma_f32 v[10:11], v[68:69], v[68:69], v[10:11]
    v_pk_add_f32 v[8:9], v[8:9], v[70:71]
    v_pk_fma_f32 v[10:11], v[70:71], v[70:71], v[10:11]
    s_add_u32 m0, s71, 98304
    s_add_u32 s67, s55, 36864
    buffer_load_dwordx4 v112, s[24:27], s67 offen offset:0 nt lds
    v_pk_add_f32 v[8:9], v[8:9], v[72:73]
    v_pk_fma_f32 v[10:11], v[72:73], v[72:73], v[10:11]
    v_pk_add_f32 v[8:9], v[8:9], v[74:75]
    v_pk_fma_f32 v[10:11], v[74:75], v[74:75], v[10:11]
    v_pk_add_f32 v[8:9], v[8:9], v[76:77]
    v_pk_fma_f32 v[10:11], v[76:77], v[76:77], v[10:11]
    v_pk_add_f32 v[8:9], v[8:9], v[78:79]
    v_pk_fma_f32 v[10:11], v[78:79], v[78:79], v[10:11]
    v_pk_add_f32 v[8:9], v[8:9], v[80:81]
    v_pk_fma_f32 v[10:11], v[80:81], v[80:81], v[10:11]
    v_pk_add_f32 v[8:9], v[8:9], v[82:83]
    v_pk_fma_f32 v[10:11], v[82:83], v[82:83], v[10:11]
    v_pk_add_f32 v[8:9], v[8:9], v[84:85]
    buffer_load_dwordx4 v113, s[24:27], s67 offen offset:1024 nt lds
    v_pk_fma_f32 v[10:11], v[84:85], v[84:85], v[10:11]
    v_pk_add_f32 v[8:9], v[8:9], v[86:87]
    v_pk_fma_f32 v[10:11], v[86:87], v[86:87], v[10:11]
    v_pk_add_f32 v[8:9], v[8:9], v[88:89]
    v_pk_fma_f32 v[10:11], v[88:89], v[88:89], v[10:11]
    v_pk_add_f32 v[8:9], v[8:9], v[90:91]
    v_pk_fma_f32 v[10:11], v[90:91], v[90:91], v[10:11]
    v_pk_add_f32 v[8:9], v[8:9], v[92:93]
    v_pk_fma_f32 v[10:11], v[92:93], v[92:93], v[10:11]
    v_pk_add_f32 v[8:9], v[8:9], v[94:95]
    v_pk_fma_f32 v[10:11], v[94:95], v[94:95], v[10:11]
    v_pk_add_f32 v[8:9], v[8:9], v[96:97]
    v_pk_fma_f32 v[10:11], v[96:97], v[96:97], v[10:11]
    buffer_load_dwordx4 v114, s[24:27], s67 offen offset:2048 nt lds
    v_pk_add_f32 v[8:9], v[8:9], v[98:99]
    v_pk_fma_f32 v[10:11], v[98:99], v[98:99], v[10:11]
    v_pk_add_f32 v[8:9], v[8:9], v[100:101]
    v_pk_fma_f32 v[10:11], v[100:101], v[100:101], v[10:11]
    v_pk_add_f32 v[8:9], v[8:9], v[102:103]
    v_pk_fma_f32 v[10:11], v[102:103], v[102:103], v[10:11]
    v_pk_add_f32 v[8:9], v[8:9], v[104:105]
    v_pk_fma_f32 v[10:11], v[104:105], v[104:105], v[10:11]
    v_pk_add_f32 v[8:9], v[8:9], v[106:107]
    v_pk_fma_f32 v[10:11], v[106:107], v[106:107], v[10:11]
    v_pk_add_f32 v[8:9], v[8:9], v[108:109]
    v_pk_fma_f32 v[10:11], v[108:109], v[108:109], v[10:11]
    v_pk_add_f32 v[8:9], v[8:9], v[110:111]
    buffer_load_dwordx4 v115, s[24:27], s67 offen offset:3072 nt lds
    v_pk_fma_f32 v[10:11], v[110:111], v[110:111], v[10:11]
    v_add_f32 v8, v8, v9
    v_add_f32 v10, v10, v11
    v_mov_b32 v9, v8
    v_mov_b32 v11, v10
    s_nop 0
    v_permlane32_swap_b32 v9, v8
    v_permlane32_swap_b32 v11, v10
    v_add_f32 v8, v8, v9
    v_add_f32 v10, v10, v11
    v_mov_b32 v9, v8
    v_mov_b32 v11, v10
    s_nop 0
    s_add_u32 m0, s71, 102400
    s_add_u32 s67, s55, 40960
    buffer_load_dwordx4 v116, s[24:27], s67 offen offset:0 nt lds
    v_permlane16_swap_b32 v9, v8
    v_permlane16_swap_b32 v11, v10
    v_add_f32 v8, v8, v9
    v_add_f32_e64 v10, v10, v11
    v_mul_f32 v9, 0xbb2aaaab, v8
    v_mul_f32 v10, 0x3b2aaaab, v10
    v_fma_f32 v10, -v9, v9, v10
    v_max_f32_e64 v10, 0, v10
    v_add_f32 v10, 0x3727c5ac, v10
    v_rsq_f32 v8, v10
    s_nop 0
    v_mul_f32 v8, s53, v8
    v_mul_f32 v9, v9, v8
    buffer_load_dwordx4 v117, s[24:27], s67 offen offset:1024 nt lds
    v_pk_fma_f32 v[16:17], v[16:17], v[8:9], v[8:9] op_sel:[0,0,1] op_sel_hi:[1,0,1]
    v_pk_fma_f32 v[18:19], v[18:19], v[8:9], v[8:9] op_sel:[0,0,1] op_sel_hi:[1,0,1]
    v_pk_fma_f32 v[20:21], v[20:21], v[8:9], v[8:9] op_sel:[0,0,1] op_sel_hi:[1,0,1]
    v_pk_fma_f32 v[22:23], v[22:23], v[8:9], v[8:9] op_sel:[0,0,1] op_sel_hi:[1,0,1]
    v_cvt_pk_bf16_f32 v16, v16, v17
    v_cvt_pk_bf16_f32 v18, v18, v19
    v_cvt_pk_bf16_f32 v20, v20, v21
    v_cvt_pk_bf16_f32 v22, v22, v23
    v_accvgpr_write_b32 a240, v16
    v_accvgpr_write_b32 a241, v18
    v_accvgpr_write_b32 a242, v20
    v_accvgpr_write_b32 a243, v22
    v_pk_fma_f32 v[24:25], v[24:25], v[8:9], v[8:9] op_sel:[0,0,1] op_sel_hi:[1,0,1]
    buffer_load_dwordx4 v118, s[24:27], s67 offen offset:2048 nt lds
    v_pk_fma_f32 v[26:27], v[26:27], v[8:9], v[8:9] op_sel:[0,0,1] op_sel_hi:[1,0,1]
    v_pk_fma_f32 v[28:29], v[28:29], v[8:9], v[8:9] op_sel:[0,0,1] op_sel_hi:[1,0,1]
    v_pk_fma_f32 v[30:31], v[30:31], v[8:9], v[8:9] op_sel:[0,0,1] op_sel_hi:[1,0,1]
    v_cvt_pk_bf16_f32 v24, v24, v25
    v_cvt_pk_bf16_f32 v26, v26, v27
    v_cvt_pk_bf16_f32 v28, v28, v29
    v_cvt_pk_bf16_f32 v30, v30, v31
    v_accvgpr_write_b32 a244, v24
    v_accvgpr_write_b32 a245, v26
    v_accvgpr_write_b32 a246, v28
    v_accvgpr_write_b32 a247, v30
    v_pk_fma_f32 v[32:33], v[32:33], v[8:9], v[8:9] op_sel:[0,0,1] op_sel_hi:[1,0,1]
    v_pk_fma_f32 v[34:35], v[34:35], v[8:9], v[8:9] op_sel:[0,0,1] op_sel_hi:[1,0,1]
    buffer_load_dwordx4 v119, s[24:27], s67 offen offset:3072 nt lds
    v_pk_fma_f32 v[36:37], v[36:37], v[8:9], v[8:9] op_sel:[0,0,1] op_sel_hi:[1,0,1]
    v_pk_fma_f32 v[38:39], v[38:39], v[8:9], v[8:9] op_sel:[0,0,1] op_sel_hi:[1,0,1]
    v_cvt_pk_bf16_f32 v32, v32, v33
    v_cvt_pk_bf16_f32 v34, v34, v35
    v_cvt_pk_bf16_f32 v36, v36, v37
    v_cvt_pk_bf16_f32 v38, v38, v39
    v_accvgpr_write_b32 a248, v32
    v_accvgpr_write_b32 a249, v34
    v_accvgpr_write_b32 a250, v36
    v_accvgpr_write_b32 a251, v38
    v_pk_fma_f32 v[40:41], v[40:41], v[8:9], v[8:9] op_sel:[0,0,1] op_sel_hi:[1,0,1]
    v_pk_fma_f32 v[42:43], v[42:43], v[8:9], v[8:9] op_sel:[0,0,1] op_sel_hi:[1,0,1]
    v_pk_fma_f32 v[44:45], v[44:45], v[8:9], v[8:9] op_sel:[0,0,1] op_sel_hi:[1,0,1]
    s_add_u32 m0, s71, 106496
    s_add_u32 s67, s55, 45056
    buffer_load_dwordx4 v120, s[24:27], s67 offen offset:0 nt lds
    v_pk_fma_f32 v[46:47], v[46:47], v[8:9], v[8:9] op_sel:[0,0,1] op_sel_hi:[1,0,1]
    v_cvt_pk_bf16_f32 v40, v40, v41
    v_cvt_pk_bf16_f32 v42, v42, v43
    v_cvt_pk_bf16_f32 v44, v44, v45
    v_cvt_pk_bf16_f32 v46, v46, v47
    v_accvgpr_write_b32 a252, v40
    v_accvgpr_write_b32 a253, v42
    v_accvgpr_write_b32 a254, v44
    v_accvgpr_write_b32 a255, v46
    v_pk_fma_f32 v[48:49], v[48:49], v[8:9], v[8:9] op_sel:[0,0,1] op_sel_hi:[1,0,1]
    v_pk_fma_f32 v[50:51], v[50:51], v[8:9], v[8:9] op_sel:[0,0,1] op_sel_hi:[1,0,1]
    v_pk_fma_f32 v[52:53], v[52:53], v[8:9], v[8:9] op_sel:[0,0,1] op_sel_hi:[1,0,1]
    v_pk_fma_f32 v[54:55], v[54:55], v[8:9], v[8:9] op_sel:[0,0,1] op_sel_hi:[1,0,1]
    buffer_load_dwordx4 v121, s[24:27], s67 offen offset:1024 nt lds
    v_cvt_pk_bf16_f32 v128, v48, v49
    v_cvt_pk_bf16_f32 v129, v50, v51
    v_cvt_pk_bf16_f32 v130, v52, v53
    v_cvt_pk_bf16_f32 v131, v54, v55
    v_pk_fma_f32 v[56:57], v[56:57], v[8:9], v[8:9] op_sel:[0,0,1] op_sel_hi:[1,0,1]
    v_pk_fma_f32 v[58:59], v[58:59], v[8:9], v[8:9] op_sel:[0,0,1] op_sel_hi:[1,0,1]
    v_pk_fma_f32 v[60:61], v[60:61], v[8:9], v[8:9] op_sel:[0,0,1] op_sel_hi:[1,0,1]
    v_pk_fma_f32 v[62:63], v[62:63], v[8:9], v[8:9] op_sel:[0,0,1] op_sel_hi:[1,0,1]
    v_cvt_pk_bf16_f32 v132, v56, v57
    v_cvt_pk_bf16_f32 v133, v58, v59
    v_cvt_pk_bf16_f32 v134, v60, v61
    v_cvt_pk_bf16_f32 v135, v62, v63
    v_pk_fma_f32 v[64:65], v[64:65], v[8:9], v[8:9] op_sel:[0,0,1] op_sel_hi:[1,0,1]
    buffer_load_dwordx4 v122, s[24:27], s67 offen offset:2048 nt lds
    v_pk_fma_f32 v[66:67], v[66:67], v[8:9], v[8:9] op_sel:[0,0,1] op_sel_hi:[1,0,1]
    v_pk_fma_f32 v[68:69], v[68:69], v[8:9], v[8:9] op_sel:[0,0,1] op_sel_hi:[1,0,1]
    v_pk_fma_f32 v[70:71], v[70:71], v[8:9], v[8:9] op_sel:[0,0,1] op_sel_hi:[1,0,1]
    v_cvt_pk_bf16_f32 v136, v64, v65
    v_cvt_pk_bf16_f32 v137, v66, v67
    v_cvt_pk_bf16_f32 v138, v68, v69
    v_cvt_pk_bf16_f32 v139, v70, v71
    v_pk_fma_f32 v[72:73], v[72:73], v[8:9], v[8:9] op_sel:[0,0,1] op_sel_hi:[1,0,1]
    v_pk_fma_f32 v[74:75], v[74:75], v[8:9], v[8:9] op_sel:[0,0,1] op_sel_hi:[1,0,1]
    v_pk_fma_f32 v[76:77], v[76:77], v[8:9], v[8:9] op_sel:[0,0,1] op_sel_hi:[1,0,1]
    v_pk_fma_f32 v[78:79], v[78:79], v[8:9], v[8:9] op_sel:[0,0,1] op_sel_hi:[1,0,1]
    v_cvt_pk_bf16_f32 v140, v72, v73
    v_cvt_pk_bf16_f32 v141, v74, v75
    buffer_load_dwordx4 v123, s[24:27], s67 offen offset:3072 nt lds
    v_cvt_pk_bf16_f32 v142, v76, v77
    v_cvt_pk_bf16_f32 v143, v78, v79
    v_pk_fma_f32 v[80:81], v[80:81], v[8:9], v[8:9] op_sel:[0,0,1] op_sel_hi:[1,0,1]
    v_pk_fma_f32 v[82:83], v[82:83], v[8:9], v[8:9] op_sel:[0,0,1] op_sel_hi:[1,0,1]
    v_pk_fma_f32 v[84:85], v[84:85], v[8:9], v[8:9] op_sel:[0,0,1] op_sel_hi:[1,0,1]
    v_pk_fma_f32 v[86:87], v[86:87], v[8:9], v[8:9] op_sel:[0,0,1] op_sel_hi:[1,0,1]
    v_cvt_pk_bf16_f32 v144, v80, v81
    v_cvt_pk_bf16_f32 v145, v82, v83
    v_cvt_pk_bf16_f32 v146, v84, v85
    v_cvt_pk_bf16_f32 v147, v86, v87
    v_pk_fma_f32 v[88:89], v[88:89], v[8:9], v[8:9] op_sel:[0,0,1] op_sel_hi:[1,0,1]
    v_pk_fma_f32 v[90:91], v[90:91], v[8:9], v[8:9] op_sel:[0,0,1] op_sel_hi:[1,0,1]
    v_pk_fma_f32 v[92:93], v[92:93], v[8:9], v[8:9] op_sel:[0,0,1] op_sel_hi:[1,0,1]
    v_pk_fma_f32 v[94:95], v[94:95], v[8:9], v[8:9] op_sel:[0,0,1] op_sel_hi:[1,0,1]
    v_cvt_pk_bf16_f32 v148, v88, v89
    v_cvt_pk_bf16_f32 v149, v90, v91
    v_cvt_pk_bf16_f32 v150, v92, v93
    v_cvt_pk_bf16_f32 v151, v94, v95
    v_pk_fma_f32 v[96:97], v[96:97], v[8:9], v[8:9] op_sel:[0,0,1] op_sel_hi:[1,0,1]
    v_pk_fma_f32 v[98:99], v[98:99], v[8:9], v[8:9] op_sel:[0,0,1] op_sel_hi:[1,0,1]
    v_pk_fma_f32 v[100:101], v[100:101], v[8:9], v[8:9] op_sel:[0,0,1] op_sel_hi:[1,0,1]
    v_pk_fma_f32 v[102:103], v[102:103], v[8:9], v[8:9] op_sel:[0,0,1] op_sel_hi:[1,0,1]
    v_cvt_pk_bf16_f32 v152, v96, v97
    v_cvt_pk_bf16_f32 v153, v98, v99
    v_cvt_pk_bf16_f32 v154, v100, v101
    v_cvt_pk_bf16_f32 v155, v102, v103
    v_pk_fma_f32 v[104:105], v[104:105], v[8:9], v[8:9] op_sel:[0,0,1] op_sel_hi:[1,0,1]
    v_pk_fma_f32 v[106:107], v[106:107], v[8:9], v[8:9] op_sel:[0,0,1] op_sel_hi:[1,0,1]
    v_pk_fma_f32 v[108:109], v[108:109], v[8:9], v[8:9] op_sel:[0,0,1] op_sel_hi:[1,0,1]
    v_pk_fma_f32 v[110:111], v[110:111], v[8:9], v[8:9] op_sel:[0,0,1] op_sel_hi:[1,0,1]
    v_cvt_pk_bf16_f32 v156, v104, v105
    v_cvt_pk_bf16_f32 v157, v106, v107
    v_cvt_pk_bf16_f32 v158, v108, v109
    v_cvt_pk_bf16_f32 v159, v110, v111
    s_waitcnt vmcnt(16)
    ds_read_b128 a[96:99], v124 offset:49152
    ds_read_b128 a[100:103], v125 offset:49152
    ds_read_b128 a[104:107], v126 offset:49152
    ds_read_b128 a[108:111], v127 offset:49152
    ds_read_b128 a[112:115], v124 offset:49408
    ds_read_b128 a[116:119], v125 offset:49408
    ds_read_b128 a[120:123], v126 offset:49408
    ds_read_b128 a[124:127], v127 offset:49408
    ds_read_b128 a[128:131], v124 offset:49664
    ds_read_b128 a[132:135], v125 offset:49664
    ds_read_b128 a[136:139], v126 offset:49664
    ds_read_b128 a[140:143], v127 offset:49664
    v_and_b32 v12, 63, v0
    v_lshlrev_b32 v112, 4, v12
    v_and_b32 v13, 3, v0
    v_bfe_u32 v12, v0, 2, 2
    v_lshl_add_u32 v13, v12, 3, v13
    v_bfe_u32 v12, v0, 5, 1
    v_lshl_add_u32 v13, v12, 26, v13
    v_bfe_u32 v12, v0, 4, 1
    v_lshl_add_u32 v13, v12, 2, v13
    v_lshlrev_b32 v117, 2, v13
    s_lshl_b32 s22, s3, 11
    s_add_u32 s22, s22, 151552
    v_lshlrev_b32_e64 v13, 10, v12
    v_add3_u32 v113, v13, v112, s22
    v_xor_b32 v114, 1024, v113
    s_lshl_b32 s22, s3, 8
    s_add_u32 s22, s22, 159744
    v_bfe_u32 v13, v0, 4, 2
    v_lshlrev_b32 v13, 3, v13
    v_lshl_add_u32 v13, v12, 5, v13
    v_add_u32 v115, s22, v13
    v_xor_b32 v116, 32, v115
    v_add_u32 v118, s56, v5
    s_waitcnt lgkmcnt(10)
    v_mfma_f32_16x16x16_bf16 v[16:19], v[208:209], a[96:97], 0
    v_mfma_f32_16x16x16_bf16 v[20:23], v[210:211], a[98:99], 0
    v_mfma_f32_16x16x16_bf16 v[24:27], v[212:213], a[100:101], 0
    v_mfma_f32_16x16x16_bf16 v[28:31], v[214:215], a[102:103], 0
    s_waitcnt lgkmcnt(8)
    v_mfma_f32_16x16x16_bf16 v[32:35], v[216:217], a[104:105], 0
    v_mfma_f32_16x16x16_bf16 v[36:39], v[218:219], a[106:107], 0
    v_mfma_f32_16x16x16_bf16 v[40:43], v[220:221], a[108:109], 0
    v_mfma_f32_16x16x16_bf16 v[44:47], v[222:223], a[110:111], 0
    s_waitcnt lgkmcnt(6)
    v_mfma_f32_16x16x16_bf16 v[48:51], v[224:225], a[112:113], 0
    v_mov_b32 v8, v16
    v_mul_f32 v10, v16, v16
    v_mfma_f32_16x16x16_bf16 v[52:55], v[226:227], a[114:115], 0
    v_mov_b32 v9, v17
    v_mul_f32 v11, v17, v17
    v_mfma_f32_16x16x16_bf16 v[56:59], v[228:229], a[116:117], 0
    v_add_f32 v8, v8, v18
    v_fmac_f32 v10, v18, v18
    v_mfma_f32_16x16x16_bf16 v[60:63], v[230:231], a[118:119], 0
    v_add_f32 v9, v9, v19
    v_fmac_f32 v11, v19, v19
    s_waitcnt lgkmcnt(4)
    v_mfma_f32_16x16x16_bf16 v[64:67], v[232:233], a[120:121], 0
    v_add_f32 v8, v8, v20
    v_fmac_f32_e64 v10, v20, v20
    v_mfma_f32_16x16x16_bf16 v[68:71], v[234:235], a[122:123], 0
    v_add_f32 v9, v9, v21
    v_fmac_f32 v11, v21, v21
    v_mfma_f32_16x16x16_bf16 v[72:75], v[236:237], a[124:125], 0
    v_add_f32 v8, v8, v22
    v_fmac_f32 v10, v22, v22
    v_mfma_f32_16x16x16_bf16 v[76:79], v[238:239], a[126:127], 0
    v_add_f32 v9, v9, v23
    v_fmac_f32 v11, v23, v23
    s_waitcnt lgkmcnt(2)
    v_mfma_f32_16x16x16_bf16 v[80:83], v[240:241], a[128:129], 0
    v_add_f32 v8, v8, v24
    v_fmac_f32_e64 v10, v24, v24
    v_mfma_f32_16x16x16_bf16 v[84:87], v[242:243], a[130:131], 0
    v_add_f32 v9, v9, v25
    v_fmac_f32 v11, v25, v25
    v_mfma_f32_16x16x16_bf16 v[88:91], v[244:245], a[132:133], 0
    v_add_f32 v8, v8, v26
    v_fmac_f32 v10, v26, v26
    v_mfma_f32_16x16x16_bf16 v[92:95], v[246:247], a[134:135], 0
    v_add_f32 v9, v9, v27
    v_fmac_f32 v11, v27, v27
    s_waitcnt lgkmcnt(0)
    v_mfma_f32_16x16x16_bf16 v[96:99], v[248:249], a[136:137], 0
    v_add_f32 v8, v8, v28
    v_fmac_f32_e64 v10, v28, v28
    v_mfma_f32_16x16x16_bf16 v[100:103], v[250:251], a[138:139], 0
    v_add_f32 v9, v9, v29
    v_fmac_f32 v11, v29, v29
    v_mfma_f32_16x16x16_bf16 v[104:107], v[252:253], a[140:141], 0
    v_add_f32 v8, v8, v30
    v_fmac_f32 v10, v30, v30
    v_mfma_f32_16x16x16_bf16 v[108:111], v[254:255], a[142:143], 0
    v_add_f32 v9, v9, v31
    v_fmac_f32 v11, v31, v31
    v_pk_add_f32 v[8:9], v[8:9], v[32:33]
    s_add_u32 m0, s71, 0
    s_add_u32 s59, s68, s66
    buffer_load_dwordx4 v1, s[28:31], s59 offen offset:0 sc1 lds
    v_pk_fma_f32 v[10:11], v[32:33], v[32:33], v[10:11]
    v_pk_add_f32 v[8:9], v[8:9], v[34:35]
    v_pk_fma_f32 v[10:11], v[34:35], v[34:35], v[10:11]
    v_pk_add_f32 v[8:9], v[8:9], v[36:37]
    v_pk_fma_f32 v[10:11], v[36:37], v[36:37], v[10:11]
    v_pk_add_f32 v[8:9], v[8:9], v[38:39]
    v_pk_fma_f32 v[10:11], v[38:39], v[38:39], v[10:11]
    v_pk_add_f32 v[8:9], v[8:9], v[40:41]
    v_pk_fma_f32 v[10:11], v[40:41], v[40:41], v[10:11]
    v_pk_add_f32 v[8:9], v[8:9], v[42:43]
    v_pk_fma_f32 v[10:11], v[42:43], v[42:43], v[10:11]
    v_pk_add_f32 v[8:9], v[8:9], v[44:45]
    v_pk_fma_f32 v[10:11], v[44:45], v[44:45], v[10:11]
    buffer_load_dwordx4 v6, s[28:31], s59 offen offset:1024 sc1 lds
    v_pk_add_f32 v[8:9], v[8:9], v[46:47]
    v_pk_fma_f32 v[10:11], v[46:47], v[46:47], v[10:11]
    v_pk_add_f32 v[8:9], v[8:9], v[48:49]
    v_pk_fma_f32 v[10:11], v[48:49], v[48:49], v[10:11]
    v_pk_add_f32 v[8:9], v[8:9], v[50:51]
    v_pk_fma_f32 v[10:11], v[50:51], v[50:51], v[10:11]
    v_pk_add_f32 v[8:9], v[8:9], v[52:53]
    v_pk_fma_f32 v[10:11], v[52:53], v[52:53], v[10:11]
    v_pk_add_f32 v[8:9], v[8:9], v[54:55]
    v_pk_fma_f32 v[10:11], v[54:55], v[54:55], v[10:11]
    v_pk_add_f32 v[8:9], v[8:9], v[56:57]
    v_pk_fma_f32 v[10:11], v[56:57], v[56:57], v[10:11]
    v_pk_add_f32 v[8:9], v[8:9], v[58:59]
    v_pk_fma_f32 v[10:11], v[58:59], v[58:59], v[10:11]
    buffer_load_dwordx4 v7, s[28:31], s59 offen offset:2048 sc1 lds
    v_pk_add_f32 v[8:9], v[8:9], v[60:61]
    v_pk_fma_f32 v[10:11], v[60:61], v[60:61], v[10:11]
    v_pk_add_f32 v[8:9], v[8:9], v[62:63]
    v_pk_fma_f32 v[10:11], v[62:63], v[62:63], v[10:11]
    v_pk_add_f32 v[8:9], v[8:9], v[64:65]
    v_pk_fma_f32 v[10:11], v[64:65], v[64:65], v[10:11]
    v_pk_add_f32 v[8:9], v[8:9], v[66:67]
    v_pk_fma_f32 v[10:11], v[66:67], v[66:67], v[10:11]
    v_pk_add_f32 v[8:9], v[8:9], v[68:69]
    v_pk_fma_f32 v[10:11], v[68:69], v[68:69], v[10:11]
    v_pk_add_f32 v[8:9], v[8:9], v[70:71]
    v_pk_fma_f32 v[10:11], v[70:71], v[70:71], v[10:11]
    v_pk_add_f32 v[8:9], v[8:9], v[72:73]
    v_pk_fma_f32 v[10:11], v[72:73], v[72:73], v[10:11]
    buffer_load_dwordx4 v14, s[28:31], s59 offen offset:3072 sc1 lds
    v_pk_add_f32 v[8:9], v[8:9], v[74:75]
    v_pk_fma_f32 v[10:11], v[74:75], v[74:75], v[10:11]
    v_pk_add_f32 v[8:9], v[8:9], v[76:77]
    v_pk_fma_f32 v[10:11], v[76:77], v[76:77], v[10:11]
    v_pk_add_f32 v[8:9], v[8:9], v[78:79]
    v_pk_fma_f32 v[10:11], v[78:79], v[78:79], v[10:11]
    v_pk_add_f32 v[8:9], v[8:9], v[80:81]
    v_pk_fma_f32 v[10:11], v[80:81], v[80:81], v[10:11]
    v_pk_add_f32 v[8:9], v[8:9], v[82:83]
    v_pk_fma_f32 v[10:11], v[82:83], v[82:83], v[10:11]
    v_pk_add_f32 v[8:9], v[8:9], v[84:85]
    v_pk_fma_f32 v[10:11], v[84:85], v[84:85], v[10:11]
    v_pk_add_f32 v[8:9], v[8:9], v[86:87]
    v_pk_fma_f32 v[10:11], v[86:87], v[86:87], v[10:11]
    s_add_u32 m0, s71, 4096
    s_add_u32 s59, s59, 98304
    buffer_load_dwordx4 v1, s[28:31], s59 offen offset:0 sc1 lds
    v_pk_add_f32 v[8:9], v[8:9], v[88:89]
    v_pk_fma_f32 v[10:11], v[88:89], v[88:89], v[10:11]
    v_pk_add_f32 v[8:9], v[8:9], v[90:91]
    v_pk_fma_f32 v[10:11], v[90:91], v[90:91], v[10:11]
    v_pk_add_f32 v[8:9], v[8:9], v[92:93]
    v_pk_fma_f32 v[10:11], v[92:93], v[92:93], v[10:11]
    v_pk_add_f32 v[8:9], v[8:9], v[94:95]
    v_pk_fma_f32 v[10:11], v[94:95], v[94:95], v[10:11]
    v_pk_add_f32 v[8:9], v[8:9], v[96:97]
    v_pk_fma_f32 v[10:11], v[96:97], v[96:97], v[10:11]
    v_pk_add_f32 v[8:9], v[8:9], v[98:99]
    v_pk_fma_f32 v[10:11], v[98:99], v[98:99], v[10:11]
    v_pk_add_f32 v[8:9], v[8:9], v[100:101]
    v_pk_fma_f32 v[10:11], v[100:101], v[100:101], v[10:11]
    buffer_load_dwordx4 v6, s[28:31], s59 offen offset:1024 sc1 lds
    v_pk_add_f32 v[8:9], v[8:9], v[102:103]
    v_pk_fma_f32 v[10:11], v[102:103], v[102:103], v[10:11]
    v_pk_add_f32 v[8:9], v[8:9], v[104:105]
    v_pk_fma_f32 v[10:11], v[104:105], v[104:105], v[10:11]
    v_pk_add_f32 v[8:9], v[8:9], v[106:107]
    v_pk_fma_f32 v[10:11], v[106:107], v[106:107], v[10:11]
    v_pk_add_f32 v[8:9], v[8:9], v[108:109]
    v_pk_fma_f32 v[10:11], v[108:109], v[108:109], v[10:11]
    v_pk_add_f32 v[8:9], v[8:9], v[110:111]
    v_pk_fma_f32 v[10:11], v[110:111], v[110:111], v[10:11]
    v_add_f32 v8, v8, v9
    v_add_f32 v10, v10, v11
    v_mov_b32 v9, v8
    v_mov_b32 v11, v10
    buffer_load_dwordx4 v7, s[28:31], s59 offen offset:2048 sc1 lds
    s_nop 0
    v_permlane32_swap_b32 v9, v8
    v_permlane32_swap_b32 v11, v10
    v_add_f32 v8, v8, v9
    v_add_f32 v10, v10, v11
    v_mov_b32 v9, v8
    v_mov_b32 v11, v10
    s_nop 0
    v_permlane16_swap_b32 v9, v8
    v_permlane16_swap_b32 v11, v10
    v_add_f32 v8, v8, v9
    v_add_f32 v10, v10, v11
    v_mul_f32 v9, 0xbb2aaaab, v8
    v_mul_f32 v10, 0x3b2aaaab, v10
    buffer_load_dwordx4 v14, s[28:31], s59 offen offset:3072 sc1 lds
    v_fma_f32 v10, -v9, v9, v10
    v_max_f32_e64 v10, 0, v10
    v_add_f32 v10, 0x3727c5ac, v10
    v_rsq_f32 v8, v10
    s_nop 0
    v_mul_f32 v8, s53, v8
    v_mul_f32 v9, v9, v8
    v_pk_fma_f32 v[16:17], v[16:17], v[8:9], v[8:9] op_sel:[0,0,1] op_sel_hi:[1,0,1]
    v_pk_fma_f32 v[18:19], v[18:19], v[8:9], v[8:9] op_sel:[0,0,1] op_sel_hi:[1,0,1]
    v_pk_fma_f32 v[20:21], v[20:21], v[8:9], v[8:9] op_sel:[0,0,1] op_sel_hi:[1,0,1]
    v_pk_fma_f32 v[22:23], v[22:23], v[8:9], v[8:9] op_sel:[0,0,1] op_sel_hi:[1,0,1]
    v_cvt_pk_bf16_f32 v160, v16, v17
    v_cvt_pk_bf16_f32 v161, v18, v19
    v_cvt_pk_bf16_f32 v162, v20, v21
    s_add_u32 m0, s71, 8192
    s_add_u32 s59, s59, 98304
    buffer_load_dwordx4 v1, s[28:31], s59 offen offset:0 sc1 lds
    v_cvt_pk_bf16_f32 v163, v22, v23
    v_pk_fma_f32 v[24:25], v[24:25], v[8:9], v[8:9] op_sel:[0,0,1] op_sel_hi:[1,0,1]
    v_pk_fma_f32 v[26:27], v[26:27], v[8:9], v[8:9] op_sel:[0,0,1] op_sel_hi:[1,0,1]
    v_pk_fma_f32 v[28:29], v[28:29], v[8:9], v[8:9] op_sel:[0,0,1] op_sel_hi:[1,0,1]
    v_pk_fma_f32 v[30:31], v[30:31], v[8:9], v[8:9] op_sel:[0,0,1] op_sel_hi:[1,0,1]
    v_cvt_pk_bf16_f32 v164, v24, v25
    v_cvt_pk_bf16_f32 v165, v26, v27
    v_cvt_pk_bf16_f32 v166, v28, v29
    v_cvt_pk_bf16_f32 v167, v30, v31
    v_pk_fma_f32 v[32:33], v[32:33], v[8:9], v[8:9] op_sel:[0,0,1] op_sel_hi:[1,0,1]
    v_pk_fma_f32 v[34:35], v[34:35], v[8:9], v[8:9] op_sel:[0,0,1] op_sel_hi:[1,0,1]
    v_pk_fma_f32 v[36:37], v[36:37], v[8:9], v[8:9] op_sel:[0,0,1] op_sel_hi:[1,0,1]
    v_pk_fma_f32 v[38:39], v[38:39], v[8:9], v[8:9] op_sel:[0,0,1] op_sel_hi:[1,0,1]
    v_cvt_pk_bf16_f32 v168, v32, v33
    buffer_load_dwordx4 v6, s[28:31], s59 offen offset:1024 sc1 lds
    v_cvt_pk_bf16_f32 v169, v34, v35
    v_cvt_pk_bf16_f32 v170, v36, v37
    v_cvt_pk_bf16_f32 v171, v38, v39
    v_pk_fma_f32 v[40:41], v[40:41], v[8:9], v[8:9] op_sel:[0,0,1] op_sel_hi:[1,0,1]
    v_pk_fma_f32 v[42:43], v[42:43], v[8:9], v[8:9] op_sel:[0,0,1] op_sel_hi:[1,0,1]
    v_pk_fma_f32 v[44:45], v[44:45], v[8:9], v[8:9] op_sel:[0,0,1] op_sel_hi:[1,0,1]
    v_pk_fma_f32 v[46:47], v[46:47], v[8:9], v[8:9] op_sel:[0,0,1] op_sel_hi:[1,0,1]
    v_cvt_pk_bf16_f32 v172, v40, v41
    v_cvt_pk_bf16_f32 v173, v42, v43
    v_cvt_pk_bf16_f32 v174, v44, v45
    v_cvt_pk_bf16_f32 v175, v46, v47
    v_pk_fma_f32 v[48:49], v[48:49], v[8:9], v[8:9] op_sel:[0,0,1] op_sel_hi:[1,0,1]
    v_pk_fma_f32 v[50:51], v[50:51], v[8:9], v[8:9] op_sel:[0,0,1] op_sel_hi:[1,0,1]
    v_pk_fma_f32 v[52:53], v[52:53], v[8:9], v[8:9] op_sel:[0,0,1] op_sel_hi:[1,0,1]
    buffer_load_dwordx4 v7, s[28:31], s59 offen offset:2048 sc1 lds
    v_pk_fma_f32 v[54:55], v[54:55], v[8:9], v[8:9] op_sel:[0,0,1] op_sel_hi:[1,0,1]
    v_cvt_pk_bf16_f32 v176, v48, v49
    v_cvt_pk_bf16_f32 v177, v50, v51
    v_cvt_pk_bf16_f32 v178, v52, v53
    v_cvt_pk_bf16_f32 v179, v54, v55
    v_pk_fma_f32 v[56:57], v[56:57], v[8:9], v[8:9] op_sel:[0,0,1] op_sel_hi:[1,0,1]
    v_pk_fma_f32 v[58:59], v[58:59], v[8:9], v[8:9] op_sel:[0,0,1] op_sel_hi:[1,0,1]
    v_pk_fma_f32 v[60:61], v[60:61], v[8:9], v[8:9] op_sel:[0,0,1] op_sel_hi:[1,0,1]
    v_pk_fma_f32 v[62:63], v[62:63], v[8:9], v[8:9] op_sel:[0,0,1] op_sel_hi:[1,0,1]
    v_cvt_pk_bf16_f32 v180, v56, v57
    v_cvt_pk_bf16_f32 v181, v58, v59
    v_cvt_pk_bf16_f32 v182, v60, v61
    v_cvt_pk_bf16_f32 v183, v62, v63
    v_pk_fma_f32 v[64:65], v[64:65], v[8:9], v[8:9] op_sel:[0,0,1] op_sel_hi:[1,0,1]
    buffer_load_dwordx4 v14, s[28:31], s59 offen offset:3072 sc1 lds
    s_add_u32 s68, s68, 128
    s_cmp_ge_u32 s68, 3072
    s_cselect_b32 s68, 0, s68
    v_pk_fma_f32 v[66:67], v[66:67], v[8:9], v[8:9] op_sel:[0,0,1] op_sel_hi:[1,0,1]
    v_pk_fma_f32 v[68:69], v[68:69], v[8:9], v[8:9] op_sel:[0,0,1] op_sel_hi:[1,0,1]
    v_pk_fma_f32 v[70:71], v[70:71], v[8:9], v[8:9] op_sel:[0,0,1] op_sel_hi:[1,0,1]
    v_cvt_pk_bf16_f32 v184, v64, v65
    v_cvt_pk_bf16_f32 v185, v66, v67
    v_cvt_pk_bf16_f32 v186, v68, v69
    v_cvt_pk_bf16_f32 v187, v70, v71
    v_pk_fma_f32 v[72:73], v[72:73], v[8:9], v[8:9] op_sel:[0,0,1] op_sel_hi:[1,0,1]
    v_pk_fma_f32 v[74:75], v[74:75], v[8:9], v[8:9] op_sel:[0,0,1] op_sel_hi:[1,0,1]
    v_pk_fma_f32 v[76:77], v[76:77], v[8:9], v[8:9] op_sel:[0,0,1] op_sel_hi:[1,0,1]
    v_pk_fma_f32 v[78:79], v[78:79], v[8:9], v[8:9] op_sel:[0,0,1] op_sel_hi:[1,0,1]
    v_cvt_pk_bf16_f32 v188, v72, v73
    v_cvt_pk_bf16_f32 v189, v74, v75
    buffer_load_dword v15, off, s[40:43], 0 sc1
    v_cvt_pk_bf16_f32 v190, v76, v77
    v_cvt_pk_bf16_f32 v191, v78, v79
    v_pk_fma_f32 v[80:81], v[80:81], v[8:9], v[8:9] op_sel:[0,0,1] op_sel_hi:[1,0,1]
    v_pk_fma_f32 v[82:83], v[82:83], v[8:9], v[8:9] op_sel:[0,0,1] op_sel_hi:[1,0,1]
    v_pk_fma_f32 v[84:85], v[84:85], v[8:9], v[8:9] op_sel:[0,0,1] op_sel_hi:[1,0,1]
    v_pk_fma_f32 v[86:87], v[86:87], v[8:9], v[8:9] op_sel:[0,0,1] op_sel_hi:[1,0,1]
    v_cvt_pk_bf16_f32 v192, v80, v81
    v_cvt_pk_bf16_f32 v193, v82, v83
    v_cvt_pk_bf16_f32 v194, v84, v85
    v_cvt_pk_bf16_f32 v195, v86, v87
    v_pk_fma_f32 v[88:89], v[88:89], v[8:9], v[8:9] op_sel:[0,0,1] op_sel_hi:[1,0,1]
    v_pk_fma_f32 v[90:91], v[90:91], v[8:9], v[8:9] op_sel:[0,0,1] op_sel_hi:[1,0,1]
    v_pk_fma_f32 v[92:93], v[92:93], v[8:9], v[8:9] op_sel:[0,0,1] op_sel_hi:[1,0,1]
    v_pk_fma_f32 v[94:95], v[94:95], v[8:9], v[8:9] op_sel:[0,0,1] op_sel_hi:[1,0,1]
    v_cvt_pk_bf16_f32 v196, v88, v89
    v_cvt_pk_bf16_f32 v197, v90, v91
    v_cvt_pk_bf16_f32 v198, v92, v93
    v_cvt_pk_bf16_f32 v199, v94, v95
    v_pk_fma_f32 v[96:97], v[96:97], v[8:9], v[8:9] op_sel:[0,0,1] op_sel_hi:[1,0,1]
    v_pk_fma_f32 v[98:99], v[98:99], v[8:9], v[8:9] op_sel:[0,0,1] op_sel_hi:[1,0,1]
    v_pk_fma_f32 v[100:101], v[100:101], v[8:9], v[8:9] op_sel:[0,0,1] op_sel_hi:[1,0,1]
    v_pk_fma_f32 v[102:103], v[102:103], v[8:9], v[8:9] op_sel:[0,0,1] op_sel_hi:[1,0,1]
    v_cvt_pk_bf16_f32 v200, v96, v97
    v_cvt_pk_bf16_f32 v201, v98, v99
    v_cvt_pk_bf16_f32 v202, v100, v101
    v_cvt_pk_bf16_f32 v203, v102, v103
    v_pk_fma_f32 v[104:105], v[104:105], v[8:9], v[8:9] op_sel:[0,0,1] op_sel_hi:[1,0,1]
    v_pk_fma_f32 v[106:107], v[106:107], v[8:9], v[8:9] op_sel:[0,0,1] op_sel_hi:[1,0,1]
    v_pk_fma_f32 v[108:109], v[108:109], v[8:9], v[8:9] op_sel:[0,0,1] op_sel_hi:[1,0,1]
    v_pk_fma_f32 v[110:111], v[110:111], v[8:9], v[8:9] op_sel:[0,0,1] op_sel_hi:[1,0,1]
    v_cvt_pk_bf16_f32 v204, v104, v105
    v_cvt_pk_bf16_f32 v205, v106, v107
    v_cvt_pk_bf16_f32 v206, v108, v109
    v_cvt_pk_bf16_f32 v207, v110, v111
    v_add_u32 v108, 98304, v124
    v_add_u32 v109, 98304, v125
    v_add_u32 v110, 98304, v126
    v_add_u32 v111, 98304, v127
    s_waitcnt vmcnt(13)
    ds_read_b128 a[144:147], v108 offset:0
    ds_read_b128 a[148:151], v109 offset:0
    ds_read_b128 a[152:155], v110 offset:0
    ds_read_b128 a[156:159], v111 offset:0
    ds_read_b128 a[160:163], v108 offset:256
    ds_read_b128 a[164:167], v109 offset:256
    ds_read_b128 a[168:171], v110 offset:256
    ds_read_b128 a[172:175], v111 offset:256
    ds_read_b128 a[176:179], v108 offset:512
    ds_read_b128 a[180:183], v109 offset:512
    ds_read_b128 a[184:187], v110 offset:512
    ds_read_b128 a[188:191], v111 offset:512
    s_waitcnt lgkmcnt(10)
    v_mfma_f32_16x16x16_bf16 v[16:19], v[208:209], a[144:145], 0
    v_mfma_f32_16x16x16_bf16 v[20:23], v[210:211], a[146:147], 0
    v_mfma_f32_16x16x16_bf16 v[24:27], v[212:213], a[148:149], 0
    v_mfma_f32_16x16x16_bf16 v[28:31], v[214:215], a[150:151], 0
    s_waitcnt lgkmcnt(8)
    v_mfma_f32_16x16x16_bf16 v[32:35], v[216:217], a[152:153], 0
    v_mfma_f32_16x16x16_bf16 v[36:39], v[218:219], a[154:155], 0
    v_mfma_f32_16x16x16_bf16 v[40:43], v[220:221], a[156:157], 0
    v_mfma_f32_16x16x16_bf16 v[44:47], v[222:223], a[158:159], 0
    s_waitcnt lgkmcnt(6)
    v_mfma_f32_16x16x16_bf16 v[48:51], v[224:225], a[160:161], 0
    v_mov_b32 v8, v16
    v_mul_f32_e64 v10, v16, v16
    v_mfma_f32_16x16x16_bf16 v[52:55], v[226:227], a[162:163], 0
    v_mov_b32 v9, v17
    v_mul_f32 v11, v17, v17
    v_mfma_f32_16x16x16_bf16 v[56:59], v[228:229], a[164:165], 0
    v_add_f32 v8, v8, v18
    v_fmac_f32 v10, v18, v18
    v_mfma_f32_16x16x16_bf16 v[60:63], v[230:231], a[166:167], 0
    v_add_f32 v9, v9, v19
    v_fmac_f32 v11, v19, v19
    s_waitcnt lgkmcnt(4)
    v_mfma_f32_16x16x16_bf16 v[64:67], v[232:233], a[168:169], 0
    v_add_f32 v8, v8, v20
    v_fmac_f32_e64 v10, v20, v20
    v_mfma_f32_16x16x16_bf16 v[68:71], v[234:235], a[170:171], 0
    v_add_f32 v9, v9, v21
    v_fmac_f32 v11, v21, v21
    v_mfma_f32_16x16x16_bf16 v[72:75], v[236:237], a[172:173], 0
    v_add_f32 v8, v8, v22
    v_fmac_f32 v10, v22, v22
    v_mfma_f32_16x16x16_bf16 v[76:79], v[238:239], a[174:175], 0
    v_add_f32 v9, v9, v23
    v_fmac_f32 v11, v23, v23
    s_waitcnt lgkmcnt(2)
    v_mfma_f32_16x16x16_bf16 v[80:83], v[240:241], a[176:177], 0
    v_add_f32 v8, v8, v24
    v_fmac_f32_e64 v10, v24, v24
    v_mfma_f32_16x16x16_bf16 v[84:87], v[242:243], a[178:179], 0
    v_add_f32 v9, v9, v25
    v_fmac_f32 v11, v25, v25
    v_mfma_f32_16x16x16_bf16 v[88:91], v[244:245], a[180:181], 0
    v_add_f32 v8, v8, v26
    v_fmac_f32 v10, v26, v26
    v_mfma_f32_16x16x16_bf16 v[92:95], v[246:247], a[182:183], 0
    v_add_f32 v9, v9, v27
    v_fmac_f32 v11, v27, v27
    s_waitcnt lgkmcnt(0)
    v_mfma_f32_16x16x16_bf16 v[96:99], v[248:249], a[184:185], 0
    v_add_f32 v8, v8, v28
    v_fmac_f32_e64 v10, v28, v28
    v_mfma_f32_16x16x16_bf16 v[100:103], v[250:251], a[186:187], 0
    v_add_f32 v9, v9, v29
    v_fmac_f32 v11, v29, v29
    v_mfma_f32_16x16x16_bf16 v[104:107], v[252:253], a[188:189], 0
    v_add_f32 v8, v8, v30
    v_fmac_f32 v10, v30, v30
    v_mfma_f32_16x16x16_bf16 v[108:111], v[254:255], a[190:191], 0
    v_add_f32 v9, v9, v31
    v_fmac_f32 v11, v31, v31
    v_pk_add_f32 v[8:9], v[8:9], v[32:33]
    v_pk_fma_f32 v[10:11], v[32:33], v[32:33], v[10:11]
    v_pk_add_f32 v[8:9], v[8:9], v[34:35]
    v_pk_fma_f32 v[10:11], v[34:35], v[34:35], v[10:11]
    v_pk_add_f32 v[8:9], v[8:9], v[36:37]
    v_pk_fma_f32 v[10:11], v[36:37], v[36:37], v[10:11]
    v_pk_add_f32 v[8:9], v[8:9], v[38:39]
    v_pk_fma_f32 v[10:11], v[38:39], v[38:39], v[10:11]
    v_pk_add_f32 v[8:9], v[8:9], v[40:41]
    v_pk_fma_f32 v[10:11], v[40:41], v[40:41], v[10:11]
    v_pk_add_f32 v[8:9], v[8:9], v[42:43]
    v_pk_fma_f32 v[10:11], v[42:43], v[42:43], v[10:11]
    v_pk_add_f32 v[8:9], v[8:9], v[44:45]
    v_pk_fma_f32 v[10:11], v[44:45], v[44:45], v[10:11]
    v_pk_add_f32 v[8:9], v[8:9], v[46:47]
    v_pk_fma_f32 v[10:11], v[46:47], v[46:47], v[10:11]
    v_pk_add_f32 v[8:9], v[8:9], v[48:49]
    v_pk_fma_f32 v[10:11], v[48:49], v[48:49], v[10:11]
    v_pk_add_f32 v[8:9], v[8:9], v[50:51]
    v_pk_fma_f32 v[10:11], v[50:51], v[50:51], v[10:11]
    v_pk_add_f32 v[8:9], v[8:9], v[52:53]
    v_pk_fma_f32 v[10:11], v[52:53], v[52:53], v[10:11]
    v_pk_add_f32 v[8:9], v[8:9], v[54:55]
    v_pk_fma_f32 v[10:11], v[54:55], v[54:55], v[10:11]
    v_pk_add_f32 v[8:9], v[8:9], v[56:57]
    v_pk_fma_f32 v[10:11], v[56:57], v[56:57], v[10:11]
    v_pk_add_f32 v[8:9], v[8:9], v[58:59]
    v_pk_fma_f32 v[10:11], v[58:59], v[58:59], v[10:11]
    v_pk_add_f32 v[8:9], v[8:9], v[60:61]
    v_pk_fma_f32 v[10:11], v[60:61], v[60:61], v[10:11]
    v_pk_add_f32 v[8:9], v[8:9], v[62:63]
    v_pk_fma_f32 v[10:11], v[62:63], v[62:63], v[10:11]
    v_pk_add_f32 v[8:9], v[8:9], v[64:65]
    v_pk_fma_f32 v[10:11], v[64:65], v[64:65], v[10:11]
    v_pk_add_f32 v[8:9], v[8:9], v[66:67]
    v_pk_fma_f32 v[10:11], v[66:67], v[66:67], v[10:11]
    v_pk_add_f32 v[8:9], v[8:9], v[68:69]
    v_pk_fma_f32 v[10:11], v[68:69], v[68:69], v[10:11]
    v_pk_add_f32 v[8:9], v[8:9], v[70:71]
    v_pk_fma_f32 v[10:11], v[70:71], v[70:71], v[10:11]
    v_pk_add_f32 v[8:9], v[8:9], v[72:73]
    v_pk_fma_f32 v[10:11], v[72:73], v[72:73], v[10:11]
    v_pk_add_f32 v[8:9], v[8:9], v[74:75]
    v_pk_fma_f32 v[10:11], v[74:75], v[74:75], v[10:11]
    v_pk_add_f32 v[8:9], v[8:9], v[76:77]
    v_pk_fma_f32 v[10:11], v[76:77], v[76:77], v[10:11]
    v_pk_add_f32 v[8:9], v[8:9], v[78:79]
    v_pk_fma_f32 v[10:11], v[78:79], v[78:79], v[10:11]
    v_pk_add_f32 v[8:9], v[8:9], v[80:81]
    v_pk_fma_f32 v[10:11], v[80:81], v[80:81], v[10:11]
    v_pk_add_f32 v[8:9], v[8:9], v[82:83]
    v_pk_fma_f32 v[10:11], v[82:83], v[82:83], v[10:11]
    v_pk_add_f32 v[8:9], v[8:9], v[84:85]
    v_pk_fma_f32 v[10:11], v[84:85], v[84:85], v[10:11]
    v_pk_add_f32 v[8:9], v[8:9], v[86:87]
    v_pk_fma_f32 v[10:11], v[86:87], v[86:87], v[10:11]
    v_pk_add_f32 v[8:9], v[8:9], v[88:89]
    v_pk_fma_f32 v[10:11], v[88:89], v[88:89], v[10:11]
    v_pk_add_f32 v[8:9], v[8:9], v[90:91]
    v_pk_fma_f32 v[10:11], v[90:91], v[90:91], v[10:11]
    v_pk_add_f32 v[8:9], v[8:9], v[92:93]
    v_pk_fma_f32 v[10:11], v[92:93], v[92:93], v[10:11]
    v_pk_add_f32 v[8:9], v[8:9], v[94:95]
    v_pk_fma_f32 v[10:11], v[94:95], v[94:95], v[10:11]
    v_pk_add_f32 v[8:9], v[8:9], v[96:97]
    v_pk_fma_f32 v[10:11], v[96:97], v[96:97], v[10:11]
    v_pk_add_f32 v[8:9], v[8:9], v[98:99]
    v_pk_fma_f32 v[10:11], v[98:99], v[98:99], v[10:11]
    v_pk_add_f32 v[8:9], v[8:9], v[100:101]
    v_pk_fma_f32 v[10:11], v[100:101], v[100:101], v[10:11]
    v_pk_add_f32 v[8:9], v[8:9], v[102:103]
    v_pk_fma_f32 v[10:11], v[102:103], v[102:103], v[10:11]
    v_pk_add_f32 v[8:9], v[8:9], v[104:105]
    v_pk_fma_f32 v[10:11], v[104:105], v[104:105], v[10:11]
    v_pk_add_f32 v[8:9], v[8:9], v[106:107]
    v_pk_fma_f32 v[10:11], v[106:107], v[106:107], v[10:11]
    v_pk_add_f32 v[8:9], v[8:9], v[108:109]
    v_pk_fma_f32 v[10:11], v[108:109], v[108:109], v[10:11]
    v_pk_add_f32 v[8:9], v[8:9], v[110:111]
    v_pk_fma_f32 v[10:11], v[110:111], v[110:111], v[10:11]
    v_add_f32 v8, v8, v9
    v_add_f32 v10, v10, v11
    v_mov_b32 v9, v8
    v_mov_b32 v11, v10
    s_nop 0
    v_permlane32_swap_b32 v9, v8
    v_permlane32_swap_b32 v11, v10
    v_add_f32 v8, v8, v9
    v_add_f32 v10, v10, v11
    v_mov_b32 v9, v8
    v_mov_b32 v11, v10
    s_nop 0
    v_permlane16_swap_b32 v9, v8
    v_permlane16_swap_b32 v11, v10
    v_add_f32 v8, v8, v9
    v_add_f32 v10, v10, v11
    v_mul_f32 v9, 0xbb2aaaab, v8
    v_mul_f32 v10, 0x3b2aaaab, v10
    v_fma_f32 v10, -v9, v9, v10
    v_max_f32_e64 v10, 0, v10
    v_add_f32 v10, 0x3727c5ac, v10
    s_add_u32 m0, s71, 49152
    s_add_u32 s59, s68, s66
    buffer_load_dwordx4 v1, s[28:31], s59 offen offset:0 sc1 lds
    v_rsq_f32 v8, v10
    s_nop 0
    v_mul_f32 v8, s53, v8
    v_mul_f32_e64 v9, v9, v8
    v_pk_fma_f32 v[16:17], v[16:17], v[8:9], v[8:9] op_sel:[0,0,1] op_sel_hi:[1,0,1]
    v_pk_fma_f32 v[18:19], v[18:19], v[8:9], v[8:9] op_sel:[0,0,1] op_sel_hi:[1,0,1]
    v_pk_fma_f32 v[20:21], v[20:21], v[8:9], v[8:9] op_sel:[0,0,1] op_sel_hi:[1,0,1]
    buffer_load_dwordx4 v6, s[28:31], s59 offen offset:1024 sc1 lds
    v_pk_fma_f32 v[22:23], v[22:23], v[8:9], v[8:9] op_sel:[0,0,1] op_sel_hi:[1,0,1]
    v_cvt_pk_bf16_f32 v208, v16, v17
    v_cvt_pk_bf16_f32 v209, v18, v19
    v_cvt_pk_bf16_f32 v210, v20, v21
    v_cvt_pk_bf16_f32 v211, v22, v23
    v_pk_fma_f32 v[24:25], v[24:25], v[8:9], v[8:9] op_sel:[0,0,1] op_sel_hi:[1,0,1]
    v_pk_fma_f32 v[26:27], v[26:27], v[8:9], v[8:9] op_sel:[0,0,1] op_sel_hi:[1,0,1]
    v_pk_fma_f32 v[28:29], v[28:29], v[8:9], v[8:9] op_sel:[0,0,1] op_sel_hi:[1,0,1]
    buffer_load_dwordx4 v7, s[28:31], s59 offen offset:2048 sc1 lds
    v_pk_fma_f32 v[30:31], v[30:31], v[8:9], v[8:9] op_sel:[0,0,1] op_sel_hi:[1,0,1]
    v_cvt_pk_bf16_f32 v212, v24, v25
    v_cvt_pk_bf16_f32 v213, v26, v27
    v_cvt_pk_bf16_f32 v214, v28, v29
    v_cvt_pk_bf16_f32 v215, v30, v31
    v_pk_fma_f32 v[32:33], v[32:33], v[8:9], v[8:9] op_sel:[0,0,1] op_sel_hi:[1,0,1]
    v_pk_fma_f32 v[34:35], v[34:35], v[8:9], v[8:9] op_sel:[0,0,1] op_sel_hi:[1,0,1]
    buffer_load_dwordx4 v14, s[28:31], s59 offen offset:3072 sc1 lds
    v_pk_fma_f32 v[36:37], v[36:37], v[8:9], v[8:9] op_sel:[0,0,1] op_sel_hi:[1,0,1]
    v_pk_fma_f32 v[38:39], v[38:39], v[8:9], v[8:9] op_sel:[0,0,1] op_sel_hi:[1,0,1]
    v_cvt_pk_bf16_f32 v216, v32, v33
    v_cvt_pk_bf16_f32 v217, v34, v35
    v_cvt_pk_bf16_f32 v218, v36, v37
    v_cvt_pk_bf16_f32 v219, v38, v39
    v_pk_fma_f32 v[40:41], v[40:41], v[8:9], v[8:9] op_sel:[0,0,1] op_sel_hi:[1,0,1]
    v_pk_fma_f32 v[42:43], v[42:43], v[8:9], v[8:9] op_sel:[0,0,1] op_sel_hi:[1,0,1]
    s_add_u32 m0, s71, 53248
    s_add_u32 s59, s59, 98304
    buffer_load_dwordx4 v1, s[28:31], s59 offen offset:0 sc1 lds
    v_pk_fma_f32 v[44:45], v[44:45], v[8:9], v[8:9] op_sel:[0,0,1] op_sel_hi:[1,0,1]
    v_pk_fma_f32 v[46:47], v[46:47], v[8:9], v[8:9] op_sel:[0,0,1] op_sel_hi:[1,0,1]
    v_cvt_pk_bf16_f32 v220, v40, v41
    v_cvt_pk_bf16_f32 v221, v42, v43
    v_cvt_pk_bf16_f32 v222, v44, v45
    v_cvt_pk_bf16_f32 v223, v46, v47
    v_pk_fma_f32 v[48:49], v[48:49], v[8:9], v[8:9] op_sel:[0,0,1] op_sel_hi:[1,0,1]
    buffer_load_dwordx4 v6, s[28:31], s59 offen offset:1024 sc1 lds
    v_pk_fma_f32 v[50:51], v[50:51], v[8:9], v[8:9] op_sel:[0,0,1] op_sel_hi:[1,0,1]
    v_pk_fma_f32 v[52:53], v[52:53], v[8:9], v[8:9] op_sel:[0,0,1] op_sel_hi:[1,0,1]
    v_pk_fma_f32 v[54:55], v[54:55], v[8:9], v[8:9] op_sel:[0,0,1] op_sel_hi:[1,0,1]
    v_cvt_pk_bf16_f32 v224, v48, v49
    v_cvt_pk_bf16_f32 v225, v50, v51
    v_cvt_pk_bf16_f32 v226, v52, v53
    v_cvt_pk_bf16_f32 v227, v54, v55
    v_pk_fma_f32 v[56:57], v[56:57], v[8:9], v[8:9] op_sel:[0,0,1] op_sel_hi:[1,0,1]
    buffer_load_dwordx4 v7, s[28:31], s59 offen offset:2048 sc1 lds
    v_pk_fma_f32 v[58:59], v[58:59], v[8:9], v[8:9] op_sel:[0,0,1] op_sel_hi:[1,0,1]
    v_pk_fma_f32 v[60:61], v[60:61], v[8:9], v[8:9] op_sel:[0,0,1] op_sel_hi:[1,0,1]
    v_pk_fma_f32 v[62:63], v[62:63], v[8:9], v[8:9] op_sel:[0,0,1] op_sel_hi:[1,0,1]
    v_cvt_pk_bf16_f32 v228, v56, v57
    v_cvt_pk_bf16_f32 v229, v58, v59
    v_cvt_pk_bf16_f32 v230, v60, v61
    v_cvt_pk_bf16_f32 v231, v62, v63
    v_pk_fma_f32 v[64:65], v[64:65], v[8:9], v[8:9] op_sel:[0,0,1] op_sel_hi:[1,0,1]
    buffer_load_dwordx4 v14, s[28:31], s59 offen offset:3072 sc1 lds
    v_pk_fma_f32 v[66:67], v[66:67], v[8:9], v[8:9] op_sel:[0,0,1] op_sel_hi:[1,0,1]
    v_pk_fma_f32 v[68:69], v[68:69], v[8:9], v[8:9] op_sel:[0,0,1] op_sel_hi:[1,0,1]
    v_pk_fma_f32 v[70:71], v[70:71], v[8:9], v[8:9] op_sel:[0,0,1] op_sel_hi:[1,0,1]
    v_cvt_pk_bf16_f32 v232, v64, v65
    v_cvt_pk_bf16_f32 v233, v66, v67
    v_cvt_pk_bf16_f32 v234, v68, v69
    v_cvt_pk_bf16_f32 v235, v70, v71
    s_add_u32 m0, s71, 57344
    s_add_u32 s59, s59, 98304
    buffer_load_dwordx4 v1, s[28:31], s59 offen offset:0 sc1 lds
    v_pk_fma_f32 v[72:73], v[72:73], v[8:9], v[8:9] op_sel:[0,0,1] op_sel_hi:[1,0,1]
    v_pk_fma_f32 v[74:75], v[74:75], v[8:9], v[8:9] op_sel:[0,0,1] op_sel_hi:[1,0,1]
    v_pk_fma_f32 v[76:77], v[76:77], v[8:9], v[8:9] op_sel:[0,0,1] op_sel_hi:[1,0,1]
    v_pk_fma_f32 v[78:79], v[78:79], v[8:9], v[8:9] op_sel:[0,0,1] op_sel_hi:[1,0,1]
    v_cvt_pk_bf16_f32 v236, v72, v73
    v_cvt_pk_bf16_f32 v237, v74, v75
    v_cvt_pk_bf16_f32 v238, v76, v77
    v_cvt_pk_bf16_f32 v239, v78, v79
    buffer_load_dwordx4 v6, s[28:31], s59 offen offset:1024 sc1 lds
    v_pk_fma_f32 v[80:81], v[80:81], v[8:9], v[8:9] op_sel:[0,0,1] op_sel_hi:[1,0,1]
    v_pk_fma_f32 v[82:83], v[82:83], v[8:9], v[8:9] op_sel:[0,0,1] op_sel_hi:[1,0,1]
    v_pk_fma_f32 v[84:85], v[84:85], v[8:9], v[8:9] op_sel:[0,0,1] op_sel_hi:[1,0,1]
    v_pk_fma_f32 v[86:87], v[86:87], v[8:9], v[8:9] op_sel:[0,0,1] op_sel_hi:[1,0,1]
    v_cvt_pk_bf16_f32 v240, v80, v81
    v_cvt_pk_bf16_f32 v241, v82, v83
    v_cvt_pk_bf16_f32 v242, v84, v85
    buffer_load_dwordx4 v7, s[28:31], s59 offen offset:2048 sc1 lds
    v_cvt_pk_bf16_f32 v243, v86, v87
    v_pk_fma_f32 v[88:89], v[88:89], v[8:9], v[8:9] op_sel:[0,0,1] op_sel_hi:[1,0,1]
    v_pk_fma_f32 v[90:91], v[90:91], v[8:9], v[8:9] op_sel:[0,0,1] op_sel_hi:[1,0,1]
    v_pk_fma_f32 v[92:93], v[92:93], v[8:9], v[8:9] op_sel:[0,0,1] op_sel_hi:[1,0,1]
    v_pk_fma_f32 v[94:95], v[94:95], v[8:9], v[8:9] op_sel:[0,0,1] op_sel_hi:[1,0,1]
    v_cvt_pk_bf16_f32 v244, v88, v89
    v_cvt_pk_bf16_f32 v245, v90, v91
    v_cvt_pk_bf16_f32 v246, v92, v93
    buffer_load_dwordx4 v14, s[28:31], s59 offen offset:3072 sc1 lds
    s_add_u32 s68, s68, 128
    s_cmp_ge_u32 s68, 3072
    s_cselect_b32 s68, 0, s68
    v_cvt_pk_bf16_f32 v247, v94, v95
    v_pk_fma_f32 v[96:97], v[96:97], v[8:9], v[8:9] op_sel:[0,0,1] op_sel_hi:[1,0,1]
    v_pk_fma_f32 v[98:99], v[98:99], v[8:9], v[8:9] op_sel:[0,0,1] op_sel_hi:[1,0,1]
    v_pk_fma_f32 v[100:101], v[100:101], v[8:9], v[8:9] op_sel:[0,0,1] op_sel_hi:[1,0,1]
    v_pk_fma_f32 v[102:103], v[102:103], v[8:9], v[8:9] op_sel:[0,0,1] op_sel_hi:[1,0,1]
    v_cvt_pk_bf16_f32 v248, v96, v97
    v_cvt_pk_bf16_f32 v249, v98, v99
    v_cvt_pk_bf16_f32 v250, v100, v101
    v_cvt_pk_bf16_f32 v251, v102, v103
    v_pk_fma_f32 v[104:105], v[104:105], v[8:9], v[8:9] op_sel:[0,0,1] op_sel_hi:[1,0,1]
    v_pk_fma_f32 v[106:107], v[106:107], v[8:9], v[8:9] op_sel:[0,0,1] op_sel_hi:[1,0,1]
    v_pk_fma_f32 v[108:109], v[108:109], v[8:9], v[8:9] op_sel:[0,0,1] op_sel_hi:[1,0,1]
    v_pk_fma_f32 v[110:111], v[110:111], v[8:9], v[8:9] op_sel:[0,0,1] op_sel_hi:[1,0,1]
    v_cvt_pk_bf16_f32 v252, v104, v105
    v_cvt_pk_bf16_f32 v253, v106, v107
    v_cvt_pk_bf16_f32 v254, v108, v109
    v_cvt_pk_bf16_f32 v255, v110, v111
    s_waitcnt vmcnt(12)
    ds_read_b64_tr_b16 v[32:33], v113 offset:0
    ds_read_b64_tr_b16 v[34:35], v114 offset:0
    ds_read_b64_tr_b16 v[36:37], v113 offset:8
    ds_read_b64_tr_b16 v[38:39], v114 offset:8
    ds_read_b64 v[48:49], v115
    ds_read_b64 v[50:51], v116
    s_barrier
    ds_read_b64_tr_b16 v[40:41], v118 offset:0
    ds_read_b64_tr_b16 v[42:43], v118 offset:1024
    ds_read_b64_tr_b16 v[44:45], v118 offset:4096
    ds_read_b64_tr_b16 v[46:47], v118 offset:5120
    ds_read_b64_tr_b16 v[56:57], v4 offset:0
    ds_read_b64_tr_b16 v[58:59], v4 offset:1024
    ds_read_b64_tr_b16 v[60:61], v4 offset:4096
    ds_read_b64_tr_b16 v[62:63], v4 offset:5120
    v_mov_b32 v24, v112
    v_mov_b32 v12, v117
    s_waitcnt lgkmcnt(8)
    v_mfma_f32_16x16x32_bf16 v[16:19], v[48:51], v[32:35], 0
    v_mfma_f32_16x16x32_bf16 v[20:23], v[48:51], v[36:39], 0
    ds_read_b64_tr_b16 v[64:65], v4 offset:8192
    ds_read_b64_tr_b16 v[66:67], v4 offset:9216
    ds_read_b64_tr_b16 v[68:69], v4 offset:12288
    ds_read_b64_tr_b16 v[70:71], v4 offset:13312
    ds_read_b64_tr_b16 v[72:73], v4 offset:16384
    ds_read_b64_tr_b16 v[74:75], v4 offset:17408
    buffer_store_dwordx4 v[32:35], v24, s[48:51], s5 offen offset:0 sc1
    buffer_store_dwordx4 v[36:39], v24, s[48:51], s5 offen offset:2048 sc1
    s_waitcnt lgkmcnt(1)
    ds_read_b64_tr_b16 v[76:77], v4 offset:20480
    ds_read_b64_tr_b16 v[78:79], v4 offset:21504
    ds_read_b64_tr_b16 v[104:105], v4 offset:24576
    ds_read_b64_tr_b16 v[106:107], v4 offset:25600
    ds_read_b64_tr_b16 v[108:109], v4 offset:28672
    ds_read_b64_tr_b16 v[110:111], v4 offset:29696
    ds_read_b64_tr_b16 v[112:113], v4 offset:32768
    ds_read_b64_tr_b16 v[114:115], v4 offset:33792
    ds_read_b64_tr_b16 v[116:117], v4 offset:36864
    ds_read_b64_tr_b16 v[118:119], v4 offset:37888
    ds_read_b64_tr_b16 v[120:121], v4 offset:40960
    ds_read_b64_tr_b16 v[122:123], v4 offset:41984
    ds_read_b64_tr_b16 v[124:125], v4 offset:45056
    ds_read_b64_tr_b16 v[126:127], v4 offset:46080
    buffer_store_dwordx4 v[40:43], v24, s[48:51], s4 offen offset:0 sc1
    buffer_store_dwordx4 v[44:47], v24, s[48:51], s4 offen offset:1024 sc1
    s_mov_b32 vcc_lo, 0xffff
    s_mov_b32 vcc_hi, 0xffff
    v_cndmask_b32 v13, v20, v16, vcc
    s_mov_b32 s22, 0x40000
Lw_a:
    v_readfirstlane_b32 s23, v15
    s_nop 1
    s_cmp_ge_u32 s23, 18
    s_cbranch_scc1 Lw_a_ok
    buffer_load_dword v15, off, s[40:43], 0 offset:0 sc1
    s_sub_u32 s22, s22, 1
    s_cmp_lg_u32 s22, 0
    s_waitcnt vmcnt(0)
    s_cbranch_scc1 Lw_a
Lw_a_ok:
    buffer_atomic_add_f32 v13, v12, s[48:51], s6 offen
    v_mov_b32_e64 v15, 1
    s_mov_b32 s4, 98304
    s_mov_b32 s5, 98304
    s_mov_b32 s6, 4096
    s_mov_b32 s7, 4096
    s_mov_b32 s53, 128
    s_waitcnt lgkmcnt(0)
.p2align 6
L1_raw:
    v_mfma_f32_16x16x32_bf16 v[16:19], a[192:195], v[56:59], 0
    s_add_u32 s59, s68, s66
    v_exp_f32 v52, v52
    v_mfma_f32_16x16x32_bf16 v[16:19], a[196:199], v[60:63], v[16:19]
    s_add_u32 m0, s60, s71
    v_exp_f32 v53, v53
    v_mfma_f32_16x16x32_bf16 v[16:19], a[200:203], v[64:67], v[16:19]
    v_exp_f32_e64 v54, v54
    v_mfma_f32_16x16x32_bf16 v[16:19], a[204:207], v[68:71], v[16:19]
    v_exp_f32_e64 v55, v55
    v_mfma_f32_16x16x32_bf16 v[16:19], a[208:211], v[72:75], v[16:19]
    ds_read_b64_tr_b16 v[80:81], v4 offset:256
    ds_read_b64_tr_b16 v[82:83], v4 offset:1280
    ds_read_b64_tr_b16 v[84:85], v4 offset:4352
    ds_read_b64_tr_b16 v[86:87], v4 offset:5376
    v_mfma_f32_16x16x32_bf16 v[16:19], a[212:215], v[76:79], v[16:19]
    v_add_f32 v52, 1.0, v52
    v_add_f32 v53, 1.0, v53
    v_mfma_f32_16x16x32_bf16 v[16:19], a[216:219], v[104:107], v[16:19]
    v_add_f32 v54, 1.0, v54
    v_add_f32 v55, 1.0, v55
    v_mfma_f32_16x16x32_bf16 v[16:19], a[220:223], v[108:111], v[16:19]
    v_rcp_f32_e64 v52, v52
    v_mfma_f32_16x16x32_bf16 v[16:19], a[224:227], v[112:115], v[16:19]
    buffer_load_dwordx4 v1, s[28:31], s59 offen offset:0 sc1 lds
    v_mfma_f32_16x16x32_bf16 v[16:19], a[228:231], v[116:119], v[16:19]
    v_rcp_f32_e64 v53, v53
    v_mfma_f32_16x16x32_bf16 v[16:19], a[232:235], v[120:123], v[16:19]
    v_rcp_f32_e64 v54, v54
    v_mfma_f32_16x16x32_bf16 v[16:19], a[236:239], v[124:127], v[16:19]
    buffer_store_dwordx4 v[36:39], v2, s[32:35], s57 offen offset:1024 sc1
    v_rcp_f32_e64 v55, v55
    v_cvt_pk_bf16_f32 v42, v48, v49
    v_dot2_f32_bf16 v11, v36, v36, v11
    v_dot2_f32_bf16 v11, v37, v37, v11
    v_cvt_pk_bf16_f32 v43, v50, v51
    v_pk_mul_f32 v[52:53], v[28:29], v[52:53]
    v_pk_mul_f32 v[54:55], v[30:31], v[54:55]
    v_pk_fma_f32 v[48:49], v[16:17], v[16:17], s[52:53] op_sel_hi:[1,1,0]
    v_pk_fma_f32 v[50:51], v[18:19], v[18:19], s[52:53] op_sel_hi:[1,1,0]
    v_pk_mul_f32 v[48:49], v[16:17], v[48:49] neg_lo:[1,0] neg_hi:[1,0]
    v_pk_mul_f32 v[50:51], v[18:19], v[50:51] neg_lo:[1,0] neg_hi:[1,0]
    v_mfma_f32_16x16x32_bf16 v[20:23], v[156:159], v[124:127], 0
    v_exp_f32_e64 v48, v48
    v_mfma_f32_16x16x32_bf16 v[20:23], v[152:155], v[120:123], v[20:23]
    v_exp_f32_e64 v49, v49
    v_mfma_f32_16x16x32_bf16 v[20:23], v[148:151], v[116:119], v[20:23]
    v_exp_f32_e64 v50, v50
    v_mfma_f32_16x16x32_bf16 v[20:23], v[144:147], v[112:115], v[20:23]
    v_exp_f32_e64 v51, v51
    v_mfma_f32_16x16x32_bf16 v[20:23], v[140:143], v[108:111], v[20:23]
    ds_read_b64_tr_b16 v[88:89], v4 offset:8448
    ds_read_b64_tr_b16 v[90:91], v4 offset:9472
    ds_read_b64_tr_b16 v[92:93], v4 offset:12544
    ds_read_b64_tr_b16 v[94:95], v4 offset:13568
    v_mfma_f32_16x16x32_bf16 v[20:23], v[136:139], v[104:107], v[20:23]
    v_add_f32 v48, 1.0, v48
    v_add_f32 v49, 1.0, v49
    v_mfma_f32_16x16x32_bf16 v[20:23], v[132:135], v[76:79], v[20:23]
    v_add_f32 v50, 1.0, v50
    v_add_f32 v51, 1.0, v51
    v_mfma_f32_16x16x32_bf16 v[20:23], v[128:131], v[72:75], v[20:23]
    v_rcp_f32_e64 v48, v48
    v_mfma_f32_16x16x32_bf16 v[20:23], a[252:255], v[68:71], v[20:23]
    buffer_load_dwordx4 v6, s[28:31], s59 offen offset:1024 sc1 lds
    v_mfma_f32_16x16x32_bf16 v[20:23], a[248:251], v[64:67], v[20:23]
    v_rcp_f32_e64 v49, v49
    v_mfma_f32_16x16x32_bf16 v[20:23], a[244:247], v[60:63], v[20:23]
    v_rcp_f32_e64 v50, v50
    v_mfma_f32_16x16x32_bf16 v[20:23], a[240:243], v[56:59], v[20:23]
    buffer_store_dwordx4 v[40:43], v2, s[32:35], s57 offen offset:2048 sc1
    v_rcp_f32_e64 v51, v51
    v_cvt_pk_bf16_f32 v44, v52, v53
    v_dot2_f32_bf16 v11, v42, v42, v11
    v_dot2_f32_bf16 v11, v43, v43, v11
    v_cvt_pk_bf16_f32 v45, v54, v55
    v_pk_mul_f32 v[48:49], v[16:17], v[48:49]
    v_pk_mul_f32 v[50:51], v[18:19], v[50:51]
    v_pk_fma_f32 v[52:53], v[20:21], v[20:21], s[52:53] op_sel_hi:[1,1,0]
    v_pk_fma_f32 v[54:55], v[22:23], v[22:23], s[52:53] op_sel_hi:[1,1,0]
    v_pk_mul_f32 v[52:53], v[20:21], v[52:53] neg_lo:[1,0] neg_hi:[1,0]
    v_pk_mul_f32 v[54:55], v[22:23], v[54:55] neg_lo:[1,0] neg_hi:[1,0]
    v_mfma_f32_16x16x32_bf16 v[24:27], v[160:163], v[56:59], 0
    v_exp_f32_e64 v52, v52
    v_mfma_f32_16x16x32_bf16 v[24:27], v[164:167], v[60:63], v[24:27]
    v_exp_f32_e64 v53, v53
    v_mfma_f32_16x16x32_bf16 v[24:27], v[168:171], v[64:67], v[24:27]
    v_exp_f32_e64 v54, v54
    v_mfma_f32_16x16x32_bf16 v[24:27], v[172:175], v[68:71], v[24:27]
    v_exp_f32_e64 v55, v55
    v_mfma_f32_16x16x32_bf16 v[24:27], v[176:179], v[72:75], v[24:27]
    ds_read_b64_tr_b16 v[96:97], v4 offset:16640
    ds_read_b64_tr_b16 v[98:99], v4 offset:17664
    ds_read_b64_tr_b16 v[100:101], v4 offset:20736
    ds_read_b64_tr_b16 v[102:103], v4 offset:21760
    v_mfma_f32_16x16x32_bf16 v[24:27], v[180:183], v[76:79], v[24:27]
    v_add_f32 v52, 1.0, v52
    v_add_f32 v53, 1.0, v53
    v_mfma_f32_16x16x32_bf16 v[24:27], v[184:187], v[104:107], v[24:27]
    v_add_f32 v54, 1.0, v54
    v_add_f32 v55, 1.0, v55
    v_mfma_f32_16x16x32_bf16 v[24:27], v[188:191], v[108:111], v[24:27]
    v_rcp_f32_e64 v52, v52
    v_mfma_f32_16x16x32_bf16 v[24:27], v[192:195], v[112:115], v[24:27]
    v_permlane32_swap_b32 v8, v10
    v_add_f32 v12, v8, v10
    v_mfma_f32_16x16x32_bf16 v[24:27], v[196:199], v[116:119], v[24:27]
    v_rcp_f32_e64 v53, v53
    v_mfma_f32_16x16x32_bf16 v[24:27], v[200:203], v[120:123], v[24:27]
    v_rcp_f32_e64 v54, v54
    v_mfma_f32_16x16x32_bf16 v[24:27], v[204:207], v[124:127], v[24:27]
    buffer_store_dwordx4 v[44:47], v2, s[32:35], s57 offen offset:3072 sc1
    v_rcp_f32_e64 v55, v55
    v_cvt_pk_bf16_f32 v32, v48, v49
    v_dot2_f32_bf16 v11, v44, v44, v11
    v_dot2_f32_bf16 v11, v45, v45, v11
    v_cvt_pk_bf16_f32 v33, v50, v51
    v_pk_mul_f32 v[52:53], v[20:21], v[52:53]
    v_pk_mul_f32 v[54:55], v[22:23], v[54:55]
    v_pk_fma_f32 v[48:49], v[24:25], v[24:25], s[52:53] op_sel_hi:[1,1,0]
    v_pk_fma_f32 v[50:51], v[26:27], v[26:27], s[52:53] op_sel_hi:[1,1,0]
    v_pk_mul_f32 v[48:49], v[24:25], v[48:49] neg_lo:[1,0] neg_hi:[1,0]
    v_pk_mul_f32 v[50:51], v[26:27], v[50:51] neg_lo:[1,0] neg_hi:[1,0]
    v_mfma_f32_16x16x32_bf16 v[28:31], v[252:255], v[124:127], 0
    s_lshl_b32 s56, s63, 13
    v_exp_f32 v48, v48
    v_mfma_f32_16x16x32_bf16 v[28:31], v[248:251], v[120:123], v[28:31]
    s_add_u32 s56, s56, s64
    v_exp_f32 v49, v49
    v_mfma_f32_16x16x32_bf16 v[28:31], v[244:247], v[116:119], v[28:31]
    ds_read_b64_tr_b16 v[120:121], v4 offset:41216
    ds_read_b64_tr_b16 v[122:123], v4 offset:42240
    ds_read_b64_tr_b16 v[124:125], v4 offset:45312
    ds_read_b64_tr_b16 v[126:127], v4 offset:46336
    v_mfma_f32_16x16x32_bf16 v[28:31], v[240:243], v[112:115], v[28:31]
    s_add_u32 s57, s56, 4096
    v_exp_f32_e64 v50, v50
    v_mfma_f32_16x16x32_bf16 v[28:31], v[236:239], v[108:111], v[28:31]
    ds_read_b64_tr_b16 v[112:113], v4 offset:33024
    ds_read_b64_tr_b16 v[114:115], v4 offset:34048
    ds_read_b64_tr_b16 v[116:117], v4 offset:37120
    ds_read_b64_tr_b16 v[118:119], v4 offset:38144
    v_mfma_f32_16x16x32_bf16 v[28:31], v[232:235], v[104:107], v[28:31]
    v_exp_f32_e64 v51, v51
    v_mfma_f32_16x16x32_bf16 v[28:31], v[228:231], v[76:79], v[28:31]
    ds_read_b64_tr_b16 v[104:105], v4 offset:24832
    ds_read_b64_tr_b16 v[106:107], v4 offset:25856
    ds_read_b64_tr_b16 v[108:109], v4 offset:28928
    ds_read_b64_tr_b16 v[110:111], v4 offset:29952
    v_mfma_f32_16x16x32_bf16 v[28:31], v[224:227], v[72:75], v[28:31]
    v_add_f32 v48, 1.0, v48
    v_add_f32 v49, 1.0, v49
    v_mfma_f32_16x16x32_bf16 v[28:31], v[220:223], v[68:71], v[28:31]
    v_add_f32 v50, 1.0, v50
    v_add_f32 v51, 1.0, v51
    v_mfma_f32_16x16x32_bf16 v[28:31], v[216:219], v[64:67], v[28:31]
    v_rcp_f32_e64 v48, v48
    v_mfma_f32_16x16x32_bf16 v[28:31], v[212:215], v[60:63], v[28:31]
    v_rcp_f32_e64 v49, v49
    v_mfma_f32_16x16x32_bf16 v[28:31], v[208:211], v[56:59], v[28:31]
    s_waitcnt lgkmcnt(0)
    v_rcp_f32 v50, v50
    v_rcp_f32_e64 v51, v51
    v_cvt_pk_bf16_f32 v38, v52, v53
    v_dot2_f32_bf16 v8, v32, v32, 0
    v_dot2_f32_bf16 v8, v33, v33, v8
    v_cvt_pk_bf16_f32 v39, v54, v55
    v_pk_mul_f32 v[48:49], v[24:25], v[48:49]
    v_pk_mul_f32 v[50:51], v[26:27], v[50:51]
    v_pk_fma_f32 v[52:53], v[28:29], v[28:29], s[52:53] op_sel_hi:[1,1,0]
    v_pk_fma_f32 v[54:55], v[30:31], v[30:31], s[52:53] op_sel_hi:[1,1,0]
    v_pk_mul_f32 v[52:53], v[28:29], v[52:53] neg_lo:[1,0] neg_hi:[1,0]
    v_pk_mul_f32 v[54:55], v[30:31], v[54:55] neg_lo:[1,0] neg_hi:[1,0]
    v_mfma_f32_16x16x32_bf16 v[16:19], a[192:195], v[80:83], 0
    v_exp_f32_e64 v52, v52
    v_mfma_f32_16x16x32_bf16 v[16:19], a[196:199], v[84:87], v[16:19]
    v_permlane32_swap_b32 v9, v11
    v_add_f32 v13, v9, v11
    v_mfma_f32_16x16x32_bf16 v[16:19], a[200:203], v[88:91], v[16:19]
    v_exp_f32_e64 v53, v53
    v_mfma_f32_16x16x32_bf16 v[16:19], a[204:207], v[92:95], v[16:19]
    v_exp_f32_e64 v54, v54
    v_mfma_f32_16x16x32_bf16 v[16:19], a[208:211], v[96:99], v[16:19]
    ds_read_b64_tr_b16 v[56:57], v4 offset:512
    ds_read_b64_tr_b16 v[58:59], v4 offset:1536
    ds_read_b64_tr_b16 v[60:61], v4 offset:4608
    ds_read_b64_tr_b16 v[62:63], v4 offset:5632
    v_mfma_f32_16x16x32_bf16 v[16:19], a[212:215], v[100:103], v[16:19]
    v_exp_f32_e64 v55, v55
    v_mfma_f32_16x16x32_bf16 v[16:19], a[216:219], v[104:107], v[16:19]
    v_add_f32 v52, 1.0, v52
    v_add_f32 v53, 1.0, v53
    v_mfma_f32_16x16x32_bf16 v[16:19], a[220:223], v[108:111], v[16:19]
    v_add_f32 v54, 1.0, v54
    v_add_f32 v55, 1.0, v55
    v_mfma_f32_16x16x32_bf16 v[16:19], a[224:227], v[112:115], v[16:19]
    buffer_load_dwordx4 v7, s[28:31], s59 offen offset:2048 sc1 lds
    v_mfma_f32_16x16x32_bf16 v[16:19], a[228:231], v[116:119], v[16:19]
    v_rcp_f32_e64 v52, v52
    v_mfma_f32_16x16x32_bf16 v[16:19], a[232:235], v[120:123], v[16:19]
    v_rcp_f32_e64 v53, v53
    v_mfma_f32_16x16x32_bf16 v[16:19], a[236:239], v[124:127], v[16:19]
    v_rcp_f32 v54, v54
    v_rcp_f32 v55, v55
    v_cvt_pk_bf16_f32 v40, v48, v49
    v_dot2_f32_bf16 v8, v38, v38, v8
    v_dot2_f32_bf16 v8, v39, v39, v8
    v_cvt_pk_bf16_f32 v41, v50, v51
    v_pk_mul_f32 v[52:53], v[28:29], v[52:53]
    v_pk_mul_f32 v[54:55], v[30:31], v[54:55]
    v_pk_fma_f32 v[48:49], v[16:17], v[16:17], s[52:53] op_sel_hi:[1,1,0]
    v_pk_fma_f32 v[50:51], v[18:19], v[18:19], s[52:53] op_sel_hi:[1,1,0]
    v_pk_mul_f32 v[48:49], v[16:17], v[48:49] neg_lo:[1,0] neg_hi:[1,0]
    v_pk_mul_f32 v[50:51], v[18:19], v[50:51] neg_lo:[1,0] neg_hi:[1,0]
    v_mfma_f32_16x16x32_bf16 v[20:23], v[156:159], v[124:127], 0
    v_exp_f32_e64 v48, v48
    v_mfma_f32_16x16x32_bf16 v[20:23], v[152:155], v[120:123], v[20:23]
    v_permlane16_swap_b32 v12, v13
    v_add_f32 v13, v12, v13
    v_mfma_f32_16x16x32_bf16 v[20:23], v[148:151], v[116:119], v[20:23]
    v_exp_f32_e64 v49, v49
    v_mfma_f32_16x16x32_bf16 v[20:23], v[144:147], v[112:115], v[20:23]
    v_exp_f32_e64 v50, v50
    v_mfma_f32_16x16x32_bf16 v[20:23], v[140:143], v[108:111], v[20:23]
    ds_read_b64_tr_b16 v[64:65], v4 offset:8704
    ds_read_b64_tr_b16 v[66:67], v4 offset:9728
    ds_read_b64_tr_b16 v[68:69], v4 offset:12800
    ds_read_b64_tr_b16 v[70:71], v4 offset:13824
    v_mfma_f32_16x16x32_bf16 v[20:23], v[136:139], v[104:107], v[20:23]
    v_exp_f32_e64 v51, v51
    v_mfma_f32_16x16x32_bf16 v[20:23], v[132:135], v[100:103], v[20:23]
    v_add_f32 v48, 1.0, v48
    v_add_f32 v49, 1.0, v49
    v_mfma_f32_16x16x32_bf16 v[20:23], v[128:131], v[96:99], v[20:23]
    v_add_f32 v50, 1.0, v50
    v_add_f32 v51, 1.0, v51
    v_mfma_f32_16x16x32_bf16 v[20:23], a[252:255], v[92:95], v[20:23]
    buffer_load_dwordx4 v14, s[28:31], s59 offen offset:3072 sc1 lds
    v_mfma_f32_16x16x32_bf16 v[20:23], a[248:251], v[88:91], v[20:23]
    s_add_u32 s59, s59, s4
    v_rcp_f32 v48, v48
    v_mfma_f32_16x16x32_bf16 v[20:23], a[244:247], v[84:87], v[20:23]
    s_add_u32 m0, m0, s6
    v_rcp_f32 v49, v49
    v_mfma_f32_16x16x32_bf16 v[20:23], a[240:243], v[80:83], v[20:23]
    v_rcp_f32 v50, v50
    v_rcp_f32 v51, v51
    v_cvt_pk_bf16_f32 v46, v52, v53
    v_dot2_f32_bf16 v8, v40, v40, v8
    v_dot2_f32_bf16 v8, v41, v41, v8
    v_cvt_pk_bf16_f32 v47, v54, v55
    v_pk_mul_f32 v[48:49], v[16:17], v[48:49]
    v_pk_mul_f32 v[50:51], v[18:19], v[50:51]
    v_pk_fma_f32 v[52:53], v[20:21], v[20:21], s[52:53] op_sel_hi:[1,1,0]
    v_pk_fma_f32 v[54:55], v[22:23], v[22:23], s[52:53] op_sel_hi:[1,1,0]
    v_pk_mul_f32 v[52:53], v[20:21], v[52:53] neg_lo:[1,0] neg_hi:[1,0]
    v_pk_mul_f32 v[54:55], v[22:23], v[54:55] neg_lo:[1,0] neg_hi:[1,0]
    v_mfma_f32_16x16x32_bf16 v[24:27], v[160:163], v[80:83], 0
    v_exp_f32_e64 v52, v52
    v_mfma_f32_16x16x32_bf16 v[24:27], v[164:167], v[84:87], v[24:27]
    buffer_atomic_add_f32 v13, v3, s[36:39], s58 offen
    v_mfma_f32_16x16x32_bf16 v[24:27], v[168:171], v[88:91], v[24:27]
    s_lshl_b32 s58, s63, 8
    v_exp_f32 v53, v53
    v_mfma_f32_16x16x32_bf16 v[24:27], v[172:175], v[92:95], v[24:27]
    s_add_u32 s58, s58, s65
    v_exp_f32 v54, v54
    v_mfma_f32_16x16x32_bf16 v[24:27], v[176:179], v[96:99], v[24:27]
    ds_read_b64_tr_b16 v[72:73], v4 offset:16896
    ds_read_b64_tr_b16 v[74:75], v4 offset:17920
    ds_read_b64_tr_b16 v[76:77], v4 offset:20992
    ds_read_b64_tr_b16 v[78:79], v4 offset:22016
    v_mfma_f32_16x16x32_bf16 v[24:27], v[180:183], v[100:103], v[24:27]
    s_mov_b32 s38, 18432
    v_exp_f32_e64 v55, v55
    v_mfma_f32_16x16x32_bf16 v[24:27], v[184:187], v[104:107], v[24:27]
    v_add_f32 v52, 1.0, v52
    v_add_f32 v53, 1.0, v53
    v_mfma_f32_16x16x32_bf16 v[24:27], v[188:191], v[108:111], v[24:27]
    v_add_f32 v54, 1.0, v54
    v_add_f32 v55, 1.0, v55
    v_mfma_f32_16x16x32_bf16 v[24:27], v[192:195], v[112:115], v[24:27]
    buffer_load_dwordx4 v1, s[28:31], s59 offen offset:0 sc1 lds
    v_mfma_f32_16x16x32_bf16 v[24:27], v[196:199], v[116:119], v[24:27]
    v_rcp_f32_e64 v52, v52
    v_mfma_f32_16x16x32_bf16 v[24:27], v[200:203], v[120:123], v[24:27]
    v_rcp_f32_e64 v53, v53
    v_mfma_f32_16x16x32_bf16 v[24:27], v[204:207], v[124:127], v[24:27]
    v_rcp_f32 v54, v54
    v_rcp_f32 v55, v55
    v_cvt_pk_bf16_f32 v34, v48, v49
    v_dot2_f32_bf16 v8, v46, v46, v8
    v_dot2_f32_bf16 v8, v47, v47, v8
    v_cvt_pk_bf16_f32 v35, v50, v51
    v_pk_mul_f32 v[52:53], v[20:21], v[52:53]
    v_pk_mul_f32 v[54:55], v[22:23], v[54:55]
    v_pk_fma_f32 v[48:49], v[24:25], v[24:25], s[52:53] op_sel_hi:[1,1,0]
    v_pk_fma_f32 v[50:51], v[26:27], v[26:27], s[52:53] op_sel_hi:[1,1,0]
    v_pk_mul_f32 v[48:49], v[24:25], v[48:49] neg_lo:[1,0] neg_hi:[1,0]
    v_pk_mul_f32 v[50:51], v[26:27], v[50:51] neg_lo:[1,0] neg_hi:[1,0]
    v_mfma_f32_16x16x32_bf16 v[28:31], v[252:255], v[124:127], 0
    s_add_u32 s68, s68, s53
    v_exp_f32 v48, v48
    v_mfma_f32_16x16x32_bf16 v[28:31], v[248:251], v[120:123], v[28:31]
    s_cmp_ge_u32 s68, s73
    v_exp_f32 v49, v49
    v_mfma_f32_16x16x32_bf16 v[28:31], v[244:247], v[116:119], v[28:31]
    ds_read_b64_tr_b16 v[120:121], v4 offset:41472
    ds_read_b64_tr_b16 v[122:123], v4 offset:42496
    ds_read_b64_tr_b16 v[124:125], v4 offset:45568
    ds_read_b64_tr_b16 v[126:127], v4 offset:46592
    v_mfma_f32_16x16x32_bf16 v[28:31], v[240:243], v[112:115], v[28:31]
    s_cselect_b32 s68, 0, s68
    v_exp_f32 v50, v50
    v_mfma_f32_16x16x32_bf16 v[28:31], v[236:239], v[108:111], v[28:31]
    ds_read_b64_tr_b16 v[112:113], v4 offset:33280
    ds_read_b64_tr_b16 v[114:115], v4 offset:34304
    ds_read_b64_tr_b16 v[116:117], v4 offset:37376
    ds_read_b64_tr_b16 v[118:119], v4 offset:38400
    v_mfma_f32_16x16x32_bf16 v[28:31], v[232:235], v[104:107], v[28:31]
    s_add_u32 s60, s60, 49152
    v_exp_f32_e64 v51, v51
    v_mfma_f32_16x16x32_bf16 v[28:31], v[228:231], v[100:103], v[28:31]
    ds_read_b64_tr_b16 v[104:105], v4 offset:25088
    ds_read_b64_tr_b16 v[106:107], v4 offset:26112
    ds_read_b64_tr_b16 v[108:109], v4 offset:29184
    ds_read_b64_tr_b16 v[110:111], v4 offset:30208
    v_mfma_f32_16x16x32_bf16 v[28:31], v[224:227], v[96:99], v[28:31]
    s_cmp_ge_u32 s60, 147456
    v_add_f32 v48, 1.0, v48
    v_add_f32 v49, 1.0, v49
    v_mfma_f32_16x16x32_bf16 v[28:31], v[220:223], v[92:95], v[28:31]
    s_cselect_b32 s60, 0, s60
    v_add_f32 v50, 1.0, v50
    v_add_f32_e64 v51, 1.0, v51
    v_mfma_f32_16x16x32_bf16 v[28:31], v[216:219], v[88:91], v[28:31]
    s_add_u32 s63, s63, 1
    v_rcp_f32 v48, v48
    v_mfma_f32_16x16x32_bf16 v[28:31], v[212:215], v[84:87], v[28:31]
    s_cmp_ge_u32 s63, 24
    v_rcp_f32 v49, v49
    v_mfma_f32_16x16x32_bf16 v[28:31], v[208:211], v[80:83], v[28:31]
    s_waitcnt lgkmcnt(0)
    buffer_store_dwordx4 v[32:35], v2, s[32:35], s56 offen offset:0 sc1
    v_rcp_f32 v50, v50
    v_rcp_f32_e64 v51, v51
    v_cvt_pk_bf16_f32 v36, v52, v53
    v_dot2_f32_bf16 v9, v34, v34, 0
    v_dot2_f32_bf16 v9, v35, v35, v9
    v_cvt_pk_bf16_f32 v37, v54, v55
    v_pk_mul_f32 v[48:49], v[24:25], v[48:49]
    v_pk_mul_f32 v[50:51], v[26:27], v[50:51]
    v_pk_fma_f32 v[52:53], v[28:29], v[28:29], s[52:53] op_sel_hi:[1,1,0]
    v_pk_fma_f32 v[54:55], v[30:31], v[30:31], s[52:53] op_sel_hi:[1,1,0]
    v_pk_mul_f32 v[52:53], v[28:29], v[52:53] neg_lo:[1,0] neg_hi:[1,0]
    v_pk_mul_f32 v[54:55], v[30:31], v[54:55] neg_lo:[1,0] neg_hi:[1,0]
    v_mfma_f32_16x16x32_bf16 v[16:19], a[192:195], v[56:59], 0
    s_cselect_b32 s63, 0, s63
    v_exp_f32 v52, v52
    v_mfma_f32_16x16x32_bf16 v[16:19], a[196:199], v[60:63], v[16:19]
    s_add_u32 s61, s61, 49152
    v_exp_f32_e64 v53, v53
    v_mfma_f32_16x16x32_bf16 v[16:19], a[200:203], v[64:67], v[16:19]
    s_cmp_ge_u32 s61, 147456
    v_exp_f32_e64 v54, v54
    v_mfma_f32_16x16x32_bf16 v[16:19], a[204:207], v[68:71], v[16:19]
    s_cselect_b32 s61, 0, s61
    v_exp_f32 v55, v55
    v_mfma_f32_16x16x32_bf16 v[16:19], a[208:211], v[72:75], v[16:19]
    ds_read_b64_tr_b16 v[80:81], v4 offset:768
    ds_read_b64_tr_b16 v[82:83], v4 offset:1792
    ds_read_b64_tr_b16 v[84:85], v4 offset:4864
    ds_read_b64_tr_b16 v[86:87], v4 offset:5888
    v_mfma_f32_16x16x32_bf16 v[16:19], a[212:215], v[76:79], v[16:19]
    v_add_f32 v52, 1.0, v52
    v_add_f32 v53, 1.0, v53
    v_mfma_f32_16x16x32_bf16 v[16:19], a[216:219], v[104:107], v[16:19]
    v_add_f32 v54, 1.0, v54
    v_add_f32 v55, 1.0, v55
    v_mfma_f32_16x16x32_bf16 v[16:19], a[220:223], v[108:111], v[16:19]
    v_rcp_f32_e64 v52, v52
    v_mfma_f32_16x16x32_bf16 v[16:19], a[224:227], v[112:115], v[16:19]
    buffer_load_dwordx4 v6, s[28:31], s59 offen offset:1024 sc1 lds
    v_mfma_f32_16x16x32_bf16 v[16:19], a[228:231], v[116:119], v[16:19]
    v_rcp_f32_e64 v53, v53
    v_mfma_f32_16x16x32_bf16 v[16:19], a[232:235], v[120:123], v[16:19]
    v_rcp_f32_e64 v54, v54
    v_mfma_f32_16x16x32_bf16 v[16:19], a[236:239], v[124:127], v[16:19]
    buffer_store_dwordx4 v[36:39], v2, s[32:35], s56 offen offset:1024 sc1
    v_rcp_f32_e64 v55, v55
    v_cvt_pk_bf16_f32 v42, v48, v49
    v_dot2_f32_bf16 v9, v36, v36, v9
    v_dot2_f32_bf16 v9, v37, v37, v9
    v_cvt_pk_bf16_f32 v43, v50, v51
    v_pk_mul_f32 v[52:53], v[28:29], v[52:53]
    v_pk_mul_f32 v[54:55], v[30:31], v[54:55]
    v_pk_fma_f32 v[48:49], v[16:17], v[16:17], s[52:53] op_sel_hi:[1,1,0]
    v_pk_fma_f32 v[50:51], v[18:19], v[18:19], s[52:53] op_sel_hi:[1,1,0]
    v_pk_mul_f32 v[48:49], v[16:17], v[48:49] neg_lo:[1,0] neg_hi:[1,0]
    v_pk_mul_f32 v[50:51], v[18:19], v[50:51] neg_lo:[1,0] neg_hi:[1,0]
    v_mfma_f32_16x16x32_bf16 v[20:23], v[156:159], v[124:127], 0
    v_exp_f32_e64 v48, v48
    v_mfma_f32_16x16x32_bf16 v[20:23], v[152:155], v[120:123], v[20:23]
    v_exp_f32_e64 v49, v49
    v_mfma_f32_16x16x32_bf16 v[20:23], v[148:151], v[116:119], v[20:23]
    v_exp_f32_e64 v50, v50
    v_mfma_f32_16x16x32_bf16 v[20:23], v[144:147], v[112:115], v[20:23]
    v_exp_f32_e64 v51, v51
    v_mfma_f32_16x16x32_bf16 v[20:23], v[140:143], v[108:111], v[20:23]
    ds_read_b64_tr_b16 v[88:89], v4 offset:8960
    ds_read_b64_tr_b16 v[90:91], v4 offset:9984
    ds_read_b64_tr_b16 v[92:93], v4 offset:13056
    ds_read_b64_tr_b16 v[94:95], v4 offset:14080
    v_mfma_f32_16x16x32_bf16 v[20:23], v[136:139], v[104:107], v[20:23]
    v_add_f32 v48, 1.0, v48
    v_add_f32 v49, 1.0, v49
    v_mfma_f32_16x16x32_bf16 v[20:23], v[132:135], v[76:79], v[20:23]
    v_add_f32 v50, 1.0, v50
    v_add_f32 v51, 1.0, v51
    v_mfma_f32_16x16x32_bf16 v[20:23], v[128:131], v[72:75], v[20:23]
    v_rcp_f32_e64 v48, v48
    v_mfma_f32_16x16x32_bf16 v[20:23], a[252:255], v[68:71], v[20:23]
    buffer_load_dwordx4 v7, s[28:31], s59 offen offset:2048 sc1 lds
    v_mfma_f32_16x16x32_bf16 v[20:23], a[248:251], v[64:67], v[20:23]
    v_rcp_f32_e64 v49, v49
    v_mfma_f32_16x16x32_bf16 v[20:23], a[244:247], v[60:63], v[20:23]
    v_rcp_f32_e64 v50, v50
    v_mfma_f32_16x16x32_bf16 v[20:23], a[240:243], v[56:59], v[20:23]
    buffer_store_dwordx4 v[40:43], v2, s[32:35], s56 offen offset:2048 sc1
    v_rcp_f32_e64 v51, v51
    v_cvt_pk_bf16_f32 v44, v52, v53
    v_dot2_f32_bf16 v9, v42, v42, v9
    v_dot2_f32_bf16 v9, v43, v43, v9
    v_cvt_pk_bf16_f32 v45, v54, v55
    v_pk_mul_f32 v[48:49], v[16:17], v[48:49]
    v_pk_mul_f32 v[50:51], v[18:19], v[50:51]
    v_pk_fma_f32 v[52:53], v[20:21], v[20:21], s[52:53] op_sel_hi:[1,1,0]
    v_pk_fma_f32 v[54:55], v[22:23], v[22:23], s[52:53] op_sel_hi:[1,1,0]
    v_pk_mul_f32 v[52:53], v[20:21], v[52:53] neg_lo:[1,0] neg_hi:[1,0]
    v_pk_mul_f32 v[54:55], v[22:23], v[54:55] neg_lo:[1,0] neg_hi:[1,0]
    v_mfma_f32_16x16x32_bf16 v[24:27], v[160:163], v[56:59], 0
    v_exp_f32_e64 v52, v52
    v_mfma_f32_16x16x32_bf16 v[24:27], v[164:167], v[60:63], v[24:27]
    v_exp_f32_e64 v53, v53
    v_mfma_f32_16x16x32_bf16 v[24:27], v[168:171], v[64:67], v[24:27]
    v_exp_f32_e64 v54, v54
    v_mfma_f32_16x16x32_bf16 v[24:27], v[172:175], v[68:71], v[24:27]
    v_exp_f32_e64 v55, v55
    v_mfma_f32_16x16x32_bf16 v[24:27], v[176:179], v[72:75], v[24:27]
    ds_read_b64_tr_b16 v[96:97], v4 offset:17152
    ds_read_b64_tr_b16 v[98:99], v4 offset:18176
    ds_read_b64_tr_b16 v[100:101], v4 offset:21248
    ds_read_b64_tr_b16 v[102:103], v4 offset:22272
    v_mfma_f32_16x16x32_bf16 v[24:27], v[180:183], v[76:79], v[24:27]
    v_add_f32 v52, 1.0, v52
    v_add_f32 v53, 1.0, v53
    v_mfma_f32_16x16x32_bf16 v[24:27], v[184:187], v[104:107], v[24:27]
    v_add_f32 v54, 1.0, v54
    v_add_f32 v55, 1.0, v55
    v_mfma_f32_16x16x32_bf16 v[24:27], v[188:191], v[108:111], v[24:27]
    v_rcp_f32_e64 v52, v52
    v_mfma_f32_16x16x32_bf16 v[24:27], v[192:195], v[112:115], v[24:27]
    buffer_load_dwordx4 v14, s[28:31], s59 offen offset:3072 sc1 lds
    v_mfma_f32_16x16x32_bf16 v[24:27], v[196:199], v[116:119], v[24:27]
    s_add_u32 s59, s59, s5
    v_rcp_f32 v53, v53
    v_mfma_f32_16x16x32_bf16 v[24:27], v[200:203], v[120:123], v[24:27]
    s_add_u32 m0, m0, s7
    v_rcp_f32 v54, v54
    v_mfma_f32_16x16x32_bf16 v[24:27], v[204:207], v[124:127], v[24:27]
    buffer_store_dwordx4 v[44:47], v2, s[32:35], s56 offen offset:3072 sc1
    v_rcp_f32_e64 v55, v55
    v_cvt_pk_bf16_f32 v32, v48, v49
    v_dot2_f32_bf16 v9, v44, v44, v9
    v_dot2_f32_bf16 v9, v45, v45, v9
    v_cvt_pk_bf16_f32 v33, v50, v51
    v_pk_mul_f32 v[52:53], v[20:21], v[52:53]
    v_pk_mul_f32 v[54:55], v[22:23], v[54:55]
    v_pk_fma_f32 v[48:49], v[24:25], v[24:25], s[52:53] op_sel_hi:[1,1,0]
    v_pk_fma_f32 v[50:51], v[26:27], v[26:27], s[52:53] op_sel_hi:[1,1,0]
    v_pk_mul_f32 v[48:49], v[24:25], v[48:49] neg_lo:[1,0] neg_hi:[1,0]
    v_pk_mul_f32 v[50:51], v[26:27], v[50:51] neg_lo:[1,0] neg_hi:[1,0]
    v_mfma_f32_16x16x32_bf16 v[28:31], v[252:255], v[124:127], 0
    v_exp_f32_e64 v48, v48
    v_mfma_f32_16x16x32_bf16 v[28:31], v[248:251], v[120:123], v[28:31]
    v_exp_f32_e64 v49, v49
    v_mfma_f32_16x16x32_bf16 v[28:31], v[244:247], v[116:119], v[28:31]
    ds_read_b64_tr_b16 v[120:121], v4 offset:41728
    ds_read_b64_tr_b16 v[122:123], v4 offset:42752
    ds_read_b64_tr_b16 v[124:125], v4 offset:45824
    ds_read_b64_tr_b16 v[126:127], v4 offset:46848
    v_mfma_f32_16x16x32_bf16 v[28:31], v[240:243], v[112:115], v[28:31]
    v_exp_f32_e64 v50, v50
    v_mfma_f32_16x16x32_bf16 v[28:31], v[236:239], v[108:111], v[28:31]
    ds_read_b64_tr_b16 v[112:113], v4 offset:33536
    ds_read_b64_tr_b16 v[114:115], v4 offset:34560
    ds_read_b64_tr_b16 v[116:117], v4 offset:37632
    ds_read_b64_tr_b16 v[118:119], v4 offset:38656
    v_mfma_f32_16x16x32_bf16 v[28:31], v[232:235], v[104:107], v[28:31]
    v_exp_f32_e64 v51, v51
    v_mfma_f32_16x16x32_bf16 v[28:31], v[228:231], v[76:79], v[28:31]
    ds_read_b64_tr_b16 v[104:105], v4 offset:25344
    ds_read_b64_tr_b16 v[106:107], v4 offset:26368
    ds_read_b64_tr_b16 v[108:109], v4 offset:29440
    ds_read_b64_tr_b16 v[110:111], v4 offset:30464
    v_mfma_f32_16x16x32_bf16 v[28:31], v[224:227], v[72:75], v[28:31]
    v_add_f32 v48, 1.0, v48
    v_add_f32 v49, 1.0, v49
    v_mfma_f32_16x16x32_bf16 v[28:31], v[220:223], v[68:71], v[28:31]
    v_add_f32 v50, 1.0, v50
    v_add_f32 v51, 1.0, v51
    v_mfma_f32_16x16x32_bf16 v[28:31], v[216:219], v[64:67], v[28:31]
    v_rcp_f32_e64 v48, v48
    v_mfma_f32_16x16x32_bf16 v[28:31], v[212:215], v[60:63], v[28:31]
    s_cmp_eq_u32 s62, 20
    v_rcp_f32 v49, v49
    v_mfma_f32_16x16x32_bf16 v[28:31], v[208:211], v[56:59], v[28:31]
    s_waitcnt vmcnt(16) lgkmcnt(0)
    s_barrier
    s_cbranch_scc1 L1_mid
    buffer_atomic_add v15, v3, s[44:47], 0 offen sc1
    s_mov_b32 s46, 0
    v_rcp_f32 v50, v50
    v_rcp_f32 v51, v51
    v_cvt_pk_bf16_f32 v38, v52, v53
    v_dot2_f32_bf16 v10, v32, v32, 0
    v_dot2_f32_bf16 v10, v33, v33, v10
    v_cvt_pk_bf16_f32 v39, v54, v55
    v_pk_mul_f32 v[48:49], v[24:25], v[48:49]
    v_pk_mul_f32 v[50:51], v[26:27], v[50:51]
    v_pk_fma_f32 v[52:53], v[28:29], v[28:29], s[52:53] op_sel_hi:[1,1,0]
    v_pk_fma_f32 v[54:55], v[30:31], v[30:31], s[52:53] op_sel_hi:[1,1,0]
    v_pk_mul_f32 v[52:53], v[28:29], v[52:53] neg_lo:[1,0] neg_hi:[1,0]
    v_pk_mul_f32 v[54:55], v[30:31], v[54:55] neg_lo:[1,0] neg_hi:[1,0]
    v_mfma_f32_16x16x32_bf16 v[16:19], a[192:195], v[80:83], 0
    v_exp_f32_e64 v52, v52
    v_mfma_f32_16x16x32_bf16 v[16:19], a[196:199], v[84:87], v[16:19]
    buffer_load_dwordx4 v1, s[28:31], s59 offen offset:0 sc1 lds
    v_mfma_f32_16x16x32_bf16 v[16:19], a[200:203], v[88:91], v[16:19]
    v_exp_f32_e64 v53, v53
    v_mfma_f32_16x16x32_bf16 v[16:19], a[204:207], v[92:95], v[16:19]
    v_exp_f32_e64 v54, v54
    v_mfma_f32_16x16x32_bf16 v[16:19], a[208:211], v[96:99], v[16:19]
    v_exp_f32_e64 v55, v55
    v_mfma_f32_16x16x32_bf16 v[16:19], a[212:215], v[100:103], v[16:19]
    v_add_f32 v52, 1.0, v52
    v_add_f32 v53, 1.0, v53
    v_mfma_f32_16x16x32_bf16 v[16:19], a[216:219], v[104:107], v[16:19]
    v_add_u32_e64 v4, s61, v5
    v_mfma_f32_16x16x32_bf16 v[16:19], a[220:223], v[108:111], v[16:19]
    v_add_f32 v54, 1.0, v54
    v_add_f32 v55, 1.0, v55
    v_mfma_f32_16x16x32_bf16 v[16:19], a[224:227], v[112:115], v[16:19]
    buffer_load_dwordx4 v6, s[28:31], s59 offen offset:1024 sc1 lds
    v_mfma_f32_16x16x32_bf16 v[16:19], a[228:231], v[116:119], v[16:19]
    v_rcp_f32_e64 v52, v52
    v_mfma_f32_16x16x32_bf16 v[16:19], a[232:235], v[120:123], v[16:19]
    v_rcp_f32_e64 v53, v53
    v_mfma_f32_16x16x32_bf16 v[16:19], a[236:239], v[124:127], v[16:19]
    v_rcp_f32 v54, v54
    v_rcp_f32 v55, v55
    v_cvt_pk_bf16_f32 v40, v48, v49
    v_dot2_f32_bf16 v10, v38, v38, v10
    v_dot2_f32_bf16 v10, v39, v39, v10
    v_cvt_pk_bf16_f32 v41, v50, v51
    v_pk_mul_f32 v[52:53], v[28:29], v[52:53]
    v_pk_mul_f32 v[54:55], v[30:31], v[54:55]
    v_pk_fma_f32 v[48:49], v[16:17], v[16:17], s[52:53] op_sel_hi:[1,1,0]
    v_pk_fma_f32 v[50:51], v[18:19], v[18:19], s[52:53] op_sel_hi:[1,1,0]
    v_pk_mul_f32 v[48:49], v[16:17], v[48:49] neg_lo:[1,0] neg_hi:[1,0]
    v_pk_mul_f32 v[50:51], v[18:19], v[50:51] neg_lo:[1,0] neg_hi:[1,0]
    v_mfma_f32_16x16x32_bf16 v[20:23], v[156:159], v[124:127], 0
    v_exp_f32_e64 v48, v48
    v_mfma_f32_16x16x32_bf16 v[20:23], v[152:155], v[120:123], v[20:23]
    v_exp_f32_e64 v49, v49
    v_mfma_f32_16x16x32_bf16 v[20:23], v[148:151], v[116:119], v[20:23]
    ds_read_b64_tr_b16 v[56:57], v4 offset:0
    ds_read_b64_tr_b16 v[58:59], v4 offset:1024
    ds_read_b64_tr_b16 v[60:61], v4 offset:4096
    ds_read_b64_tr_b16 v[62:63], v4 offset:5120
    v_mfma_f32_16x16x32_bf16 v[20:23], v[144:147], v[112:115], v[20:23]
    v_exp_f32_e64 v50, v50
    v_mfma_f32_16x16x32_bf16 v[20:23], v[140:143], v[108:111], v[20:23]
    ds_read_b64_tr_b16 v[64:65], v4 offset:8192
    ds_read_b64_tr_b16 v[66:67], v4 offset:9216
    ds_read_b64_tr_b16 v[68:69], v4 offset:12288
    ds_read_b64_tr_b16 v[70:71], v4 offset:13312
    v_mfma_f32_16x16x32_bf16 v[20:23], v[136:139], v[104:107], v[20:23]
    v_exp_f32_e64 v51, v51
    v_mfma_f32_16x16x32_bf16 v[20:23], v[132:135], v[100:103], v[20:23]
    v_add_f32 v48, 1.0, v48
    v_add_f32 v49, 1.0, v49
    v_mfma_f32_16x16x32_bf16 v[20:23], v[128:131], v[96:99], v[20:23]
    v_add_f32 v50, 1.0, v50
    v_add_f32 v51, 1.0, v51
    v_mfma_f32_16x16x32_bf16 v[20:23], a[252:255], v[92:95], v[20:23]
    buffer_load_dwordx4 v7, s[28:31], s59 offen offset:2048 sc1 lds
    v_mfma_f32_16x16x32_bf16 v[20:23], a[248:251], v[88:91], v[20:23]
    v_rcp_f32_e64 v48, v48
    v_mfma_f32_16x16x32_bf16 v[20:23], a[244:247], v[84:87], v[20:23]
    v_rcp_f32_e64 v49, v49
    v_mfma_f32_16x16x32_bf16 v[20:23], a[240:243], v[80:83], v[20:23]
    s_sub_u32 s62, s62, 1
    v_rcp_f32 v50, v50
    v_rcp_f32_e64 v51, v51
    v_cvt_pk_bf16_f32 v46, v52, v53
    v_dot2_f32_bf16 v10, v40, v40, v10
    v_dot2_f32_bf16 v10, v41, v41, v10
    v_cvt_pk_bf16_f32 v47, v54, v55
    v_pk_mul_f32 v[48:49], v[16:17], v[48:49]
    v_pk_mul_f32 v[50:51], v[18:19], v[50:51]
    v_pk_fma_f32 v[52:53], v[20:21], v[20:21], s[52:53] op_sel_hi:[1,1,0]
    v_pk_fma_f32 v[54:55], v[22:23], v[22:23], s[52:53] op_sel_hi:[1,1,0]
    v_pk_mul_f32 v[52:53], v[20:21], v[52:53] neg_lo:[1,0] neg_hi:[1,0]
    v_pk_mul_f32 v[54:55], v[22:23], v[54:55] neg_lo:[1,0] neg_hi:[1,0]
    v_mfma_f32_16x16x32_bf16 v[24:27], v[160:163], v[80:83], 0
    v_exp_f32_e64 v52, v52
    v_mfma_f32_16x16x32_bf16 v[24:27], v[164:167], v[84:87], v[24:27]
    v_exp_f32_e64 v53, v53
    v_mfma_f32_16x16x32_bf16 v[24:27], v[168:171], v[88:91], v[24:27]
    v_exp_f32_e64 v54, v54
    v_mfma_f32_16x16x32_bf16 v[24:27], v[172:175], v[92:95], v[24:27]
    v_exp_f32_e64 v55, v55
    v_mfma_f32_16x16x32_bf16 v[24:27], v[176:179], v[96:99], v[24:27]
    ds_read_b64_tr_b16 v[72:73], v4 offset:16384
    ds_read_b64_tr_b16 v[74:75], v4 offset:17408
    ds_read_b64_tr_b16 v[76:77], v4 offset:20480
    ds_read_b64_tr_b16 v[78:79], v4 offset:21504
    v_mfma_f32_16x16x32_bf16 v[24:27], v[180:183], v[100:103], v[24:27]
    v_add_f32 v52, 1.0, v52
    v_add_f32 v53, 1.0, v53
    v_mfma_f32_16x16x32_bf16 v[24:27], v[184:187], v[104:107], v[24:27]
    v_add_f32 v54, 1.0, v54
    v_add_f32 v55, 1.0, v55
    v_mfma_f32_16x16x32_bf16 v[24:27], v[188:191], v[108:111], v[24:27]
    v_rcp_f32_e64 v52, v52
    v_mfma_f32_16x16x32_bf16 v[24:27], v[192:195], v[112:115], v[24:27]
    buffer_load_dwordx4 v14, s[28:31], s59 offen offset:3072 sc1 lds
    v_mfma_f32_16x16x32_bf16 v[24:27], v[196:199], v[116:119], v[24:27]
    v_rcp_f32_e64 v53, v53
    v_mfma_f32_16x16x32_bf16 v[24:27], v[200:203], v[120:123], v[24:27]
    v_rcp_f32_e64 v54, v54
    v_mfma_f32_16x16x32_bf16 v[24:27], v[204:207], v[124:127], v[24:27]
    s_sub_u32 s22, s62, 21
    s_cmp_gt_u32 s22, 1
    s_nop 1
    v_rcp_f32 v55, v55
    v_cvt_pk_bf16_f32 v34, v48, v49
    v_cvt_pk_bf16_f32 v35, v50, v51
    v_pk_mul_f32 v[52:53], v[20:21], v[52:53]
    v_pk_mul_f32 v[54:55], v[22:23], v[54:55]
    v_pk_fma_f32 v[48:49], v[24:25], v[24:25], s[52:53] op_sel_hi:[1,1,0]
    v_pk_fma_f32 v[50:51], v[26:27], v[26:27], s[52:53] op_sel_hi:[1,1,0]
    v_pk_mul_f32 v[48:49], v[24:25], v[48:49] neg_lo:[1,0] neg_hi:[1,0]
    v_pk_mul_f32 v[50:51], v[26:27], v[50:51] neg_lo:[1,0] neg_hi:[1,0]
    v_dot2_f32_bf16 v10, v46, v46, v10
    v_dot2_f32_bf16 v10, v47, v47, v10
    v_mfma_f32_16x16x32_bf16 v[28:31], v[252:255], v[124:127], 0
    v_exp_f32_e64 v48, v48
    v_mfma_f32_16x16x32_bf16 v[28:31], v[248:251], v[120:123], v[28:31]
    v_exp_f32_e64 v49, v49
    v_mfma_f32_16x16x32_bf16 v[28:31], v[244:247], v[116:119], v[28:31]
    ds_read_b64_tr_b16 v[120:121], v4 offset:40960
    ds_read_b64_tr_b16 v[122:123], v4 offset:41984
    ds_read_b64_tr_b16 v[124:125], v4 offset:45056
    ds_read_b64_tr_b16 v[126:127], v4 offset:46080
    v_mfma_f32_16x16x32_bf16 v[28:31], v[240:243], v[112:115], v[28:31]
    v_exp_f32_e64 v50, v50
    v_mfma_f32_16x16x32_bf16 v[28:31], v[236:239], v[108:111], v[28:31]
    ds_read_b64_tr_b16 v[112:113], v4 offset:32768
    ds_read_b64_tr_b16 v[114:115], v4 offset:33792
    ds_read_b64_tr_b16 v[116:117], v4 offset:36864
    ds_read_b64_tr_b16 v[118:119], v4 offset:37888
    v_mfma_f32_16x16x32_bf16 v[28:31], v[232:235], v[104:107], v[28:31]
    v_exp_f32_e64 v51, v51
    v_mfma_f32_16x16x32_bf16 v[28:31], v[228:231], v[100:103], v[28:31]
    ds_read_b64_tr_b16 v[104:105], v4 offset:24576
    ds_read_b64_tr_b16 v[106:107], v4 offset:25600
    ds_read_b64_tr_b16 v[108:109], v4 offset:28672
    ds_read_b64_tr_b16 v[110:111], v4 offset:29696
    v_mfma_f32_16x16x32_bf16 v[28:31], v[224:227], v[96:99], v[28:31]
    v_add_f32 v48, 1.0, v48
    v_add_f32 v49, 1.0, v49
    v_mfma_f32_16x16x32_bf16 v[28:31], v[220:223], v[92:95], v[28:31]
    v_add_f32 v50, 1.0, v50
    v_add_f32 v51, 1.0, v51
    v_mfma_f32_16x16x32_bf16 v[28:31], v[216:219], v[88:91], v[28:31]
    v_rcp_f32_e64 v48, v48
    v_mfma_f32_16x16x32_bf16 v[28:31], v[212:215], v[84:87], v[28:31]
    v_rcp_f32_e64 v49, v49
    v_mfma_f32_16x16x32_bf16 v[28:31], v[208:211], v[80:83], v[28:31]
    s_waitcnt lgkmcnt(0)
    buffer_store_dwordx4 v[32:35], v2, s[32:35], s57 offen offset:0 sc1
    v_rcp_f32 v50, v50
    v_rcp_f32_e64 v51, v51
    v_cvt_pk_bf16_f32 v36, v52, v53
    v_dot2_f32_bf16 v11, v34, v34, 0
    v_dot2_f32_bf16 v11, v35, v35, v11
    v_cvt_pk_bf16_f32 v37, v54, v55
    v_pk_mul_f32 v[48:49], v[24:25], v[48:49]
    v_pk_mul_f32 v[50:51], v[26:27], v[50:51]
    v_pk_fma_f32 v[52:53], v[28:29], v[28:29], s[52:53] op_sel_hi:[1,1,0]
    v_pk_fma_f32 v[54:55], v[30:31], v[30:31], s[52:53] op_sel_hi:[1,1,0]
    v_pk_mul_f32 v[52:53], v[28:29], v[52:53] neg_lo:[1,0] neg_hi:[1,0]
    v_pk_mul_f32 v[54:55], v[30:31], v[54:55] neg_lo:[1,0] neg_hi:[1,0]
    s_cbranch_scc1 L1_raw
    s_cmp_eq_u32 s22, 0
    s_cbranch_scc1 L1_h2
    v_and_b32 v32, 7, v0
    v_lshlrev_b32_e64 v32, 7, v32
    s_mov_b32 s23, 17408
    buffer_load_dword v15, v32, s[36:39], s23 offen sc1
    s_branch L1_raw
L1_h2:
    v_cmp_gt_u32 vcc, 18, v15
    v_and_b32 v1, 63, v0
    v_lshlrev_b32 v1, 4, v1
    v_mov_b32 v6, v1
    v_mov_b32 v7, v1
    v_mov_b32 v14, v1
    s_cbranch_vccnz Lw_c
Lw_c_ok:
    s_mov_b64 s[28:29], s[48:49]
    s_mov_b64 s[4:5], s[6:7]
    s_mul_i32 s68, s68, 384
    s_mov_b32 s66, s71
    s_mov_b32 s53, 49152
    s_mov_b32 s73, 1179648
    v_lshrrev_b32 v15, 2, v1
    v_add_u32 v15, 159744, v15
    v_mov_b32 v34, 0
    s_mov_b32 s69, 0
    ds_write_b32 v15, v34
    s_getpc_b64 s[22:23]
    v_lshlrev_b32 v32, 5, v0
    v_mov_b32 v33, s23
    v_add_co_u32 v32, vcc, s22, v32
    s_nop 1
    v_addc_co_u32 v33, vcc, 0, v33, vcc
    s_mov_b32 m0, 151552
    s_nop 0
    global_load_lds_dword v[32:33], off
    s_branch L1_raw
L1_lz:
    ds_read_b32 v14, v15
    s_waitcnt lgkmcnt(0)
    v_cmp_gt_u32 vcc, s69, v14
    s_nop 4
    s_cbranch_vccnz L1_lz
    s_branch L1_lzb
Lw_c:
    s_mov_b32 s22, 0x40000
Lw_c_l:
    v_and_b32 v32, 7, v0
    v_lshlrev_b32_e64 v32, 7, v32
    s_mov_b32 s23, 17408
    buffer_load_dword v15, v32, s[36:39], s23 offen sc1
    s_sub_u32 s22, s22, 1
    s_cmp_eq_u32 s22, 0
    s_waitcnt vmcnt(0)
    s_cbranch_scc1 Lw_c_ok
    v_cmp_gt_u32 vcc, 18, v15
    s_nop 4
    s_cbranch_vccnz Lw_c_l
    s_branch Lw_c_ok
.p2align 6
L1_loop:
    v_mfma_f32_16x16x32_bf16 v[16:19], a[192:195], v[56:59], 0
    s_add_u32 s59, s68, s66
    v_exp_f32 v52, v52
    v_mfma_f32_16x16x32_bf16 v[16:19], a[196:199], v[60:63], v[16:19]
    s_add_u32 m0, s60, s71
    v_exp_f32 v53, v53
    v_mfma_f32_16x16x32_bf16 v[16:19], a[200:203], v[64:67], v[16:19]
    v_exp_f32_e64 v54, v54
    v_mfma_f32_16x16x32_bf16 v[16:19], a[204:207], v[68:71], v[16:19]
    v_exp_f32_e64 v55, v55
    v_mfma_f32_16x16x32_bf16 v[16:19], a[208:211], v[72:75], v[16:19]
    ds_read_b128 v[80:83], v4 offset:12288
    ds_read_b128 v[84:87], v4 offset:13312
    v_mfma_f32_16x16x32_bf16 v[16:19], a[212:215], v[76:79], v[16:19]
    v_add_f32 v52, 1.0, v52
    v_add_f32 v53, 1.0, v53
    v_mfma_f32_16x16x32_bf16 v[16:19], a[216:219], v[104:107], v[16:19]
    v_add_f32 v54, 1.0, v54
    v_add_f32 v55, 1.0, v55
    v_mfma_f32_16x16x32_bf16 v[16:19], a[220:223], v[108:111], v[16:19]
    v_rcp_f32_e64 v52, v52
    v_mfma_f32_16x16x32_bf16 v[16:19], a[224:227], v[112:115], v[16:19]
    buffer_load_dwordx4 v1, s[28:31], s59 offen offset:0 sc1 lds
    v_mfma_f32_16x16x32_bf16 v[16:19], a[228:231], v[116:119], v[16:19]
    v_rcp_f32_e64 v53, v53
    v_mfma_f32_16x16x32_bf16 v[16:19], a[232:235], v[120:123], v[16:19]
    v_rcp_f32_e64 v54, v54
    v_mfma_f32_16x16x32_bf16 v[16:19], a[236:239], v[124:127], v[16:19]
    buffer_store_dwordx4 v[36:39], v2, s[32:35], s57 offen offset:1024 sc1
    v_rcp_f32_e64 v55, v55
    v_cvt_pk_bf16_f32 v42, v48, v49
    v_dot2_f32_bf16 v11, v36, v36, v11
    v_dot2_f32_bf16 v11, v37, v37, v11
    v_cvt_pk_bf16_f32 v43, v50, v51
    v_pk_mul_f32 v[52:53], v[28:29], v[52:53]
    v_pk_mul_f32 v[54:55], v[30:31], v[54:55]
    v_pk_fma_f32 v[48:49], v[16:17], v[16:17], s[52:53] op_sel_hi:[1,1,0]
    v_pk_fma_f32 v[50:51], v[18:19], v[18:19], s[52:53] op_sel_hi:[1,1,0]
    v_pk_mul_f32 v[48:49], v[16:17], v[48:49] neg_lo:[1,0] neg_hi:[1,0]
    v_pk_mul_f32 v[50:51], v[18:19], v[50:51] neg_lo:[1,0] neg_hi:[1,0]
    v_mfma_f32_16x16x32_bf16 v[20:23], v[156:159], v[124:127], 0
    v_exp_f32_e64 v48, v48
    v_mfma_f32_16x16x32_bf16 v[20:23], v[152:155], v[120:123], v[20:23]
    v_exp_f32_e64 v49, v49
    v_mfma_f32_16x16x32_bf16 v[20:23], v[148:151], v[116:119], v[20:23]
    v_exp_f32_e64 v50, v50
    v_mfma_f32_16x16x32_bf16 v[20:23], v[144:147], v[112:115], v[20:23]
    v_exp_f32_e64 v51, v51
    v_mfma_f32_16x16x32_bf16 v[20:23], v[140:143], v[108:111], v[20:23]
    ds_read_b128 v[88:91], v4 offset:14336
    ds_read_b128 v[92:95], v4 offset:15360
    v_mfma_f32_16x16x32_bf16 v[20:23], v[136:139], v[104:107], v[20:23]
    v_add_f32 v48, 1.0, v48
    v_add_f32 v49, 1.0, v49
    v_mfma_f32_16x16x32_bf16 v[20:23], v[132:135], v[76:79], v[20:23]
    v_add_f32 v50, 1.0, v50
    v_add_f32 v51, 1.0, v51
    v_mfma_f32_16x16x32_bf16 v[20:23], v[128:131], v[72:75], v[20:23]
    v_rcp_f32_e64 v48, v48
    v_mfma_f32_16x16x32_bf16 v[20:23], a[252:255], v[68:71], v[20:23]
    buffer_load_dwordx4 v1, s[28:31], s59 offen offset:1024 sc1 lds
    v_mfma_f32_16x16x32_bf16 v[20:23], a[248:251], v[64:67], v[20:23]
    v_rcp_f32_e64 v49, v49
    v_mfma_f32_16x16x32_bf16 v[20:23], a[244:247], v[60:63], v[20:23]
    v_rcp_f32_e64 v50, v50
    v_mfma_f32_16x16x32_bf16 v[20:23], a[240:243], v[56:59], v[20:23]
    buffer_store_dwordx4 v[40:43], v2, s[32:35], s57 offen offset:2048 sc1
    v_rcp_f32_e64 v51, v51
    v_cvt_pk_bf16_f32 v44, v52, v53
    v_dot2_f32_bf16 v11, v42, v42, v11
    v_dot2_f32_bf16 v11, v43, v43, v11
    v_cvt_pk_bf16_f32 v45, v54, v55
    v_pk_mul_f32 v[48:49], v[16:17], v[48:49]
    v_pk_mul_f32 v[50:51], v[18:19], v[50:51]
    v_pk_fma_f32 v[52:53], v[20:21], v[20:21], s[52:53] op_sel_hi:[1,1,0]
    v_pk_fma_f32 v[54:55], v[22:23], v[22:23], s[52:53] op_sel_hi:[1,1,0]
    v_pk_mul_f32 v[52:53], v[20:21], v[52:53] neg_lo:[1,0] neg_hi:[1,0]
    v_pk_mul_f32 v[54:55], v[22:23], v[54:55] neg_lo:[1,0] neg_hi:[1,0]
    v_mfma_f32_16x16x32_bf16 v[24:27], v[160:163], v[56:59], 0
    v_exp_f32_e64 v52, v52
    v_mfma_f32_16x16x32_bf16 v[24:27], v[164:167], v[60:63], v[24:27]
    v_exp_f32_e64 v53, v53
    v_mfma_f32_16x16x32_bf16 v[24:27], v[168:171], v[64:67], v[24:27]
    v_exp_f32_e64 v54, v54
    v_mfma_f32_16x16x32_bf16 v[24:27], v[172:175], v[68:71], v[24:27]
    v_exp_f32_e64 v55, v55
    v_mfma_f32_16x16x32_bf16 v[24:27], v[176:179], v[72:75], v[24:27]
    ds_read_b128 v[96:99], v4 offset:16384
    ds_read_b128 v[100:103], v4 offset:17408
    v_mfma_f32_16x16x32_bf16 v[24:27], v[180:183], v[76:79], v[24:27]
    v_add_f32 v52, 1.0, v52
    v_add_f32 v53, 1.0, v53
    v_mfma_f32_16x16x32_bf16 v[24:27], v[184:187], v[104:107], v[24:27]
    v_add_f32 v54, 1.0, v54
    v_add_f32 v55, 1.0, v55
    v_mfma_f32_16x16x32_bf16 v[24:27], v[188:191], v[108:111], v[24:27]
    v_rcp_f32_e64 v52, v52
    v_mfma_f32_16x16x32_bf16 v[24:27], v[192:195], v[112:115], v[24:27]
    v_permlane32_swap_b32 v8, v10
    v_add_f32 v12, v8, v10
    v_mfma_f32_16x16x32_bf16 v[24:27], v[196:199], v[116:119], v[24:27]
    v_rcp_f32_e64 v53, v53
    v_mfma_f32_16x16x32_bf16 v[24:27], v[200:203], v[120:123], v[24:27]
    v_rcp_f32_e64 v54, v54
    v_mfma_f32_16x16x32_bf16 v[24:27], v[204:207], v[124:127], v[24:27]
    buffer_store_dwordx4 v[44:47], v2, s[32:35], s57 offen offset:3072 sc1
    v_rcp_f32_e64 v55, v55
    v_cvt_pk_bf16_f32 v32, v48, v49
    v_dot2_f32_bf16 v11, v44, v44, v11
    v_dot2_f32_bf16 v11, v45, v45, v11
    v_cvt_pk_bf16_f32 v33, v50, v51
    v_pk_mul_f32 v[52:53], v[20:21], v[52:53]
    v_pk_mul_f32 v[54:55], v[22:23], v[54:55]
    v_pk_fma_f32 v[48:49], v[24:25], v[24:25], s[52:53] op_sel_hi:[1,1,0]
    v_pk_fma_f32 v[50:51], v[26:27], v[26:27], s[52:53] op_sel_hi:[1,1,0]
    v_pk_mul_f32 v[48:49], v[24:25], v[48:49] neg_lo:[1,0] neg_hi:[1,0]
    v_pk_mul_f32 v[50:51], v[26:27], v[50:51] neg_lo:[1,0] neg_hi:[1,0]
    v_mfma_f32_16x16x32_bf16 v[28:31], v[252:255], v[124:127], 0
    s_lshl_b32 s56, s63, 13
    v_exp_f32 v48, v48
    v_mfma_f32_16x16x32_bf16 v[28:31], v[248:251], v[120:123], v[28:31]
    s_add_u32 s56, s56, s64
    v_exp_f32 v49, v49
    v_mfma_f32_16x16x32_bf16 v[28:31], v[244:247], v[116:119], v[28:31]
    ds_read_b128 v[120:123], v4 offset:22528
    ds_read_b128 v[124:127], v4 offset:23552
    v_mfma_f32_16x16x32_bf16 v[28:31], v[240:243], v[112:115], v[28:31]
    s_add_u32 s57, s56, 4096
    v_exp_f32_e64 v50, v50
    v_mfma_f32_16x16x32_bf16 v[28:31], v[236:239], v[108:111], v[28:31]
    ds_read_b128 v[112:115], v4 offset:20480
    ds_read_b128 v[116:119], v4 offset:21504
    v_mfma_f32_16x16x32_bf16 v[28:31], v[232:235], v[104:107], v[28:31]
    v_exp_f32_e64 v51, v51
    v_mfma_f32_16x16x32_bf16 v[28:31], v[228:231], v[76:79], v[28:31]
    ds_read_b128 v[104:107], v4 offset:18432
    ds_read_b128 v[108:111], v4 offset:19456
    v_mfma_f32_16x16x32_bf16 v[28:31], v[224:227], v[72:75], v[28:31]
    v_add_f32 v48, 1.0, v48
    v_add_f32 v49, 1.0, v49
    v_mfma_f32_16x16x32_bf16 v[28:31], v[220:223], v[68:71], v[28:31]
    v_add_f32 v50, 1.0, v50
    v_add_f32 v51, 1.0, v51
    v_mfma_f32_16x16x32_bf16 v[28:31], v[216:219], v[64:67], v[28:31]
    v_rcp_f32_e64 v48, v48
    v_mfma_f32_16x16x32_bf16 v[28:31], v[212:215], v[60:63], v[28:31]
    v_rcp_f32_e64 v49, v49
    v_mfma_f32_16x16x32_bf16 v[28:31], v[208:211], v[56:59], v[28:31]
    s_waitcnt lgkmcnt(0)
    v_rcp_f32 v50, v50
    v_rcp_f32_e64 v51, v51
    v_cvt_pk_bf16_f32 v38, v52, v53
    v_dot2_f32_bf16 v8, v32, v32, 0
    v_dot2_f32_bf16 v8, v33, v33, v8
    v_cvt_pk_bf16_f32 v39, v54, v55
    v_pk_mul_f32 v[48:49], v[24:25], v[48:49]
    v_pk_mul_f32 v[50:51], v[26:27], v[50:51]
    v_pk_fma_f32 v[52:53], v[28:29], v[28:29], s[52:53] op_sel_hi:[1,1,0]
    v_pk_fma_f32 v[54:55], v[30:31], v[30:31], s[52:53] op_sel_hi:[1,1,0]
    v_pk_mul_f32 v[52:53], v[28:29], v[52:53] neg_lo:[1,0] neg_hi:[1,0]
    v_pk_mul_f32 v[54:55], v[30:31], v[54:55] neg_lo:[1,0] neg_hi:[1,0]
    v_mfma_f32_16x16x32_bf16 v[16:19], a[192:195], v[80:83], 0
    v_exp_f32_e64 v52, v52
    v_mfma_f32_16x16x32_bf16 v[16:19], a[196:199], v[84:87], v[16:19]
    v_permlane32_swap_b32 v9, v11
    v_add_f32 v13, v9, v11
    v_mfma_f32_16x16x32_bf16 v[16:19], a[200:203], v[88:91], v[16:19]
    v_exp_f32_e64 v53, v53
    v_mfma_f32_16x16x32_bf16 v[16:19], a[204:207], v[92:95], v[16:19]
    v_exp_f32_e64 v54, v54
    v_mfma_f32_16x16x32_bf16 v[16:19], a[208:211], v[96:99], v[16:19]
    ds_read_b128 v[56:59], v4 offset:24576
    ds_read_b128 v[60:63], v4 offset:25600
    v_mfma_f32_16x16x32_bf16 v[16:19], a[212:215], v[100:103], v[16:19]
    v_exp_f32_e64 v55, v55
    v_mfma_f32_16x16x32_bf16 v[16:19], a[216:219], v[104:107], v[16:19]
    v_add_f32 v52, 1.0, v52
    v_add_f32 v53, 1.0, v53
    v_mfma_f32_16x16x32_bf16 v[16:19], a[220:223], v[108:111], v[16:19]
    v_add_f32 v54, 1.0, v54
    v_add_f32 v55, 1.0, v55
    v_mfma_f32_16x16x32_bf16 v[16:19], a[224:227], v[112:115], v[16:19]
    buffer_load_dwordx4 v1, s[28:31], s59 offen offset:2048 sc1 lds
    v_mfma_f32_16x16x32_bf16 v[16:19], a[228:231], v[116:119], v[16:19]
    v_rcp_f32_e64 v52, v52
    v_mfma_f32_16x16x32_bf16 v[16:19], a[232:235], v[120:123], v[16:19]
    v_rcp_f32_e64 v53, v53
    v_mfma_f32_16x16x32_bf16 v[16:19], a[236:239], v[124:127], v[16:19]
    v_rcp_f32 v54, v54
    v_rcp_f32 v55, v55
    v_cvt_pk_bf16_f32 v40, v48, v49
    v_dot2_f32_bf16 v8, v38, v38, v8
    v_dot2_f32_bf16 v8, v39, v39, v8
    v_cvt_pk_bf16_f32 v41, v50, v51
    v_pk_mul_f32 v[52:53], v[28:29], v[52:53]
    v_pk_mul_f32 v[54:55], v[30:31], v[54:55]
    v_pk_fma_f32 v[48:49], v[16:17], v[16:17], s[52:53] op_sel_hi:[1,1,0]
    v_pk_fma_f32 v[50:51], v[18:19], v[18:19], s[52:53] op_sel_hi:[1,1,0]
    v_pk_mul_f32 v[48:49], v[16:17], v[48:49] neg_lo:[1,0] neg_hi:[1,0]
    v_pk_mul_f32 v[50:51], v[18:19], v[50:51] neg_lo:[1,0] neg_hi:[1,0]
    v_mfma_f32_16x16x32_bf16 v[20:23], v[156:159], v[124:127], 0
    v_exp_f32_e64 v48, v48
    v_mfma_f32_16x16x32_bf16 v[20:23], v[152:155], v[120:123], v[20:23]
    v_permlane16_swap_b32 v12, v13
    v_add_f32 v13, v12, v13
    v_mfma_f32_16x16x32_bf16 v[20:23], v[148:151], v[116:119], v[20:23]
    v_exp_f32_e64 v49, v49
    v_mfma_f32_16x16x32_bf16 v[20:23], v[144:147], v[112:115], v[20:23]
    v_exp_f32_e64 v50, v50
    v_mfma_f32_16x16x32_bf16 v[20:23], v[140:143], v[108:111], v[20:23]
    ds_read_b128 v[64:67], v4 offset:26624
    ds_read_b128 v[68:71], v4 offset:27648
    v_mfma_f32_16x16x32_bf16 v[20:23], v[136:139], v[104:107], v[20:23]
    v_exp_f32_e64 v51, v51
    v_mfma_f32_16x16x32_bf16 v[20:23], v[132:135], v[100:103], v[20:23]
    v_add_f32 v48, 1.0, v48
    v_add_f32 v49, 1.0, v49
    v_mfma_f32_16x16x32_bf16 v[20:23], v[128:131], v[96:99], v[20:23]
    v_add_f32 v50, 1.0, v50
    v_add_f32 v51, 1.0, v51
    v_mfma_f32_16x16x32_bf16 v[20:23], a[252:255], v[92:95], v[20:23]
    buffer_load_dwordx4 v1, s[28:31], s59 offen offset:3072 sc1 lds
    v_mfma_f32_16x16x32_bf16 v[20:23], a[248:251], v[88:91], v[20:23]
    s_add_u32 s59, s59, s4
    v_rcp_f32 v48, v48
    v_mfma_f32_16x16x32_bf16 v[20:23], a[244:247], v[84:87], v[20:23]
    s_add_u32 m0, m0, s6
    v_rcp_f32 v49, v49
    v_mfma_f32_16x16x32_bf16 v[20:23], a[240:243], v[80:83], v[20:23]
    v_rcp_f32 v50, v50
    v_rcp_f32 v51, v51
    v_cvt_pk_bf16_f32 v46, v52, v53
    v_dot2_f32_bf16 v8, v40, v40, v8
    v_dot2_f32_bf16 v8, v41, v41, v8
    v_cvt_pk_bf16_f32 v47, v54, v55
    v_pk_mul_f32 v[48:49], v[16:17], v[48:49]
    v_pk_mul_f32 v[50:51], v[18:19], v[50:51]
    v_pk_fma_f32 v[52:53], v[20:21], v[20:21], s[52:53] op_sel_hi:[1,1,0]
    v_pk_fma_f32 v[54:55], v[22:23], v[22:23], s[52:53] op_sel_hi:[1,1,0]
    v_pk_mul_f32 v[52:53], v[20:21], v[52:53] neg_lo:[1,0] neg_hi:[1,0]
    v_pk_mul_f32 v[54:55], v[22:23], v[54:55] neg_lo:[1,0] neg_hi:[1,0]
    v_mfma_f32_16x16x32_bf16 v[24:27], v[160:163], v[80:83], 0
    v_exp_f32_e64 v52, v52
    v_mfma_f32_16x16x32_bf16 v[24:27], v[164:167], v[84:87], v[24:27]
    buffer_atomic_add_f32 v13, v3, s[36:39], s58 offen
    v_mfma_f32_16x16x32_bf16 v[24:27], v[168:171], v[88:91], v[24:27]
    s_lshl_b32 s58, s63, 8
    v_exp_f32 v53, v53
    v_mfma_f32_16x16x32_bf16 v[24:27], v[172:175], v[92:95], v[24:27]
    s_add_u32 s58, s58, s65
    v_exp_f32 v54, v54
    v_mfma_f32_16x16x32_bf16 v[24:27], v[176:179], v[96:99], v[24:27]
    ds_read_b128 v[72:75], v4 offset:28672
    ds_read_b128 v[76:79], v4 offset:29696
    v_mfma_f32_16x16x32_bf16 v[24:27], v[180:183], v[100:103], v[24:27]
    v_exp_f32_e64 v55, v55
    v_mfma_f32_16x16x32_bf16 v[24:27], v[184:187], v[104:107], v[24:27]
    v_add_f32 v52, 1.0, v52
    v_add_f32 v53, 1.0, v53
    v_mfma_f32_16x16x32_bf16 v[24:27], v[188:191], v[108:111], v[24:27]
    v_add_f32 v54, 1.0, v54
    v_add_f32 v55, 1.0, v55
    v_mfma_f32_16x16x32_bf16 v[24:27], v[192:195], v[112:115], v[24:27]
    buffer_load_dwordx4 v1, s[28:31], s59 offen offset:0 sc1 lds
    v_mfma_f32_16x16x32_bf16 v[24:27], v[196:199], v[116:119], v[24:27]
    v_rcp_f32_e64 v52, v52
    v_mfma_f32_16x16x32_bf16 v[24:27], v[200:203], v[120:123], v[24:27]
    v_rcp_f32_e64 v53, v53
    v_mfma_f32_16x16x32_bf16 v[24:27], v[204:207], v[124:127], v[24:27]
    v_rcp_f32 v54, v54
    v_rcp_f32 v55, v55
    v_cvt_pk_bf16_f32 v34, v48, v49
    v_dot2_f32_bf16 v8, v46, v46, v8
    v_dot2_f32_bf16 v8, v47, v47, v8
    v_cvt_pk_bf16_f32 v35, v50, v51
    v_pk_mul_f32 v[52:53], v[20:21], v[52:53]
    v_pk_mul_f32 v[54:55], v[22:23], v[54:55]
    v_pk_fma_f32 v[48:49], v[24:25], v[24:25], s[52:53] op_sel_hi:[1,1,0]
    v_pk_fma_f32 v[50:51], v[26:27], v[26:27], s[52:53] op_sel_hi:[1,1,0]
    v_pk_mul_f32 v[48:49], v[24:25], v[48:49] neg_lo:[1,0] neg_hi:[1,0]
    v_pk_mul_f32 v[50:51], v[26:27], v[50:51] neg_lo:[1,0] neg_hi:[1,0]
    v_mfma_f32_16x16x32_bf16 v[28:31], v[252:255], v[124:127], 0
    s_add_u32 s68, s68, s53
    v_exp_f32 v48, v48
    v_mfma_f32_16x16x32_bf16 v[28:31], v[248:251], v[120:123], v[28:31]
    s_cmp_ge_u32 s68, s73
    v_exp_f32 v49, v49
    v_mfma_f32_16x16x32_bf16 v[28:31], v[244:247], v[116:119], v[28:31]
    ds_read_b128 v[120:123], v4 offset:34816
    ds_read_b128 v[124:127], v4 offset:35840
    v_mfma_f32_16x16x32_bf16 v[28:31], v[240:243], v[112:115], v[28:31]
    s_cselect_b32 s68, 0, s68
    v_exp_f32 v50, v50
    v_mfma_f32_16x16x32_bf16 v[28:31], v[236:239], v[108:111], v[28:31]
    ds_read_b128 v[112:115], v4 offset:32768
    ds_read_b128 v[116:119], v4 offset:33792
    v_mfma_f32_16x16x32_bf16 v[28:31], v[232:235], v[104:107], v[28:31]
    s_add_u32 s60, s60, 49152
    v_exp_f32_e64 v51, v51
    v_mfma_f32_16x16x32_bf16 v[28:31], v[228:231], v[100:103], v[28:31]
    ds_read_b128 v[104:107], v4 offset:30720
    ds_read_b128 v[108:111], v4 offset:31744
    v_mfma_f32_16x16x32_bf16 v[28:31], v[224:227], v[96:99], v[28:31]
    s_cmp_ge_u32 s60, 147456
    v_add_f32 v48, 1.0, v48
    v_add_f32 v49, 1.0, v49
    v_mfma_f32_16x16x32_bf16 v[28:31], v[220:223], v[92:95], v[28:31]
    s_cselect_b32 s60, 0, s60
    v_add_f32 v50, 1.0, v50
    v_add_f32_e64 v51, 1.0, v51
    v_mfma_f32_16x16x32_bf16 v[28:31], v[216:219], v[88:91], v[28:31]
    s_add_u32 s63, s63, 1
    v_rcp_f32 v48, v48
    v_mfma_f32_16x16x32_bf16 v[28:31], v[212:215], v[84:87], v[28:31]
    s_cmp_ge_u32 s63, 24
    v_rcp_f32 v49, v49
    v_mfma_f32_16x16x32_bf16 v[28:31], v[208:211], v[80:83], v[28:31]
    s_waitcnt lgkmcnt(0)
    buffer_store_dwordx4 v[32:35], v2, s[32:35], s56 offen offset:0 sc1
    v_rcp_f32 v50, v50
    v_rcp_f32_e64 v51, v51
    v_cvt_pk_bf16_f32 v36, v52, v53
    v_dot2_f32_bf16 v9, v34, v34, 0
    v_dot2_f32_bf16 v9, v35, v35, v9
    v_cvt_pk_bf16_f32 v37, v54, v55
    v_pk_mul_f32 v[48:49], v[24:25], v[48:49]
    v_pk_mul_f32 v[50:51], v[26:27], v[50:51]
    v_pk_fma_f32 v[52:53], v[28:29], v[28:29], s[52:53] op_sel_hi:[1,1,0]
    v_pk_fma_f32 v[54:55], v[30:31], v[30:31], s[52:53] op_sel_hi:[1,1,0]
    v_pk_mul_f32 v[52:53], v[28:29], v[52:53] neg_lo:[1,0] neg_hi:[1,0]
    v_pk_mul_f32 v[54:55], v[30:31], v[54:55] neg_lo:[1,0] neg_hi:[1,0]
    v_mfma_f32_16x16x32_bf16 v[16:19], a[192:195], v[56:59], 0
    s_cselect_b32 s63, 0, s63
    v_exp_f32 v52, v52
    v_mfma_f32_16x16x32_bf16 v[16:19], a[196:199], v[60:63], v[16:19]
    s_add_u32 s61, s61, 49152
    v_exp_f32_e64 v53, v53
    v_mfma_f32_16x16x32_bf16 v[16:19], a[200:203], v[64:67], v[16:19]
    s_cmp_ge_u32 s61, 147456
    v_exp_f32_e64 v54, v54
    v_mfma_f32_16x16x32_bf16 v[16:19], a[204:207], v[68:71], v[16:19]
    s_cselect_b32 s61, 0, s61
    v_exp_f32 v55, v55
    v_mfma_f32_16x16x32_bf16 v[16:19], a[208:211], v[72:75], v[16:19]
    ds_read_b128 v[80:83], v4 offset:36864
    ds_read_b128 v[84:87], v4 offset:37888
    v_mfma_f32_16x16x32_bf16 v[16:19], a[212:215], v[76:79], v[16:19]
    v_add_f32 v52, 1.0, v52
    v_add_f32 v53, 1.0, v53
    v_mfma_f32_16x16x32_bf16 v[16:19], a[216:219], v[104:107], v[16:19]
    v_add_f32 v54, 1.0, v54
    v_add_f32 v55, 1.0, v55
    v_mfma_f32_16x16x32_bf16 v[16:19], a[220:223], v[108:111], v[16:19]
    v_rcp_f32_e64 v52, v52
    v_mfma_f32_16x16x32_bf16 v[16:19], a[224:227], v[112:115], v[16:19]
    buffer_load_dwordx4 v1, s[28:31], s59 offen offset:1024 sc1 lds
    v_mfma_f32_16x16x32_bf16 v[16:19], a[228:231], v[116:119], v[16:19]
    v_rcp_f32_e64 v53, v53
    v_mfma_f32_16x16x32_bf16 v[16:19], a[232:235], v[120:123], v[16:19]
    v_rcp_f32_e64 v54, v54
    v_mfma_f32_16x16x32_bf16 v[16:19], a[236:239], v[124:127], v[16:19]
    buffer_store_dwordx4 v[36:39], v2, s[32:35], s56 offen offset:1024 sc1
    v_rcp_f32_e64 v55, v55
    v_cvt_pk_bf16_f32 v42, v48, v49
    v_dot2_f32_bf16 v9, v36, v36, v9
    v_dot2_f32_bf16 v9, v37, v37, v9
    v_cvt_pk_bf16_f32 v43, v50, v51
    v_pk_mul_f32 v[52:53], v[28:29], v[52:53]
    v_pk_mul_f32 v[54:55], v[30:31], v[54:55]
    v_pk_fma_f32 v[48:49], v[16:17], v[16:17], s[52:53] op_sel_hi:[1,1,0]
    v_pk_fma_f32 v[50:51], v[18:19], v[18:19], s[52:53] op_sel_hi:[1,1,0]
    v_pk_mul_f32 v[48:49], v[16:17], v[48:49] neg_lo:[1,0] neg_hi:[1,0]
    v_pk_mul_f32 v[50:51], v[18:19], v[50:51] neg_lo:[1,0] neg_hi:[1,0]
    v_mfma_f32_16x16x32_bf16 v[20:23], v[156:159], v[124:127], 0
    v_exp_f32_e64 v48, v48
    v_mfma_f32_16x16x32_bf16 v[20:23], v[152:155], v[120:123], v[20:23]
    v_exp_f32_e64 v49, v49
    v_mfma_f32_16x16x32_bf16 v[20:23], v[148:151], v[116:119], v[20:23]
    v_exp_f32_e64 v50, v50
    v_mfma_f32_16x16x32_bf16 v[20:23], v[144:147], v[112:115], v[20:23]
    v_exp_f32_e64 v51, v51
    v_mfma_f32_16x16x32_bf16 v[20:23], v[140:143], v[108:111], v[20:23]
    ds_read_b128 v[88:91], v4 offset:38912
    ds_read_b128 v[92:95], v4 offset:39936
    v_mfma_f32_16x16x32_bf16 v[20:23], v[136:139], v[104:107], v[20:23]
    v_add_f32 v48, 1.0, v48
    v_add_f32 v49, 1.0, v49
    v_mfma_f32_16x16x32_bf16 v[20:23], v[132:135], v[76:79], v[20:23]
    v_add_f32 v50, 1.0, v50
    v_add_f32 v51, 1.0, v51
    v_mfma_f32_16x16x32_bf16 v[20:23], v[128:131], v[72:75], v[20:23]
    v_rcp_f32_e64 v48, v48
    v_mfma_f32_16x16x32_bf16 v[20:23], a[252:255], v[68:71], v[20:23]
    buffer_load_dwordx4 v1, s[28:31], s59 offen offset:2048 sc1 lds
    v_mfma_f32_16x16x32_bf16 v[20:23], a[248:251], v[64:67], v[20:23]
    v_rcp_f32_e64 v49, v49
    v_mfma_f32_16x16x32_bf16 v[20:23], a[244:247], v[60:63], v[20:23]
    v_rcp_f32_e64 v50, v50
    v_mfma_f32_16x16x32_bf16 v[20:23], a[240:243], v[56:59], v[20:23]
    buffer_store_dwordx4 v[40:43], v2, s[32:35], s56 offen offset:2048 sc1
    v_rcp_f32_e64 v51, v51
    v_cvt_pk_bf16_f32 v44, v52, v53
    v_dot2_f32_bf16 v9, v42, v42, v9
    v_dot2_f32_bf16 v9, v43, v43, v9
    v_cvt_pk_bf16_f32 v45, v54, v55
    v_pk_mul_f32 v[48:49], v[16:17], v[48:49]
    v_pk_mul_f32 v[50:51], v[18:19], v[50:51]
    v_pk_fma_f32 v[52:53], v[20:21], v[20:21], s[52:53] op_sel_hi:[1,1,0]
    v_pk_fma_f32 v[54:55], v[22:23], v[22:23], s[52:53] op_sel_hi:[1,1,0]
    v_pk_mul_f32 v[52:53], v[20:21], v[52:53] neg_lo:[1,0] neg_hi:[1,0]
    v_pk_mul_f32 v[54:55], v[22:23], v[54:55] neg_lo:[1,0] neg_hi:[1,0]
    v_mfma_f32_16x16x32_bf16 v[24:27], v[160:163], v[56:59], 0
    v_exp_f32_e64 v52, v52
    v_mfma_f32_16x16x32_bf16 v[24:27], v[164:167], v[60:63], v[24:27]
    v_exp_f32_e64 v53, v53
    v_mfma_f32_16x16x32_bf16 v[24:27], v[168:171], v[64:67], v[24:27]
    v_exp_f32_e64 v54, v54
    v_mfma_f32_16x16x32_bf16 v[24:27], v[172:175], v[68:71], v[24:27]
    v_exp_f32_e64 v55, v55
    v_mfma_f32_16x16x32_bf16 v[24:27], v[176:179], v[72:75], v[24:27]
    ds_read_b128 v[96:99], v4 offset:40960
    ds_read_b128 v[100:103], v4 offset:41984
    v_mfma_f32_16x16x32_bf16 v[24:27], v[180:183], v[76:79], v[24:27]
    v_add_f32 v52, 1.0, v52
    v_add_f32 v53, 1.0, v53
    v_mfma_f32_16x16x32_bf16 v[24:27], v[184:187], v[104:107], v[24:27]
    v_add_f32 v54, 1.0, v54
    v_add_f32 v55, 1.0, v55
    v_mfma_f32_16x16x32_bf16 v[24:27], v[188:191], v[108:111], v[24:27]
    v_rcp_f32_e64 v52, v52
    v_mfma_f32_16x16x32_bf16 v[24:27], v[192:195], v[112:115], v[24:27]
    buffer_load_dwordx4 v1, s[28:31], s59 offen offset:3072 sc1 lds
    v_mfma_f32_16x16x32_bf16 v[24:27], v[196:199], v[116:119], v[24:27]
    s_add_u32 s59, s59, s5
    v_rcp_f32 v53, v53
    v_mfma_f32_16x16x32_bf16 v[24:27], v[200:203], v[120:123], v[24:27]
    s_add_u32 m0, m0, s7
    v_rcp_f32 v54, v54
    v_mfma_f32_16x16x32_bf16 v[24:27], v[204:207], v[124:127], v[24:27]
    buffer_store_dwordx4 v[44:47], v2, s[32:35], s56 offen offset:3072 sc1
    v_rcp_f32_e64 v55, v55
    v_cvt_pk_bf16_f32 v32, v48, v49
    v_dot2_f32_bf16 v9, v44, v44, v9
    v_dot2_f32_bf16 v9, v45, v45, v9
    v_cvt_pk_bf16_f32 v33, v50, v51
    v_pk_mul_f32 v[52:53], v[20:21], v[52:53]
    v_pk_mul_f32 v[54:55], v[22:23], v[54:55]
    v_pk_fma_f32 v[48:49], v[24:25], v[24:25], s[52:53] op_sel_hi:[1,1,0]
    v_pk_fma_f32 v[50:51], v[26:27], v[26:27], s[52:53] op_sel_hi:[1,1,0]
    v_pk_mul_f32 v[48:49], v[24:25], v[48:49] neg_lo:[1,0] neg_hi:[1,0]
    v_pk_mul_f32 v[50:51], v[26:27], v[50:51] neg_lo:[1,0] neg_hi:[1,0]
    v_mfma_f32_16x16x32_bf16 v[28:31], v[252:255], v[124:127], 0
    v_exp_f32_e64 v48, v48
    v_mfma_f32_16x16x32_bf16 v[28:31], v[248:251], v[120:123], v[28:31]
    v_exp_f32_e64 v49, v49
    v_mfma_f32_16x16x32_bf16 v[28:31], v[244:247], v[116:119], v[28:31]
    ds_read_b128 v[120:123], v4 offset:47104
    ds_read_b128 v[124:127], v4 offset:48128
    v_mfma_f32_16x16x32_bf16 v[28:31], v[240:243], v[112:115], v[28:31]
    v_exp_f32_e64 v50, v50
    v_mfma_f32_16x16x32_bf16 v[28:31], v[236:239], v[108:111], v[28:31]
    ds_read_b128 v[112:115], v4 offset:45056
    ds_read_b128 v[116:119], v4 offset:46080
    v_mfma_f32_16x16x32_bf16 v[28:31], v[232:235], v[104:107], v[28:31]
    v_exp_f32_e64 v51, v51
    v_mfma_f32_16x16x32_bf16 v[28:31], v[228:231], v[76:79], v[28:31]
    ds_read_b128 v[104:107], v4 offset:43008
    ds_read_b128 v[108:111], v4 offset:44032
    v_mfma_f32_16x16x32_bf16 v[28:31], v[224:227], v[72:75], v[28:31]
    v_add_f32 v48, 1.0, v48
    v_add_f32 v49, 1.0, v49
    v_mfma_f32_16x16x32_bf16 v[28:31], v[220:223], v[68:71], v[28:31]
    v_add_f32 v50, 1.0, v50
    v_add_f32 v51, 1.0, v51
    v_mfma_f32_16x16x32_bf16 v[28:31], v[216:219], v[64:67], v[28:31]
    v_rcp_f32_e64 v48, v48
    v_mfma_f32_16x16x32_bf16 v[28:31], v[212:215], v[60:63], v[28:31]
    v_rcp_f32_e64 v49, v49
    v_mfma_f32_16x16x32_bf16 v[28:31], v[208:211], v[56:59], v[28:31]
    s_waitcnt vmcnt(16) lgkmcnt(0)
L1_mid:
    ds_inc_u32 v15, v15
    v_rcp_f32 v50, v50
    v_rcp_f32_e64 v51, v51
    v_cvt_pk_bf16_f32 v38, v52, v53
    v_dot2_f32_bf16 v10, v32, v32, 0
    v_dot2_f32_bf16 v10, v33, v33, v10
    v_cvt_pk_bf16_f32 v39, v54, v55
    v_pk_mul_f32 v[48:49], v[24:25], v[48:49]
    v_pk_mul_f32 v[50:51], v[26:27], v[50:51]
    v_pk_fma_f32 v[52:53], v[28:29], v[28:29], s[52:53] op_sel_hi:[1,1,0]
    v_pk_fma_f32 v[54:55], v[30:31], v[30:31], s[52:53] op_sel_hi:[1,1,0]
    v_pk_mul_f32 v[52:53], v[28:29], v[52:53] neg_lo:[1,0] neg_hi:[1,0]
    v_pk_mul_f32 v[54:55], v[30:31], v[54:55] neg_lo:[1,0] neg_hi:[1,0]
    v_mfma_f32_16x16x32_bf16 v[16:19], a[192:195], v[80:83], 0
    s_add_u32 s69, s69, 4
    v_exp_f32 v52, v52
    v_mfma_f32_16x16x32_bf16 v[16:19], a[196:199], v[84:87], v[16:19]
    buffer_load_dwordx4 v1, s[28:31], s59 offen offset:0 sc1 lds
    v_mfma_f32_16x16x32_bf16 v[16:19], a[200:203], v[88:91], v[16:19]
    v_exp_f32_e64 v53, v53
    v_mfma_f32_16x16x32_bf16 v[16:19], a[204:207], v[92:95], v[16:19]
    v_exp_f32_e64 v54, v54
    v_mfma_f32_16x16x32_bf16 v[16:19], a[208:211], v[96:99], v[16:19]
    v_exp_f32_e64 v55, v55
    v_mfma_f32_16x16x32_bf16 v[16:19], a[212:215], v[100:103], v[16:19]
    v_add_f32 v52, 1.0, v52
    v_add_f32 v53, 1.0, v53
    v_mfma_f32_16x16x32_bf16 v[16:19], a[216:219], v[104:107], v[16:19]
    ds_read_b32 v14, v15
    v_add_u32_e64 v4, s61, v1
    v_mfma_f32_16x16x32_bf16 v[16:19], a[220:223], v[108:111], v[16:19]
    v_add_f32 v54, 1.0, v54
    v_add_f32 v55, 1.0, v55
    v_mfma_f32_16x16x32_bf16 v[16:19], a[224:227], v[112:115], v[16:19]
    buffer_load_dwordx4 v1, s[28:31], s59 offen offset:1024 sc1 lds
    v_mfma_f32_16x16x32_bf16 v[16:19], a[228:231], v[116:119], v[16:19]
    v_rcp_f32_e64 v52, v52
    v_mfma_f32_16x16x32_bf16 v[16:19], a[232:235], v[120:123], v[16:19]
    v_rcp_f32_e64 v53, v53
    v_mfma_f32_16x16x32_bf16 v[16:19], a[236:239], v[124:127], v[16:19]
    s_waitcnt lgkmcnt(0)
    v_cmp_gt_u32 vcc, s69, v14
    v_rcp_f32 v54, v54
    v_rcp_f32 v55, v55
    v_cvt_pk_bf16_f32 v40, v48, v49
    v_dot2_f32_bf16 v10, v38, v38, v10
    v_dot2_f32_bf16 v10, v39, v39, v10
    v_cvt_pk_bf16_f32 v41, v50, v51
    v_pk_mul_f32 v[52:53], v[28:29], v[52:53]
    v_pk_mul_f32 v[54:55], v[30:31], v[54:55]
    v_pk_fma_f32 v[48:49], v[16:17], v[16:17], s[52:53] op_sel_hi:[1,1,0]
    v_pk_fma_f32 v[50:51], v[18:19], v[18:19], s[52:53] op_sel_hi:[1,1,0]
    v_pk_mul_f32 v[48:49], v[16:17], v[48:49] neg_lo:[1,0] neg_hi:[1,0]
    v_pk_mul_f32 v[50:51], v[18:19], v[50:51] neg_lo:[1,0] neg_hi:[1,0]
    v_mfma_f32_16x16x32_bf16 v[20:23], v[156:159], v[124:127], 0
    s_cbranch_vccnz L1_lz
L1_lzb:
    v_exp_f32 v48, v48
    v_mfma_f32_16x16x32_bf16 v[20:23], v[152:155], v[120:123], v[20:23]
    v_exp_f32_e64 v49, v49
    v_mfma_f32_16x16x32_bf16 v[20:23], v[148:151], v[116:119], v[20:23]
    ds_read_b128 v[56:59], v4 offset:0
    ds_read_b128 v[60:63], v4 offset:1024
    v_mfma_f32_16x16x32_bf16 v[20:23], v[144:147], v[112:115], v[20:23]
    v_exp_f32_e64 v50, v50
    v_mfma_f32_16x16x32_bf16 v[20:23], v[140:143], v[108:111], v[20:23]
    ds_read_b128 v[64:67], v4 offset:2048
    ds_read_b128 v[68:71], v4 offset:3072
    v_mfma_f32_16x16x32_bf16 v[20:23], v[136:139], v[104:107], v[20:23]
    v_exp_f32_e64 v51, v51
    v_mfma_f32_16x16x32_bf16 v[20:23], v[132:135], v[100:103], v[20:23]
    v_add_f32 v48, 1.0, v48
    v_add_f32 v49, 1.0, v49
    v_mfma_f32_16x16x32_bf16 v[20:23], v[128:131], v[96:99], v[20:23]
    v_add_f32 v50, 1.0, v50
    v_add_f32 v51, 1.0, v51
    v_mfma_f32_16x16x32_bf16 v[20:23], a[252:255], v[92:95], v[20:23]
    buffer_load_dwordx4 v1, s[28:31], s59 offen offset:2048 sc1 lds
    v_mfma_f32_16x16x32_bf16 v[20:23], a[248:251], v[88:91], v[20:23]
    v_rcp_f32_e64 v48, v48
    v_mfma_f32_16x16x32_bf16 v[20:23], a[244:247], v[84:87], v[20:23]
    v_rcp_f32_e64 v49, v49
    v_mfma_f32_16x16x32_bf16 v[20:23], a[240:243], v[80:83], v[20:23]
    s_sub_u32 s62, s62, 1
    v_rcp_f32 v50, v50
    v_rcp_f32_e64 v51, v51
    v_cvt_pk_bf16_f32 v46, v52, v53
    v_dot2_f32_bf16 v10, v40, v40, v10
    v_dot2_f32_bf16 v10, v41, v41, v10
    v_cvt_pk_bf16_f32 v47, v54, v55
    v_pk_mul_f32 v[48:49], v[16:17], v[48:49]
    v_pk_mul_f32 v[50:51], v[18:19], v[50:51]
    v_pk_fma_f32 v[52:53], v[20:21], v[20:21], s[52:53] op_sel_hi:[1,1,0]
    v_pk_fma_f32 v[54:55], v[22:23], v[22:23], s[52:53] op_sel_hi:[1,1,0]
    v_pk_mul_f32 v[52:53], v[20:21], v[52:53] neg_lo:[1,0] neg_hi:[1,0]
    v_pk_mul_f32 v[54:55], v[22:23], v[54:55] neg_lo:[1,0] neg_hi:[1,0]
    v_mfma_f32_16x16x32_bf16 v[24:27], v[160:163], v[80:83], 0
    v_exp_f32_e64 v52, v52
    v_mfma_f32_16x16x32_bf16 v[24:27], v[164:167], v[84:87], v[24:27]
    v_exp_f32_e64 v53, v53
    v_mfma_f32_16x16x32_bf16 v[24:27], v[168:171], v[88:91], v[24:27]
    v_exp_f32_e64 v54, v54
    v_mfma_f32_16x16x32_bf16 v[24:27], v[172:175], v[92:95], v[24:27]
    v_exp_f32_e64 v55, v55
    v_mfma_f32_16x16x32_bf16 v[24:27], v[176:179], v[96:99], v[24:27]
    ds_read_b128 v[72:75], v4 offset:4096
    ds_read_b128 v[76:79], v4 offset:5120
    v_mfma_f32_16x16x32_bf16 v[24:27], v[180:183], v[100:103], v[24:27]
    v_add_f32 v52, 1.0, v52
    v_add_f32 v53, 1.0, v53
    v_mfma_f32_16x16x32_bf16 v[24:27], v[184:187], v[104:107], v[24:27]
    v_add_f32 v54, 1.0, v54
    v_add_f32 v55, 1.0, v55
    v_mfma_f32_16x16x32_bf16 v[24:27], v[188:191], v[108:111], v[24:27]
    v_rcp_f32_e64 v52, v52
    v_mfma_f32_16x16x32_bf16 v[24:27], v[192:195], v[112:115], v[24:27]
    buffer_load_dwordx4 v1, s[28:31], s59 offen offset:3072 sc1 lds
    v_mfma_f32_16x16x32_bf16 v[24:27], v[196:199], v[116:119], v[24:27]
    v_rcp_f32_e64 v53, v53
    v_mfma_f32_16x16x32_bf16 v[24:27], v[200:203], v[120:123], v[24:27]
    v_rcp_f32_e64 v54, v54
    v_mfma_f32_16x16x32_bf16 v[24:27], v[204:207], v[124:127], v[24:27]
    s_cmp_gt_u32 s62, 2
    s_nop 1
    v_rcp_f32_e64 v55, v55
    v_cvt_pk_bf16_f32 v34, v48, v49
    v_cvt_pk_bf16_f32 v35, v50, v51
    v_pk_mul_f32 v[52:53], v[20:21], v[52:53]
    v_pk_mul_f32 v[54:55], v[22:23], v[54:55]
    v_pk_fma_f32 v[48:49], v[24:25], v[24:25], s[52:53] op_sel_hi:[1,1,0]
    v_pk_fma_f32 v[50:51], v[26:27], v[26:27], s[52:53] op_sel_hi:[1,1,0]
    v_pk_mul_f32 v[48:49], v[24:25], v[48:49] neg_lo:[1,0] neg_hi:[1,0]
    v_pk_mul_f32 v[50:51], v[26:27], v[50:51] neg_lo:[1,0] neg_hi:[1,0]
    v_dot2_f32_bf16 v10, v46, v46, v10
    v_dot2_f32_bf16 v10, v47, v47, v10
    v_mfma_f32_16x16x32_bf16 v[28:31], v[252:255], v[124:127], 0
    v_exp_f32_e64 v48, v48
    v_mfma_f32_16x16x32_bf16 v[28:31], v[248:251], v[120:123], v[28:31]
    v_exp_f32_e64 v49, v49
    v_mfma_f32_16x16x32_bf16 v[28:31], v[244:247], v[116:119], v[28:31]
    ds_read_b128 v[120:123], v4 offset:10240
    ds_read_b128 v[124:127], v4 offset:11264
    v_mfma_f32_16x16x32_bf16 v[28:31], v[240:243], v[112:115], v[28:31]
    v_exp_f32_e64 v50, v50
    v_mfma_f32_16x16x32_bf16 v[28:31], v[236:239], v[108:111], v[28:31]
    ds_read_b128 v[112:115], v4 offset:8192
    ds_read_b128 v[116:119], v4 offset:9216
    v_mfma_f32_16x16x32_bf16 v[28:31], v[232:235], v[104:107], v[28:31]
    v_exp_f32_e64 v51, v51
    v_mfma_f32_16x16x32_bf16 v[28:31], v[228:231], v[100:103], v[28:31]
    ds_read_b128 v[104:107], v4 offset:6144
    ds_read_b128 v[108:111], v4 offset:7168
    v_mfma_f32_16x16x32_bf16 v[28:31], v[224:227], v[96:99], v[28:31]
    v_add_f32 v48, 1.0, v48
    v_add_f32 v49, 1.0, v49
    v_mfma_f32_16x16x32_bf16 v[28:31], v[220:223], v[92:95], v[28:31]
    v_add_f32 v50, 1.0, v50
    v_add_f32 v51, 1.0, v51
    v_mfma_f32_16x16x32_bf16 v[28:31], v[216:219], v[88:91], v[28:31]
    v_rcp_f32_e64 v48, v48
    v_mfma_f32_16x16x32_bf16 v[28:31], v[212:215], v[84:87], v[28:31]
    v_rcp_f32_e64 v49, v49
    v_mfma_f32_16x16x32_bf16 v[28:31], v[208:211], v[80:83], v[28:31]
    s_waitcnt lgkmcnt(0)
    buffer_store_dwordx4 v[32:35], v2, s[32:35], s57 offen offset:0 sc1
    v_rcp_f32 v50, v50
    v_rcp_f32_e64 v51, v51
    v_cvt_pk_bf16_f32 v36, v52, v53
    v_dot2_f32_bf16 v11, v34, v34, 0
    v_dot2_f32_bf16 v11, v35, v35, v11
    v_cvt_pk_bf16_f32 v37, v54, v55
    v_pk_mul_f32 v[48:49], v[24:25], v[48:49]
    v_pk_mul_f32 v[50:51], v[26:27], v[50:51]
    v_pk_fma_f32 v[52:53], v[28:29], v[28:29], s[52:53] op_sel_hi:[1,1,0]
    v_pk_fma_f32 v[54:55], v[30:31], v[30:31], s[52:53] op_sel_hi:[1,1,0]
    v_pk_mul_f32 v[52:53], v[28:29], v[52:53] neg_lo:[1,0] neg_hi:[1,0]
    v_pk_mul_f32 v[54:55], v[30:31], v[54:55] neg_lo:[1,0] neg_hi:[1,0]
    s_cbranch_scc1 L1_loop
    s_cmp_eq_u32 s62, 0
    s_cbranch_scc1 L1_done
    s_cmp_eq_u32 s62, 1
    s_cbranch_scc1 L1_last
    s_getpc_b64 s[22:23]
Lpc_a:
    v_lshlrev_b32 v6, 7, v0
    v_mov_b32 v7, s23
    v_min_u32 v6, L_end-Lpc_a, v6
    v_add_co_u32 v6, vcc, s22, v6
    s_nop 1
    v_addc_co_u32_e64 v7, vcc, 0, v7, vcc
    global_load_dword v6, v[6:7], off
    s_mov_b64 s[28:29], s[32:33]
    s_mov_b32 s30, 0x0d320000
    s_mul_i32 s68, s74, 24576
    s_mov_b32 s66, s64
    s_mov_b32 s60, 0
    s_lshl_b32 s71, s3, 12
    s_mov_b32 s6, 16384
    s_mov_b32 s7, 16384
    s_branch L1_loop
L1_last:
    s_lshl_b32 s22, s3, 10
    s_add_u32 m0, s22, 147456
    s_add_u32 s23, s22, 12288
    buffer_load_dwordx4 v1, s[36:39], s23 offen sc1 lds
    s_mul_i32 s68, s74, 147456
    s_add_u32 s68, s68, 220200960
    s_mul_i32 s66, s3, 12288
    s_mov_b32 s60, 49152
    s_mov_b32 s71, s66
    s_mov_b32 s6, 4096
    s_mov_b32 s7, 4096
    s_branch L1_loop
L1_done:
    v_exp_f32 v52, v52
    v_exp_f32 v53, v53
    v_exp_f32 v54, v54
    v_exp_f32 v55, v55
    v_add_f32 v52, 1.0, v52
    v_add_f32 v53, 1.0, v53
    v_add_f32 v54, 1.0, v54
    v_add_f32 v55, 1.0, v55
    v_rcp_f32 v52, v52
    v_rcp_f32 v53, v53
    v_rcp_f32 v54, v54
    v_rcp_f32 v55, v55
    v_cvt_pk_bf16_f32 v42, v48, v49
    v_cvt_pk_bf16_f32 v43, v50, v51
    v_dot2_f32_bf16 v11, v36, v36, v11
    v_dot2_f32_bf16 v11, v37, v37, v11
    v_dot2_f32_bf16 v11, v42, v42, v11
    v_dot2_f32_bf16 v11, v43, v43, v11
    v_pk_mul_f32 v[52:53], v[28:29], v[52:53]
    v_pk_mul_f32 v[54:55], v[30:31], v[54:55]
    v_cvt_pk_bf16_f32 v44, v52, v53
    v_cvt_pk_bf16_f32 v45, v54, v55
    v_dot2_f32_bf16 v11, v44, v44, v11
    v_dot2_f32_bf16 v11, v45, v45, v11
    s_nop 2
    v_permlane32_swap_b32 v8, v10
    v_permlane32_swap_b32 v9, v11
    v_add_f32 v12, v8, v10
    v_add_f32 v13, v9, v11
    s_nop 1
    v_permlane16_swap_b32 v12, v13
    s_nop 0
    v_add_f32_e64 v13, v12, v13
    buffer_atomic_add_f32 v13, v3, s[36:39], s58 offen
    buffer_store_dwordx4 v[36:39], v2, s[32:35], s57 offen offset:1024 sc1
    buffer_store_dwordx4 v[40:43], v2, s[32:35], s57 offen offset:2048 sc1
    buffer_store_dwordx4 v[44:47], v2, s[32:35], s57 offen offset:3072 sc1
    v_and_b32_e64 v10, 15, v0
    v_bfe_u32 v11, v0, 4, 2
    v_lshrrev_b32 v12, 2, v10
    v_cmp_eq_u32 vcc, v12, v11
    v_and_b32 v13, 1, v10
    v_lshlrev_b32 v13, 4, v13
    v_mov_b32 v12, 0x3f80
    v_lshlrev_b32 v13, v13, v12
    v_cndmask_b32 v13, 0, v13, vcc
    v_and_b32 v12, 2, v10
    v_cmp_eq_u32 vcc, 0, v12
    s_nop 1
    v_cndmask_b32 v126, 0, v13, vcc
    v_sub_u32 v127, v13, v126
    v_mov_b32 v30, v10
    v_mov_b32 v31, v11
    s_lshl_b32 s71, s3, 12
    v_mfma_f32_16x16x16_bf16 v[128:131], v[126:127], a[0:1], 0
    v_accvgpr_read_b32 v120, a188
    v_accvgpr_read_b32 v121, a189
    v_mfma_f32_16x16x16_bf16 v[132:135], v[126:127], a[2:3], 0
    v_accvgpr_read_b32 v122, a190
    v_accvgpr_read_b32 v123, a191
    v_mfma_f32_16x16x16_bf16 v[136:139], v[126:127], a[48:49], 0
    v_and_b32 v12, 1, v31
    v_lshlrev_b32 v12, 3, v12
    v_mfma_f32_16x16x16_bf16 v[140:143], v[126:127], a[50:51], 0
    v_and_b32_e64 v13, 3, v30
    v_mfma_f32_16x16x16_bf16 v[144:147], v[126:127], a[96:97], 0
    v_lshl_add_u32 v12, v13, 8, v12
    v_xor_b32_e64 v13, v13, v31
    v_mfma_f32_16x16x16_bf16 v[148:151], v[126:127], a[98:99], 0
    v_lshl_add_u32 v12, v13, 6, v12
    v_lshrrev_b32_e64 v13, 2, v30
    v_mfma_f32_16x16x16_bf16 v[152:155], v[126:127], a[144:145], 0
    v_lshl_add_u32 v12, v13, 4, v12
    v_add_u32_e64 v3, s71, v12
    v_mfma_f32_16x16x16_bf16 v[156:159], v[126:127], a[146:147], 0
    v_xor_b32_e64 v4, 8, v3
    v_mfma_f32_16x16x16_bf16 v[160:163], v[126:127], a[4:5], 0
    v_lshlrev_b32 v24, 3, v13
    v_and_b32 v12, 3, v30
    v_mfma_f32_16x16x16_bf16 v[164:167], v[126:127], a[6:7], 0
    v_add_u32 v24, v24, v12
    v_and_b32 v12, 1, v31
    v_mfma_f32_16x16x16_bf16 v[168:171], v[126:127], a[52:53], 0
    v_lshl_add_u32 v24, v12, 2, v24
    v_lshrrev_b32_e64 v12, 1, v31
    v_mfma_f32_16x16x16_bf16 v[172:175], v[126:127], a[54:55], 0
    v_lshl_add_u32 v24, v12, 5, v24
    v_mfma_f32_16x16x16_bf16 v[176:179], v[126:127], a[100:101], 0
    v_lshlrev_b32_e64 v24, 2, v24
    v_add_u32 v24, 147456, v24
    v_mfma_f32_16x16x16_bf16 v[180:183], v[126:127], a[102:103], 0
    v_lshlrev_b32_e64 v26, 2, v0
    v_add_u32 v26, 160768, v26
    v_mfma_f32_16x16x16_bf16 v[184:187], v[126:127], a[148:149], 0
    ds_read_b64_tr_b16 v[8:9], v3 offset:0
    ds_read_b64_tr_b16 v[10:11], v4 offset:0
    v_mfma_f32_16x16x16_bf16 v[188:191], v[126:127], a[150:151], 0
    ds_read_b64_tr_b16 v[12:13], v4 offset:1024
    v_mfma_f32_16x16x16_bf16 v[192:195], v[126:127], a[8:9], 0
    ds_read_b64_tr_b16 v[14:15], v3 offset:1024
    ds_read_b64_tr_b16 v[16:17], v3 offset:2048
    v_mfma_f32_16x16x16_bf16 v[196:199], v[126:127], a[10:11], 0
    ds_read_b64_tr_b16 v[18:19], v4 offset:2048
    ds_read_b64_tr_b16 v[20:21], v4 offset:3072
    v_mfma_f32_16x16x16_bf16 v[200:203], v[126:127], a[56:57], 0
    ds_read_b64_tr_b16 v[22:23], v3 offset:3072
    ds_read2st64_b32 v[96:97], v24 offset0:0 offset1:8
    v_mfma_f32_16x16x16_bf16 v[204:207], v[126:127], a[58:59], 0
    ds_read2st64_b32 v[98:99], v24 offset0:1 offset1:9
    v_mfma_f32_16x16x16_bf16 v[208:211], v[126:127], a[104:105], 0
    ds_read2st64_b32 v[100:101], v24 offset0:2 offset1:10
    ds_read2st64_b32 v[102:103], v24 offset0:3 offset1:11
    v_mfma_f32_16x16x16_bf16 v[212:215], v[126:127], a[106:107], 0
    ds_read2st64_b32 v[104:105], v24 offset0:4 offset1:12
    ds_read2st64_b32 v[106:107], v24 offset0:5 offset1:13
    v_mfma_f32_16x16x16_bf16 v[216:219], v[126:127], a[152:153], 0
    s_cmp_eq_u32 s3, 0
    s_cselect_b32 s42, 36, 0
    v_mfma_f32_16x16x16_bf16 v[220:223], v[126:127], a[154:155], 0
    v_mov_b32_e64 v124, 1
    v_mfma_f32_16x16x16_bf16 v[224:227], v[126:127], a[12:13], 0
    v_mov_b32_e64 v125, 1
    s_mul_hi_u32 s23, s72, 0x15555556
    v_mfma_f32_16x16x16_bf16 v[228:231], v[126:127], a[14:15], 0
    s_mul_i32 s22, s23, 12
    s_sub_u32 s69, s72, s22
    v_mfma_f32_16x16x16_bf16 v[232:235], v[126:127], a[60:61], 0
    s_lshl_b32 s69, s69, 12
    s_lshr_b32 s22, s23, 1
    v_mfma_f32_16x16x16_bf16 v[236:239], v[126:127], a[62:63], 0
    s_mul_i32 s22, s22, 49152
    v_mfma_f32_16x16x16_bf16 v[240:243], v[126:127], a[108:109], 0
    s_add_u32 s69, s69, s22
    s_and_b32 s22, s23, 1
    v_mfma_f32_16x16x16_bf16 v[244:247], v[126:127], a[110:111], 0
    s_lshl_b32 s22, s22, 10
    s_add_u32 s69, s69, s22
    v_mfma_f32_16x16x16_bf16 v[248:251], v[126:127], a[156:157], 0
    s_lshl_b32 s58, s23, 7
    s_mul_i32 s22, s23, 12
    v_mfma_f32_16x16x16_bf16 v[252:255], v[126:127], a[158:159], 0
    s_sub_u32 s63, s72, s22
    v_mfma_f32_16x16x16_bf16 a[192:195], v[126:127], a[16:17], 0
    s_mul_i32 s63, s63, 6144
    s_mul_i32 s22, s23, 86
    v_mfma_f32_16x16x16_bf16 a[196:199], v[126:127], a[18:19], 0
    s_lshr_b32 s22, s22, 8
    s_mul_i32 s22, s22, 70656
    v_mfma_f32_16x16x16_bf16 a[200:203], v[126:127], a[64:65], 0
    s_lshl_b32 s23, s23, 10
    s_add_u32 s63, s63, s22
    v_mfma_f32_16x16x16_bf16 a[204:207], v[126:127], a[66:67], 0
    s_add_u32 s63, s63, s23
    v_mfma_f32_16x16x16_bf16 a[208:211], v[126:127], a[112:113], 0
    s_add_u32 s75, s64, 196608
    s_mul_i32 s56, s74, 24576
    v_mfma_f32_16x16x16_bf16 a[212:215], v[126:127], a[114:115], 0
    s_add_u32 s56, s56, s64
    s_add_u32 s56, s56, 12288
    v_mfma_f32_16x16x16_bf16 a[216:219], v[126:127], a[160:161], 0
    s_add_u32 s28, s20, 0x0d200000
    s_addc_u32 s29, s21, 0
    v_mfma_f32_16x16x16_bf16 a[220:223], v[126:127], a[162:163], 0
    s_and_b32 s29, s29, 0xffff
    v_mfma_f32_16x16x16_bf16 a[224:227], v[126:127], a[20:21], 0
    s_mov_b32 s30, 0x00120000
    s_mov_b32 s31, 0x20000
    v_mfma_f32_16x16x16_bf16 a[228:231], v[126:127], a[22:23], 0
    s_add_u32 m0, s71, 0
    s_waitcnt lgkmcnt(6)
    v_mfma_f32_16x16x16_bf16 a[232:235], v[126:127], a[68:69], 0
    ds_read_b32 v25, v26 offset:0
    ds_read_b32 v27, v26 offset:1024
    v_mfma_f32_16x16x16_bf16 a[236:239], v[126:127], a[70:71], 0
    ds_read_b32 v29, v26 offset:2048
    s_waitcnt vmcnt(3)
    s_barrier
    buffer_atomic_add v124, v1, s[40:43], 0 offen offset:32 sc0 sc1
    v_mfma_f32_16x16x16_bf16 a[240:243], v[126:127], a[116:117], 0
    buffer_load_dwordx4 v1, s[32:35], s56 offen offset:0 lds
    v_lshlrev_b32 v32, 16, v8
    v_mfma_f32_16x16x16_bf16 a[244:247], v[126:127], a[118:119], 0
    v_and_b32_e64 v33, s54, v8
    v_mfma_f32_16x16x16_bf16 a[248:251], v[126:127], a[164:165], 0
    v_lshlrev_b32_e64 v34, 16, v9
    v_mfma_f32_16x16x16_bf16 a[252:255], v[126:127], a[166:167], 0
    v_and_b32_e64 v35, s54, v9
    v_mfma_f32_16x16x16_bf16 a[188:191], v[126:127], a[24:25], 0
    v_lshlrev_b32_e64 v36, 16, v10
    v_mfma_f32_16x16x16_bf16 a[0:3], v[126:127], a[26:27], 0
    v_and_b32_e64 v37, s54, v10
    v_mfma_f32_16x16x16_bf16 a[48:51], v[126:127], a[72:73], 0
    v_lshlrev_b32_e64 v38, 16, v11
    v_mfma_f32_16x16x16_bf16 a[96:99], v[126:127], a[74:75], 0
    v_and_b32_e64 v39, s54, v11
    buffer_load_dwordx4 v1, s[32:35], s56 offen offset:1024 lds
    v_mfma_f32_16x16x16_bf16 a[144:147], v[126:127], a[120:121], 0
    v_lshlrev_b32_e64 v40, 16, v12
    v_mfma_f32_16x16x16_bf16 a[4:7], v[126:127], a[122:123], 0
    v_and_b32_e64 v41, s54, v12
    v_mfma_f32_16x16x16_bf16 a[52:55], v[126:127], a[168:169], 0
    v_lshlrev_b32_e64 v42, 16, v13
    v_mfma_f32_16x16x16_bf16 a[100:103], v[126:127], a[170:171], 0
    v_and_b32_e64 v43, s54, v13
    v_mfma_f32_16x16x16_bf16 a[148:151], v[126:127], a[28:29], 0
    v_lshlrev_b32_e64 v44, 16, v14
    v_mfma_f32_16x16x16_bf16 a[8:11], v[126:127], a[30:31], 0
    v_and_b32_e64 v45, s54, v14
    v_mfma_f32_16x16x16_bf16 a[56:59], v[126:127], a[76:77], 0
    v_lshlrev_b32 v46, 16, v15
    v_and_b32 v47, s54, v15
    v_mfma_f32_16x16x16_bf16 a[104:107], v[126:127], a[78:79], 0
    buffer_load_dwordx4 v1, s[32:35], s56 offen offset:2048 lds
    v_mfma_f32_16x16x16_bf16 a[152:155], v[126:127], a[124:125], 0
    v_lshlrev_b32_e64 v48, 16, v16
    v_mfma_f32_16x16x16_bf16 a[12:15], v[126:127], a[126:127], 0
    v_and_b32_e64 v49, s54, v16
    v_mfma_f32_16x16x16_bf16 a[60:63], v[126:127], a[172:173], 0
    v_lshlrev_b32_e64 v50, 16, v17
    v_mfma_f32_16x16x16_bf16 a[108:111], v[126:127], a[174:175], 0
    v_and_b32_e64 v51, s54, v17
    v_mfma_f32_16x16x16_bf16 a[156:159], v[126:127], a[32:33], 0
    v_lshlrev_b32_e64 v52, 16, v18
    v_mfma_f32_16x16x16_bf16 a[16:19], v[126:127], a[34:35], 0
    v_and_b32_e64 v53, s54, v18
    v_mfma_f32_16x16x16_bf16 a[64:67], v[126:127], a[80:81], 0
    v_lshlrev_b32 v54, 16, v19
    v_and_b32 v55, s54, v19
    v_mfma_f32_16x16x16_bf16 a[112:115], v[126:127], a[82:83], 0
    buffer_load_dwordx4 v1, s[32:35], s56 offen offset:3072 lds
    v_mfma_f32_16x16x16_bf16 a[160:163], v[126:127], a[128:129], 0
    v_lshlrev_b32_e64 v56, 16, v20
    v_mfma_f32_16x16x16_bf16 a[20:23], v[126:127], a[130:131], 0
    v_and_b32_e64 v57, s54, v20
    v_mfma_f32_16x16x16_bf16 a[68:71], v[126:127], a[176:177], 0
    v_lshlrev_b32_e64 v58, 16, v21
    v_mfma_f32_16x16x16_bf16 a[116:119], v[126:127], a[178:179], 0
    v_and_b32_e64 v59, s54, v21
    v_mfma_f32_16x16x16_bf16 a[164:167], v[126:127], a[36:37], 0
    v_lshlrev_b32_e64 v60, 16, v22
    v_mfma_f32_16x16x16_bf16 a[24:27], v[126:127], a[38:39], 0
    v_and_b32 v61, s54, v22
    v_lshlrev_b32 v62, 16, v23
    v_mfma_f32_16x16x16_bf16 a[72:75], v[126:127], a[84:85], 0
    v_and_b32_e64 v63, s54, v23
    v_mfma_f32_16x16x16_bf16 a[120:123], v[126:127], a[86:87], 0
    s_add_u32 s56, s56, 4096
    v_mfma_f32_16x16x16_bf16 a[168:171], v[126:127], a[132:133], 0
    ds_read_b64_tr_b16 v[8:9], v3 offset:16384
    v_mfma_f32_16x16x16_bf16 a[28:31], v[126:127], a[134:135], 0
    ds_read_b64_tr_b16 v[10:11], v4 offset:16384
    v_mfma_f32_16x16x16_bf16 a[76:79], v[126:127], a[180:181], 0
    ds_read_b64_tr_b16 v[12:13], v4 offset:17408
    v_mfma_f32_16x16x16_bf16 a[124:127], v[126:127], a[182:183], 0
    ds_read_b64_tr_b16 v[14:15], v3 offset:17408
    v_mfma_f32_16x16x16_bf16 a[172:175], v[126:127], a[40:41], 0
    ds_read_b64_tr_b16 v[16:17], v3 offset:18432
    ds_read_b64_tr_b16 v[18:19], v4 offset:18432
    v_mfma_f32_16x16x16_bf16 a[32:35], v[126:127], a[42:43], 0
    ds_read_b64_tr_b16 v[20:21], v4 offset:19456
    v_mfma_f32_16x16x16_bf16 a[80:83], v[126:127], a[88:89], 0
    ds_read_b64_tr_b16 v[22:23], v3 offset:19456
    v_mfma_f32_16x16x16_bf16 a[128:131], v[126:127], a[90:91], 0
    buffer_load_dwordx4 v[112:115], v1, s[28:31], s69 offen offset:0 sc1
    v_mfma_f32_16x16x16_bf16 a[176:179], v[126:127], a[136:137], 0
    buffer_load_dwordx4 v[116:119], v1, s[28:31], s69 offen offset:2048 sc1
    v_mfma_f32_16x16x16_bf16 a[36:39], v[126:127], a[138:139], 0
    s_waitcnt lgkmcnt(8)
    v_mfma_f32_16x16x16_bf16 a[84:87], v[126:127], a[184:185], 0
    v_add_f32 v96, v96, v97
    v_mfma_f32_16x16x16_bf16 a[132:135], v[126:127], a[186:187], 0
    v_add_f32 v98, v98, v99
    s_waitcnt vmcnt(6)
    v_readfirstlane_b32 s23, v124
    s_mov_b32 s5, 0x07060302
    s_mov_b32 s4, s23
    s_cmp_eq_u32 s23, 255
    s_cselect_b32 s42, 256, 0
    s_cselect_b32 s23, 1, 0
    buffer_store_dword v125, off, s[40:43], 0 offset:128 sc1
    v_mov_b32 v124, s23
    s_mov_b32 s42, 256
    v_mfma_f32_16x16x16_bf16 a[180:183], v[126:127], a[44:45], 0
    v_add_f32 v100, v100, v101
    v_add_f32 v102, v102, v103
    v_mfma_f32_16x16x16_bf16 a[40:43], v[126:127], a[46:47], 0
    v_add_f32_e64 v104, v104, v105
    v_mfma_f32_16x16x16_bf16 a[88:91], v[126:127], a[92:93], 0
    v_add_f32_e64 v106, v106, v107
    v_mfma_f32_16x16x16_bf16 a[136:139], v[126:127], a[94:95], 0
    v_lshlrev_b32_e64 v24, 16, v25
    v_mfma_f32_16x16x16_bf16 a[184:187], v[126:127], a[140:141], 0
    v_and_b32 v25, s54, v25
    v_lshlrev_b32 v26, 16, v27
    v_mfma_f32_16x16x16_bf16 a[44:47], v[126:127], a[142:143], 0
    v_and_b32_e64 v27, s54, v27
    v_mfma_f32_16x16x16_bf16 a[92:95], v[126:127], v[120:121], 0
    v_lshlrev_b32_e64 v28, 16, v29
    v_mfma_f32_16x16x16_bf16 a[140:143], v[126:127], v[122:123], 0
    v_and_b32 v29, s54, v29
    v_and_b32 v120, s54, v96
    v_sub_f32 v121, v96, v120
    v_and_b32 v120, s54, v121
    v_sub_f32_e64 v120, v121, v120
    v_perm_b32 v96, v121, v96, s5
    v_lshrrev_b32 v97, 16, v120
    v_and_b32 v120, s54, v98
    v_sub_f32 v121, v98, v120
    v_and_b32 v120, s54, v121
    v_sub_f32_e64 v120, v121, v120
    v_perm_b32 v98, v121, v98, s5
    v_lshrrev_b32 v99, 16, v120
    v_and_b32 v120, s54, v100
    v_sub_f32 v121, v100, v120
    v_and_b32 v120, s54, v121
    v_sub_f32_e64 v120, v121, v120
    v_perm_b32 v100, v121, v100, s5
    v_lshrrev_b32 v101, 16, v120
    v_and_b32 v120, s54, v102
    v_sub_f32 v121, v102, v120
    v_and_b32 v120, s54, v121
    v_sub_f32_e64 v120, v121, v120
    v_perm_b32 v102, v121, v102, s5
    v_lshrrev_b32 v103, 16, v120
    v_and_b32 v120, s54, v104
    v_sub_f32 v121, v104, v120
    v_and_b32 v120, s54, v121
    v_sub_f32_e64 v120, v121, v120
    v_perm_b32 v104, v121, v104, s5
    v_lshrrev_b32 v105, 16, v120
    v_and_b32 v120, s54, v106
    v_sub_f32 v121, v106, v120
    v_and_b32 v120, s54, v121
    v_sub_f32_e64 v120, v121, v120
    v_perm_b32 v106, v121, v106, s5
    v_lshrrev_b32 v107, 16, v120
    s_waitcnt lgkmcnt(0)
    v_lshlrev_b32 v88, 16, v20
    v_and_b32 v89, s54, v20
    v_lshlrev_b32 v90, 16, v21
    v_and_b32 v91, s54, v21
    v_lshlrev_b32 v92, 16, v22
    v_and_b32 v93, s54, v22
    v_lshlrev_b32 v94, 16, v23
    v_and_b32 v95, s54, v23
    v_cmp_eq_u32_e64 vcc, 0, v31
    v_mov_b32 v20, 0x3f803f80
    s_nop 0
    v_cndmask_b32 v108, 0, v20, vcc
    v_cndmask_b32 v109, 0, v20, vcc
    v_cmp_eq_u32 vcc, 1, v31
    v_mov_b32 v20, 0x3f803f80
    s_nop 0
    v_cndmask_b32 v110, 0, v20, vcc
    v_cndmask_b32_e64 v111, 0, v20, vcc
    v_mfma_f32_16x16x16_bf16 v[128:131], v[96:97], v[108:109], v[128:131]
    s_mul_i32 s66, s3, 6144
    s_mul_i32 s59, s74, 147456
    v_mfma_f32_16x16x16_bf16 v[136:139], v[96:97], v[108:109], v[136:139]
    s_add_u32 s59, s59, s66
    v_mfma_f32_16x16x16_bf16 v[144:147], v[96:97], v[108:109], v[144:147]
    s_add_u32 s59, s59, 49152
    v_lshlrev_b32 v64, 16, v8
    v_mfma_f32_16x16x16_bf16 v[152:155], v[96:97], v[108:109], v[152:155]
    v_and_b32_e64 v65, s54, v8
    v_mfma_f32_16x16x16_bf16 v[192:195], v[98:99], v[108:109], v[192:195]
    v_lshlrev_b32 v66, 16, v9
    v_and_b32 v67, s54, v9
    v_mfma_f32_16x16x16_bf16 v[200:203], v[98:99], v[108:109], v[200:203]
    v_lshlrev_b32_e64 v68, 16, v10
    v_mfma_f32_16x16x16_bf16 v[208:211], v[98:99], v[108:109], v[208:211]
    v_and_b32 v69, s54, v10
    v_lshlrev_b32 v70, 16, v11
    v_mfma_f32_16x16x16_bf16 v[216:219], v[98:99], v[108:109], v[216:219]
    v_and_b32_e64 v71, s54, v11
    v_mfma_f32_16x16x16_bf16 a[192:195], v[100:101], v[108:109], a[192:195]
    v_lshlrev_b32 v72, 16, v12
    v_and_b32 v73, s54, v12
    v_mfma_f32_16x16x16_bf16 a[200:203], v[100:101], v[108:109], a[200:203]
    v_lshlrev_b32_e64 v74, 16, v13
    v_mfma_f32_16x16x16_bf16 a[208:211], v[100:101], v[108:109], a[208:211]
    v_and_b32 v75, s54, v13
    v_lshlrev_b32 v76, 16, v14
    v_mfma_f32_16x16x16_bf16 a[216:219], v[100:101], v[108:109], a[216:219]
    v_and_b32_e64 v77, s54, v14
    v_mfma_f32_16x16x16_bf16 a[188:191], v[102:103], v[108:109], a[188:191]
    v_lshlrev_b32 v78, 16, v15
    v_and_b32 v79, s54, v15
    v_mfma_f32_16x16x16_bf16 a[48:51], v[102:103], v[108:109], a[48:51]
    v_lshlrev_b32_e64 v80, 16, v16
    v_mfma_f32_16x16x16_bf16 a[144:147], v[102:103], v[108:109], a[144:147]
    v_and_b32 v81, s54, v16
    v_lshlrev_b32 v82, 16, v17
    v_mfma_f32_16x16x16_bf16 a[52:55], v[102:103], v[108:109], a[52:55]
    v_and_b32_e64 v83, s54, v17
    v_mfma_f32_16x16x16_bf16 a[156:159], v[104:105], v[108:109], a[156:159]
    v_lshlrev_b32 v84, 16, v18
    v_and_b32 v85, s54, v18
    v_mfma_f32_16x16x16_bf16 a[64:67], v[104:105], v[108:109], a[64:67]
    v_lshlrev_b32_e64 v86, 16, v19
    v_mfma_f32_16x16x16_bf16 a[160:163], v[104:105], v[108:109], a[160:163]
    v_and_b32_e64 v87, s54, v19
    s_add_u32 m0, s71, 16384
    v_mfma_f32_16x16x16_bf16 a[68:71], v[104:105], v[108:109], a[68:71]
    s_mul_i32 s69, s74, 768
    v_mfma_f32_16x16x16_bf16 a[172:175], v[106:107], v[108:109], a[172:175]
    v_lshlrev_b32_e64 v7, 5, v31
    v_add_u32 v7, 122880, v7
    v_mfma_f32_16x16x16_bf16 a[80:83], v[106:107], v[108:109], a[80:83]
    v_add_u32_e64 v6, s69, v7
    v_mfma_f32_16x16x16_bf16 a[176:179], v[106:107], v[108:109], a[176:179]
    v_add_u32 v2, 49152, v1
    v_add_u32 v5, 98304, v1
    v_mfma_f32_16x16x16_bf16 a[84:87], v[106:107], v[108:109], a[84:87]
    v_lshlrev_b32_e64 v30, 3, v0
    v_mfma_f32_16x16x16_bf16 v[132:135], v[96:97], v[110:111], v[132:135]
    v_cmp_eq_u32_e64 vcc, 2, v31
    v_mov_b32 v20, 0x3f803f80
    v_mfma_f32_16x16x16_bf16 v[140:143], v[96:97], v[110:111], v[140:143]
    s_nop 0
    v_mfma_f32_16x16x16_bf16 v[148:151], v[96:97], v[110:111], v[148:151]
    v_cndmask_b32 v108, 0, v20, vcc
    v_mfma_f32_16x16x16_bf16 v[156:159], v[96:97], v[110:111], v[156:159]
    v_cndmask_b32_e64 v109, 0, v20, vcc
    v_mfma_f32_16x16x16_bf16 v[196:199], v[98:99], v[110:111], v[196:199]
    s_mov_b32 s24, s16
    v_mfma_f32_16x16x16_bf16 v[204:207], v[98:99], v[110:111], v[204:207]
    s_and_b32 s25, s17, 0xffff
    v_mfma_f32_16x16x16_bf16 v[212:215], v[98:99], v[110:111], v[212:215]
    s_mov_b32 s26, 0x03000000
    v_mfma_f32_16x16x16_bf16 v[220:223], v[98:99], v[110:111], v[220:223]
    s_mov_b32 s27, 0x20000
    v_mfma_f32_16x16x16_bf16 a[196:199], v[100:101], v[110:111], a[196:199]
    s_add_u32 s44, s20, 0x0d400000
    v_mfma_f32_16x16x16_bf16 a[204:207], v[100:101], v[110:111], a[204:207]
    s_addc_u32 s45, s21, 0
    v_mfma_f32_16x16x16_bf16 a[212:215], v[100:101], v[110:111], a[212:215]
    s_and_b32 s45, s45, 0xffff
    v_mfma_f32_16x16x16_bf16 a[220:223], v[100:101], v[110:111], a[220:223]
    s_mov_b32 s46, 0x00120000
    v_mfma_f32_16x16x16_bf16 a[0:3], v[102:103], v[110:111], a[0:3]
    s_mov_b32 s47, 0x20000
    s_and_b32 s67, s2, 7
    v_mfma_f32_16x16x16_bf16 a[96:99], v[102:103], v[110:111], a[96:99]
    s_lshl_b32 s67, s67, 7
    v_mfma_f32_16x16x16_bf16 a[4:7], v[102:103], v[110:111], a[4:7]
    s_add_u32 s67, s67, 0x0d604000
    v_mfma_f32_16x16x16_bf16 a[100:103], v[102:103], v[110:111], a[100:103]
    s_add_u32 s48, s20, s67
    v_mfma_f32_16x16x16_bf16 a[16:19], v[104:105], v[110:111], a[16:19]
    s_addc_u32 s49, s21, 0
    v_mfma_f32_16x16x16_bf16 a[112:115], v[104:105], v[110:111], a[112:115]
    s_and_b32 s49, s49, 0xffff
    v_mfma_f32_16x16x16_bf16 a[20:23], v[104:105], v[110:111], a[20:23]
    s_mov_b32 s51, 0x20000
    v_mfma_f32_16x16x16_bf16 a[116:119], v[104:105], v[110:111], a[116:119]
    s_cmp_lt_u32 s76, 144
    v_mfma_f32_16x16x16_bf16 a[32:35], v[106:107], v[110:111], a[32:35]
    s_cselect_b32 s46, s46, 0
    v_mfma_f32_16x16x16_bf16 a[128:131], v[106:107], v[110:111], a[128:131]
    s_cselect_b32 s50, 4, 0
    v_mfma_f32_16x16x16_bf16 a[36:39], v[106:107], v[110:111], a[36:39]
    s_cmp_eq_u32 s3, 0
    v_mfma_f32_16x16x16_bf16 a[132:135], v[106:107], v[110:111], a[132:135]
    s_cselect_b32 s50, s50, 0
    s_cmp_lg_u32 s3, 0
    s_cbranch_scc1 Lw_b_ok2
    s_mov_b32 s22, 0x40000
Lw_b:
    v_readfirstlane_b32 s23, v124
    s_nop 1
    s_cmp_ge_u32 s23, 1
    s_cbranch_scc1 Lw_b_ok
    buffer_load_dword v124, off, s[40:43], 0 offset:128 sc1
    s_sub_u32 s22, s22, 1
    s_cmp_lg_u32 s22, 0
    s_waitcnt vmcnt(0)
    s_cbranch_scc1 Lw_b
Lw_b_ok:
Lw_b_ok2:
    s_barrier
    s_mov_b32 s67, 0
    buffer_load_dwordx2 v[8:9], v30, s[36:39], s67 offen sc1
    s_mov_b32 s67, 6144
    buffer_load_dwordx2 v[10:11], v30, s[36:39], s67 offen sc1
    s_mov_b32 s67, 2048
    buffer_load_dwordx2 v[12:13], v30, s[36:39], s67 offen sc1
    s_mov_b32 s67, 8192
    buffer_load_dwordx2 v[14:15], v30, s[36:39], s67 offen sc1
    s_mov_b32 s67, 4096
    buffer_load_dwordx2 v[16:17], v30, s[36:39], s67 offen sc1
    s_mov_b32 s67, 10240
    buffer_load_dwordx2 v[18:19], v30, s[36:39], s67 offen sc1
    v_mfma_f32_16x16x16_bf16 v[160:163], v[96:97], v[108:109], v[160:163]
    buffer_load_dwordx4 v1, s[32:35], s56 offen offset:0 lds
    v_cmp_eq_u32_e64 vcc, 3, v31
    v_mfma_f32_16x16x16_bf16 v[168:171], v[96:97], v[108:109], v[168:171]
    v_mov_b32 v20, 0x3f803f80
    v_mfma_f32_16x16x16_bf16 v[176:179], v[96:97], v[108:109], v[176:179]
    s_nop 0
    v_mfma_f32_16x16x16_bf16 v[184:187], v[96:97], v[108:109], v[184:187]
    v_cndmask_b32 v110, 0, v20, vcc
    v_mfma_f32_16x16x16_bf16 v[224:227], v[98:99], v[108:109], v[224:227]
    v_cndmask_b32_e64 v111, 0, v20, vcc
    v_mfma_f32_16x16x16_bf16 v[232:235], v[98:99], v[108:109], v[232:235]
    buffer_load_dwordx4 v1, s[32:35], s56 offen offset:1024 lds
    v_mfma_f32_16x16x16_bf16 v[240:243], v[98:99], v[108:109], v[240:243]
    s_mov_b32 s65, 0
    v_mfma_f32_16x16x16_bf16 v[248:251], v[98:99], v[108:109], v[248:251]
    s_mov_b32 s62, 6
    v_mfma_f32_16x16x16_bf16 a[224:227], v[100:101], v[108:109], a[224:227]
    s_mov_b32 s73, 21504
    v_mfma_f32_16x16x16_bf16 a[232:235], v[100:101], v[108:109], a[232:235]
    s_mov_b32 s60, 21504
    v_mfma_f32_16x16x16_bf16 a[240:243], v[100:101], v[108:109], a[240:243]
    v_lshrrev_b32_e64 v30, 4, v0
    v_mfma_f32_16x16x16_bf16 a[248:251], v[100:101], v[108:109], a[248:251]
    buffer_load_dwordx4 v1, s[32:35], s56 offen offset:2048 lds
    v_mfma_f32_16x16x16_bf16 a[148:151], v[102:103], v[108:109], a[148:151]
    v_lshlrev_b32_e64 v30, 7, v30
    v_mfma_f32_16x16x16_bf16 a[56:59], v[102:103], v[108:109], a[56:59]
    v_bfe_u32 v21, v0, 1, 2
    v_mfma_f32_16x16x16_bf16 a[152:155], v[102:103], v[108:109], a[152:155]
    v_lshl_add_u32 v30, v21, 5, v30
    v_mfma_f32_16x16x16_bf16 a[60:63], v[102:103], v[108:109], a[60:63]
    v_lshrrev_b32_e64 v22, 3, v0
    v_mfma_f32_16x16x16_bf16 a[164:167], v[104:105], v[108:109], a[164:167]
    v_xor_b32_e64 v22, v22, v21
    v_mfma_f32_16x16x16_bf16 a[72:75], v[104:105], v[108:109], a[72:75]
    buffer_load_dwordx4 v1, s[32:35], s56 offen offset:3072 lds
    v_mfma_f32_16x16x16_bf16 a[168:171], v[104:105], v[108:109], a[168:171]
    v_and_b32_e64 v22, 1, v22
    v_mfma_f32_16x16x16_bf16 a[76:79], v[104:105], v[108:109], a[76:79]
    v_lshl_add_u32 v30, v22, 4, v30
    v_mfma_f32_16x16x16_bf16 a[180:183], v[106:107], v[108:109], a[180:183]
    v_and_b32_e64 v22, 1, v0
    v_mfma_f32_16x16x16_bf16 a[88:91], v[106:107], v[108:109], a[88:91]
    v_lshl_add_u32 v30, v22, 3, v30
    v_mfma_f32_16x16x16_bf16 a[184:187], v[106:107], v[108:109], a[184:187]
    v_add_u32 v30, 122880, v30
    v_mfma_f32_16x16x16_bf16 a[92:95], v[106:107], v[108:109], a[92:95]
    s_add_u32 s56, s56, 4096
    v_mfma_f32_16x16x16_bf16 v[164:167], v[96:97], v[110:111], v[164:167]
    s_add_u32 m0, s66, 98304
    v_mfma_f32_16x16x16_bf16 v[172:175], v[96:97], v[110:111], v[172:175]
    v_mfma_f32_16x16x16_bf16 v[180:183], v[96:97], v[110:111], v[180:183]
    v_add_u32_e64 v124, s58, v7
    v_mfma_f32_16x16x16_bf16 v[188:191], v[96:97], v[110:111], v[188:191]
    v_mfma_f32_16x16x16_bf16 v[228:231], v[98:99], v[110:111], v[228:231]
    buffer_load_dwordx4 v1, s[28:31], s59 offen offset:0 sc1 lds
    v_mfma_f32_16x16x16_bf16 v[236:239], v[98:99], v[110:111], v[236:239]
    v_mfma_f32_16x16x16_bf16 v[244:247], v[98:99], v[110:111], v[244:247]
    s_mov_b32 s67, 0x4091afa4
    v_mfma_f32_16x16x16_bf16 v[252:255], v[98:99], v[110:111], v[252:255]
    v_mfma_f32_16x16x16_bf16 a[228:231], v[100:101], v[110:111], a[228:231]
    v_mov_b32 v20, 0x358637bd
    v_mfma_f32_16x16x16_bf16 a[236:239], v[100:101], v[110:111], a[236:239]
    v_mfma_f32_16x16x16_bf16 a[244:247], v[100:101], v[110:111], a[244:247]
    s_lshl_b32 s22, s3, 2
    v_mfma_f32_16x16x16_bf16 a[252:255], v[100:101], v[110:111], a[252:255]
    v_mfma_f32_16x16x16_bf16 a[8:11], v[102:103], v[110:111], a[8:11]
    buffer_load_dwordx4 v1, s[28:31], s59 offen offset:1024 sc1 lds
    v_mfma_f32_16x16x16_bf16 a[104:107], v[102:103], v[110:111], a[104:107]
    v_mfma_f32_16x16x16_bf16 a[12:15], v[102:103], v[110:111], a[12:15]
    s_add_u32 s22, s22, 129024
    v_mfma_f32_16x16x16_bf16 a[108:111], v[102:103], v[110:111], a[108:111]
    v_mfma_f32_16x16x16_bf16 a[24:27], v[104:105], v[110:111], a[24:27]
    v_mov_b32 v31, s22
    v_mfma_f32_16x16x16_bf16 a[120:123], v[104:105], v[110:111], a[120:123]
    v_mfma_f32_16x16x16_bf16 a[28:31], v[104:105], v[110:111], a[28:31]
    v_mov_b32 v120, 129024
    v_mfma_f32_16x16x16_bf16 a[124:127], v[104:105], v[110:111], a[124:127]
    v_mfma_f32_16x16x16_bf16 a[40:43], v[106:107], v[110:111], a[40:43]
    v_mov_b32 v126, 0x34fb9d56
    v_mfma_f32_16x16x16_bf16 a[136:139], v[106:107], v[110:111], a[136:139]
    v_mfma_f32_16x16x16_bf16 a[44:47], v[106:107], v[110:111], a[44:47]
    v_mov_b32 v127, 0x40088e99
    v_mfma_f32_16x16x16_bf16 a[140:143], v[106:107], v[110:111], a[140:143]
    s_waitcnt vmcnt(6)
    v_add_f32 v8, v8, v10
    v_add_f32 v9, v9, v11
    v_add_f32 v12, v12, v14
    v_add_f32 v13, v13, v15
    v_add_f32 v16, v16, v18
    v_add_f32_e64 v17, v17, v19
    v_fma_f32 v8, v8, s67, v20
    v_fma_f32 v9, v9, s67, v20
    v_fma_f32 v12, v12, s67, v20
    v_fma_f32 v13, v13, s67, v20
    v_fma_f32 v16, v16, s67, v20
    v_fma_f32 v17, v17, s67, v20
    v_sqrt_f32 v8, v8
    v_sqrt_f32 v9, v9
    v_sqrt_f32 v12, v12
    v_sqrt_f32 v13, v13
    v_sqrt_f32 v16, v16
    v_sqrt_f32 v17, v17
    v_add_f32 v20, v8, v9
    v_add_f32 v21, v12, v13
    v_add_f32 v22, v16, v17
    v_add_f32 v20, v20, v21
    v_add_f32 v20, v20, v22
    v_mul_f32 v24, v24, v8
    v_mul_f32_e64 v25, v25, v9
    v_add_f32_dpp v20, v20, v20 row_ror:8 row_mask:0xf bank_mask:0xf
    v_mul_f32 v26, v26, v12
    v_mul_f32 v27, v27, v13
    v_add_f32_dpp v20, v20, v20 row_ror:4 row_mask:0xf bank_mask:0xf
    v_mul_f32 v28, v28, v16
    v_mul_f32 v29, v29, v17
    v_add_f32_dpp v20, v20, v20 row_ror:2 row_mask:0xf bank_mask:0xf
    ds_write_b64 v30, v[24:25]
    ds_write_b64 v30, v[26:27] offset:2048
    v_add_f32_dpp v20, v20, v20 row_ror:1 row_mask:0xf bank_mask:0xf
    ds_write_b64 v30, v[28:29] offset:4096
    v_mov_b32 v21, v20
    s_nop 1
    v_permlane32_swap_b32 v21, v20
    s_nop 0
    v_add_f32 v20, v20, v21
    v_mov_b32 v21, v20
    s_nop 1
    v_permlane16_swap_b32 v21, v20
    s_nop 0
    v_add_f32 v20, v20, v21
    ds_write_b32 v31, v20
    s_waitcnt lgkmcnt(0)
    s_barrier
    ds_read_b128 v[120:123], v120
    ds_read_b128 v[96:99], v6 offset:0
    ds_read_b128 v[100:103], v6 offset:16
    ds_read_b128 v[104:107], v6 offset:128
    ds_read_b128 v[108:111], v6 offset:144
    ds_read_b128 v[24:27], v124 offset:0
    ds_read_b128 v[28:31], v124 offset:16
    ds_read_b128 v[8:11], v2 offset:0
    ds_read_b128 v[12:15], v2 offset:1024
    ds_read_b128 v[16:19], v2 offset:2048
    ds_read_b128 v[20:23], v2 offset:3072
    s_waitcnt lgkmcnt(10)
    v_add_f32 v120, v120, v121
    v_add_f32 v122, v122, v123
    v_add_f32 v120, v120, v122
    v_fmac_f32 v126, 0x399ff8e5, v120
    v_rcp_f32 v126, v126
    s_waitcnt lgkmcnt(4)
    v_pk_fma_f32 v[96:97], v[96:97], v[126:127], v[126:127] op_sel:[0,0,1] op_sel_hi:[1,0,1]
    v_pk_fma_f32 v[98:99], v[98:99], v[126:127], v[126:127] op_sel:[0,0,1] op_sel_hi:[1,0,1]
    v_pk_fma_f32 v[100:101], v[100:101], v[126:127], v[126:127] op_sel:[0,0,1] op_sel_hi:[1,0,1]
    v_pk_fma_f32 v[102:103], v[102:103], v[126:127], v[126:127] op_sel:[0,0,1] op_sel_hi:[1,0,1]
    v_pk_fma_f32 v[104:105], v[104:105], v[126:127], v[126:127] op_sel:[0,0,1] op_sel_hi:[1,0,1]
    v_pk_fma_f32 v[106:107], v[106:107], v[126:127], v[126:127] op_sel:[0,0,1] op_sel_hi:[1,0,1]
    v_pk_fma_f32 v[108:109], v[108:109], v[126:127], v[126:127] op_sel:[0,0,1] op_sel_hi:[1,0,1]
    v_pk_fma_f32 v[110:111], v[110:111], v[126:127], v[126:127] op_sel:[0,0,1] op_sel_hi:[1,0,1]
    v_pk_fma_f32 v[24:25], v[24:25], v[126:127], v[126:127] op_sel:[0,0,1] op_sel_hi:[1,0,1]
    v_pk_fma_f32 v[26:27], v[26:27], v[126:127], v[126:127] op_sel:[0,0,1] op_sel_hi:[1,0,1]
    v_pk_fma_f32 v[28:29], v[28:29], v[126:127], v[126:127] op_sel:[0,0,1] op_sel_hi:[1,0,1]
    v_pk_fma_f32 v[30:31], v[30:31], v[126:127], v[126:127] op_sel:[0,0,1] op_sel_hi:[1,0,1]
    v_mov_b32_e64 v7, v126
    v_pk_mul_f32 v[32:33], v[32:33], v[96:97]
    v_pk_mul_f32 v[34:35], v[34:35], v[98:99]
    v_pk_mul_f32 v[36:37], v[36:37], v[100:101]
    v_pk_mul_f32 v[38:39], v[38:39], v[102:103]
    v_cvt_pk_bf16_f32 v32, v32, v33
    v_cvt_pk_bf16_f32 v33, v34, v35
    v_cvt_pk_bf16_f32 v34, v36, v37
    v_cvt_pk_bf16_f32 v35, v38, v39
    v_pk_mul_f32 v[40:41], v[40:41], v[96:97]
    v_pk_mul_f32 v[42:43], v[42:43], v[98:99]
    v_pk_mul_f32 v[44:45], v[44:45], v[100:101]
    v_pk_mul_f32 v[46:47], v[46:47], v[102:103]
    v_cvt_pk_bf16_f32 v36, v40, v41
    v_cvt_pk_bf16_f32 v37, v42, v43
    v_cvt_pk_bf16_f32 v38, v44, v45
    v_cvt_pk_bf16_f32 v39, v46, v47
    v_pk_mul_f32 v[48:49], v[48:49], v[96:97]
    v_pk_mul_f32 v[50:51], v[50:51], v[98:99]
    v_pk_mul_f32 v[52:53], v[52:53], v[100:101]
    v_pk_mul_f32 v[54:55], v[54:55], v[102:103]
    v_cvt_pk_bf16_f32 v40, v48, v49
    v_cvt_pk_bf16_f32 v41, v50, v51
    v_cvt_pk_bf16_f32 v42, v52, v53
    v_cvt_pk_bf16_f32 v43, v54, v55
    v_pk_mul_f32 v[56:57], v[56:57], v[96:97]
    v_pk_mul_f32 v[58:59], v[58:59], v[98:99]
    v_pk_mul_f32 v[60:61], v[60:61], v[100:101]
    v_pk_mul_f32 v[62:63], v[62:63], v[102:103]
    v_cvt_pk_bf16_f32 v44, v56, v57
    v_cvt_pk_bf16_f32 v45, v58, v59
    v_cvt_pk_bf16_f32 v46, v60, v61
    v_cvt_pk_bf16_f32 v47, v62, v63
    v_lshlrev_b32 v96, 16, v112
    v_and_b32 v97, s54, v112
    v_lshlrev_b32 v98, 16, v113
    v_and_b32 v99, s54, v113
    v_pk_mul_f32 v[96:97], v[96:97], v[24:25]
    v_pk_mul_f32 v[98:99], v[98:99], v[26:27]
    v_cvt_pk_bf16_f32 v112, v96, v97
    v_cvt_pk_bf16_f32 v113, v98, v99
    v_lshlrev_b32 v100, 16, v114
    v_and_b32 v101, s54, v114
    v_lshlrev_b32 v102, 16, v115
    v_and_b32 v103, s54, v115
    v_pk_mul_f32 v[100:101], v[100:101], v[28:29]
    v_pk_mul_f32 v[102:103], v[102:103], v[30:31]
    v_cvt_pk_bf16_f32 v114, v100, v101
    v_cvt_pk_bf16_f32 v115, v102, v103
    v_lshlrev_b32 v96, 16, v116
    v_and_b32 v97, s54, v116
    v_lshlrev_b32 v98, 16, v117
    v_and_b32 v99, s54, v117
    v_pk_mul_f32 v[96:97], v[96:97], v[24:25]
    v_pk_mul_f32 v[98:99], v[98:99], v[26:27]
    v_cvt_pk_bf16_f32 v116, v96, v97
    v_cvt_pk_bf16_f32 v117, v98, v99
    v_lshlrev_b32 v100, 16, v118
    v_and_b32 v101, s54, v118
    v_lshlrev_b32 v102, 16, v119
    v_and_b32 v103, s54, v119
    v_pk_mul_f32 v[100:101], v[100:101], v[28:29]
    v_pk_mul_f32 v[102:103], v[102:103], v[30:31]
    v_cvt_pk_bf16_f32 v118, v100, v101
    v_cvt_pk_bf16_f32 v119, v102, v103
    buffer_store_dwordx4 v[112:115], v1, s[44:47], s63 offen offset:0 sc1
    buffer_store_dwordx4 v[116:119], v1, s[44:47], s63 offen offset:3072 sc1
    v_pk_mul_f32 v[64:65], v[64:65], v[104:105]
    v_pk_mul_f32 v[66:67], v[66:67], v[106:107]
    v_pk_mul_f32 v[68:69], v[68:69], v[108:109]
    v_pk_mul_f32 v[70:71], v[70:71], v[110:111]
    v_cvt_pk_bf16_f32 v48, v64, v65
    v_cvt_pk_bf16_f32 v49, v66, v67
    v_cvt_pk_bf16_f32 v50, v68, v69
    v_cvt_pk_bf16_f32 v51, v70, v71
    v_pk_mul_f32 v[72:73], v[72:73], v[104:105]
    v_pk_mul_f32 v[74:75], v[74:75], v[106:107]
    v_pk_mul_f32 v[76:77], v[76:77], v[108:109]
    v_pk_mul_f32 v[78:79], v[78:79], v[110:111]
    v_cvt_pk_bf16_f32 v52, v72, v73
    v_cvt_pk_bf16_f32 v53, v74, v75
    v_cvt_pk_bf16_f32 v54, v76, v77
    v_cvt_pk_bf16_f32 v55, v78, v79
    v_pk_mul_f32 v[80:81], v[80:81], v[104:105]
    v_pk_mul_f32 v[82:83], v[82:83], v[106:107]
    v_pk_mul_f32 v[84:85], v[84:85], v[108:109]
    v_pk_mul_f32 v[86:87], v[86:87], v[110:111]
    v_cvt_pk_bf16_f32 v56, v80, v81
    v_cvt_pk_bf16_f32 v57, v82, v83
    v_cvt_pk_bf16_f32 v58, v84, v85
    v_cvt_pk_bf16_f32 v59, v86, v87
    v_pk_mul_f32 v[88:89], v[88:89], v[104:105]
    v_pk_mul_f32 v[90:91], v[90:91], v[106:107]
    v_pk_mul_f32 v[92:93], v[92:93], v[108:109]
    v_pk_mul_f32 v[94:95], v[94:95], v[110:111]
    v_cvt_pk_bf16_f32 v60, v88, v89
    v_cvt_pk_bf16_f32 v61, v90, v91
    v_cvt_pk_bf16_f32 v62, v92, v93
    v_cvt_pk_bf16_f32 v63, v94, v95
    s_waitcnt lgkmcnt(0)
.p2align 3
L3_head:
    v_mfma_f32_16x16x32_bf16 v[128:131], v[8:11], v[32:35], v[128:131]
    ds_read_b128 v[24:27], v2 offset:4096
    v_mfma_f32_16x16x32_bf16 v[128:131], v[12:15], v[48:51], v[128:131]
    buffer_load_dwordx4 v1, s[28:31], s59 offen offset:2048 sc1 lds
    v_mfma_f32_16x16x32_bf16 v[136:139], v[12:15], v[52:55], v[136:139]
    ds_read_b128 v[96:99], v6 offset:256
    ds_read_b128 v[100:103], v6 offset:272
    v_mfma_f32_16x16x32_bf16 v[136:139], v[8:11], v[36:39], v[136:139]
    ds_read_b64_tr_b16 v[64:65], v3 offset:32768
    ds_read_b64_tr_b16 v[66:67], v4 offset:32768
    v_mfma_f32_16x16x32_bf16 v[144:147], v[8:11], v[40:43], v[144:147]
    ds_read_b128 v[28:31], v2 offset:5120
    v_mfma_f32_16x16x32_bf16 v[144:147], v[12:15], v[56:59], v[144:147]
    s_add_u32 s59, s59, 3072
    v_mfma_f32_16x16x32_bf16 v[152:155], v[12:15], v[60:63], v[152:155]
    ds_read_b64_tr_b16 v[68:69], v4 offset:33792
    ds_read_b64_tr_b16 v[70:71], v3 offset:33792
    v_mfma_f32_16x16x32_bf16 v[152:155], v[8:11], v[44:47], v[152:155]
    v_mfma_f32_16x16x32_bf16 v[156:159], v[16:19], v[44:47], v[156:159]
    ds_read_b128 v[8:11], v2 offset:6144
    v_mfma_f32_16x16x32_bf16 v[156:159], v[20:23], v[60:63], v[156:159]
    s_add_u32 m0, m0, 3072
    v_mfma_f32_16x16x32_bf16 v[148:151], v[20:23], v[56:59], v[148:151]
    ds_read_b64_tr_b16 v[72:73], v3 offset:34816
    ds_read_b64_tr_b16 v[74:75], v4 offset:34816
    v_mfma_f32_16x16x32_bf16 v[148:151], v[16:19], v[40:43], v[148:151]
    ds_read_b64_tr_b16 v[76:77], v4 offset:35840
    ds_read_b64_tr_b16 v[78:79], v3 offset:35840
    v_mfma_f32_16x16x32_bf16 v[140:143], v[16:19], v[36:39], v[140:143]
    ds_read_b128 v[12:15], v2 offset:7168
    v_mfma_f32_16x16x32_bf16 v[140:143], v[20:23], v[52:55], v[140:143]
    buffer_load_dwordx4 v1, s[28:31], s59 offen offset:0 sc1 lds
    v_mfma_f32_16x16x32_bf16 v[132:135], v[20:23], v[48:51], v[132:135]
    v_mfma_f32_16x16x32_bf16 v[132:135], v[16:19], v[32:35], v[132:135]
    s_waitcnt lgkmcnt(8)
    v_fmaak_f32 v96, v96, v7, 0x40088e99
    v_fmaak_f32 v97, v97, v7, 0x40088e99
    v_mfma_f32_16x16x32_bf16 v[160:163], v[24:27], v[32:35], v[160:163]
    ds_read_b128 v[16:19], v2 offset:8192
    v_fmaak_f32 v98, v98, v7, 0x40088e99
    v_mfma_f32_16x16x32_bf16 v[160:163], v[28:31], v[48:51], v[160:163]
    v_fmaak_f32 v99, v99, v7, 0x40088e99
    v_mfma_f32_16x16x32_bf16 v[168:171], v[28:31], v[52:55], v[168:171]
    v_fmaak_f32 v100, v100, v7, 0x40088e99
    v_fmaak_f32 v101, v101, v7, 0x40088e99
    v_mfma_f32_16x16x32_bf16 v[168:171], v[24:27], v[36:39], v[168:171]
    v_fmaak_f32 v102, v102, v7, 0x40088e99
    v_mfma_f32_16x16x32_bf16 v[176:179], v[24:27], v[40:43], v[176:179]
    ds_read_b128 v[20:23], v2 offset:9216
    v_fmaak_f32 v103, v103, v7, 0x40088e99
    v_mfma_f32_16x16x32_bf16 v[176:179], v[28:31], v[56:59], v[176:179]
    buffer_load_dwordx4 v1, s[28:31], s59 offen offset:1024 sc1 lds
    v_mfma_f32_16x16x32_bf16 v[184:187], v[28:31], v[60:63], v[184:187]
    v_lshlrev_b32 v104, 16, v64
    v_mfma_f32_16x16x32_bf16 v[184:187], v[24:27], v[44:47], v[184:187]
    s_waitcnt lgkmcnt(2)
    v_and_b32 v105, s54, v64
    v_lshlrev_b32_e64 v106, 16, v65
    v_mfma_f32_16x16x32_bf16 v[188:191], v[8:11], v[44:47], v[188:191]
    ds_read_b128 v[24:27], v2 offset:10240
    v_and_b32_e64 v107, s54, v65
    v_mfma_f32_16x16x32_bf16 v[188:191], v[12:15], v[60:63], v[188:191]
    v_mul_f32_e64 v104, v104, v96
    v_mfma_f32_16x16x32_bf16 v[180:183], v[12:15], v[56:59], v[180:183]
    v_mul_f32 v105, v105, v97
    v_mul_f32 v106, v106, v98
    v_mfma_f32_16x16x32_bf16 v[180:183], v[8:11], v[40:43], v[180:183]
    v_mul_f32_e64 v107, v107, v99
    v_mfma_f32_16x16x32_bf16 v[172:175], v[8:11], v[36:39], v[172:175]
    ds_read_b128 v[28:31], v2 offset:11264
    v_cvt_pk_bf16_f32 v64, v104, v105
    v_mfma_f32_16x16x32_bf16 v[172:175], v[12:15], v[52:55], v[172:175]
    v_cvt_pk_bf16_f32 v65, v106, v107
    v_mfma_f32_16x16x32_bf16 v[164:167], v[12:15], v[48:51], v[164:167]
    v_lshlrev_b32 v108, 16, v66
    v_and_b32 v109, s54, v66
    v_mfma_f32_16x16x32_bf16 v[164:167], v[8:11], v[32:35], v[164:167]
    s_waitcnt lgkmcnt(2)
    v_lshlrev_b32 v110, 16, v67
    v_mfma_f32_16x16x32_bf16 v[192:195], v[16:19], v[32:35], v[192:195]
    ds_read_b128 v[8:11], v2 offset:12288
    v_and_b32_e64 v111, s54, v67
    v_mfma_f32_16x16x32_bf16 v[192:195], v[20:23], v[48:51], v[192:195]
    buffer_load_dwordx4 v1, s[28:31], s59 offen offset:2048 sc1 lds
    v_mfma_f32_16x16x32_bf16 v[200:203], v[20:23], v[52:55], v[200:203]
    v_mul_f32 v108, v108, v100
    v_mul_f32 v109, v109, v101
    v_mfma_f32_16x16x32_bf16 v[200:203], v[16:19], v[36:39], v[200:203]
    v_mul_f32_e64 v110, v110, v102
    v_mfma_f32_16x16x32_bf16 v[208:211], v[16:19], v[40:43], v[208:211]
    ds_read_b128 v[12:15], v2 offset:13312
    v_mul_f32_e64 v111, v111, v103
    v_mfma_f32_16x16x32_bf16 v[208:211], v[20:23], v[56:59], v[208:211]
    s_add_u32 m0, s71, 32768
    v_cvt_pk_bf16_f32 v66, v108, v109
    v_mfma_f32_16x16x32_bf16 v[216:219], v[20:23], v[60:63], v[216:219]
    s_add_u32 s59, s59, 21504
    v_cvt_pk_bf16_f32 v67, v110, v111
    v_lshlrev_b32_e64 v104, 16, v68
    v_mfma_f32_16x16x32_bf16 v[216:219], v[16:19], v[44:47], v[216:219]
    s_waitcnt lgkmcnt(2)
    v_and_b32 v105, s54, v68
    v_mfma_f32_16x16x32_bf16 v[220:223], v[24:27], v[44:47], v[220:223]
    ds_read_b128 v[16:19], v2 offset:14336
    v_lshlrev_b32_e64 v106, 16, v69
    v_mfma_f32_16x16x32_bf16 v[220:223], v[28:31], v[60:63], v[220:223]
    v_and_b32 v107, s54, v69
    v_mul_f32 v104, v104, v96
    v_mfma_f32_16x16x32_bf16 v[212:215], v[28:31], v[56:59], v[212:215]
    v_mul_f32_e64 v105, v105, v97
    v_mfma_f32_16x16x32_bf16 v[212:215], v[24:27], v[40:43], v[212:215]
    buffer_load_dwordx4 v1, s[32:35], s56 offen offset:0 lds
    v_mfma_f32_16x16x32_bf16 v[204:207], v[24:27], v[36:39], v[204:207]
    ds_read_b128 v[20:23], v2 offset:15360
    v_mul_f32_e64 v106, v106, v98
    v_mfma_f32_16x16x32_bf16 v[204:207], v[28:31], v[52:55], v[204:207]
    v_mul_f32_e64 v107, v107, v99
    v_mfma_f32_16x16x32_bf16 v[196:199], v[28:31], v[48:51], v[196:199]
    v_cvt_pk_bf16_f32 v68, v104, v105
    v_cvt_pk_bf16_f32 v69, v106, v107
    v_mfma_f32_16x16x32_bf16 v[196:199], v[24:27], v[32:35], v[196:199]
    s_waitcnt lgkmcnt(2)
    v_lshlrev_b32 v108, 16, v70
    v_mfma_f32_16x16x32_bf16 v[224:227], v[8:11], v[32:35], v[224:227]
    ds_read_b128 v[24:27], v2 offset:16384
    v_and_b32_e64 v109, s54, v70
    v_mfma_f32_16x16x32_bf16 v[224:227], v[12:15], v[48:51], v[224:227]
    v_lshlrev_b32 v110, 16, v71
    v_and_b32 v111, s54, v71
    v_mfma_f32_16x16x32_bf16 v[232:235], v[12:15], v[52:55], v[232:235]
    v_mul_f32_e64 v108, v108, v100
    v_mfma_f32_16x16x32_bf16 v[232:235], v[8:11], v[36:39], v[232:235]
    buffer_load_dwordx4 v1, s[32:35], s56 offen offset:1024 lds
    v_mfma_f32_16x16x32_bf16 v[240:243], v[8:11], v[40:43], v[240:243]
    ds_read_b128 v[28:31], v2 offset:17408
    v_mul_f32_e64 v109, v109, v101
    v_mfma_f32_16x16x32_bf16 v[240:243], v[12:15], v[56:59], v[240:243]
    v_mul_f32_e64 v110, v110, v102
    v_mfma_f32_16x16x32_bf16 v[248:251], v[12:15], v[60:63], v[248:251]
    v_mul_f32_e64 v111, v111, v103
    v_cvt_pk_bf16_f32 v70, v108, v109
    v_mfma_f32_16x16x32_bf16 v[248:251], v[8:11], v[44:47], v[248:251]
    s_waitcnt lgkmcnt(2)
    v_cvt_pk_bf16_f32 v71, v110, v111
    v_mfma_f32_16x16x32_bf16 v[252:255], v[16:19], v[44:47], v[252:255]
    ds_read_b128 v[8:11], v2 offset:18432
    v_lshlrev_b32 v104, 16, v72
    v_mfma_f32_16x16x32_bf16 v[252:255], v[20:23], v[60:63], v[252:255]
    v_and_b32_e64 v105, s54, v72
    v_mfma_f32_16x16x32_bf16 v[244:247], v[20:23], v[56:59], v[244:247]
    v_lshlrev_b32 v106, 16, v73
    v_and_b32 v107, s54, v73
    v_mfma_f32_16x16x32_bf16 v[244:247], v[16:19], v[40:43], v[244:247]
    buffer_load_dwordx4 v1, s[32:35], s56 offen offset:2048 lds
    v_mfma_f32_16x16x32_bf16 v[236:239], v[16:19], v[36:39], v[236:239]
    ds_read_b128 v[12:15], v2 offset:19456
    v_mul_f32_e64 v104, v104, v96
    v_mfma_f32_16x16x32_bf16 v[236:239], v[20:23], v[52:55], v[236:239]
    v_mul_f32_e64 v105, v105, v97
    v_mfma_f32_16x16x32_bf16 v[228:231], v[20:23], v[48:51], v[228:231]
    v_mul_f32 v106, v106, v98
    v_mul_f32 v107, v107, v99
    v_mfma_f32_16x16x32_bf16 v[228:231], v[16:19], v[32:35], v[228:231]
    s_waitcnt lgkmcnt(2)
    v_cvt_pk_bf16_f32 v72, v104, v105
    v_mfma_f32_16x16x32_bf16 a[192:195], v[24:27], v[32:35], a[192:195]
    ds_read_b128 v[16:19], v2 offset:20480
    v_cvt_pk_bf16_f32 v73, v106, v107
    v_mfma_f32_16x16x32_bf16 a[192:195], v[28:31], v[48:51], a[192:195]
    v_lshlrev_b32 v108, 16, v74
    v_mfma_f32_16x16x32_bf16 a[200:203], v[28:31], v[52:55], a[200:203]
    v_and_b32 v109, s54, v74
    v_lshlrev_b32 v110, 16, v75
    v_mfma_f32_16x16x32_bf16 a[200:203], v[24:27], v[36:39], a[200:203]
    buffer_load_dwordx4 v1, s[32:35], s56 offen offset:3072 lds
    v_mfma_f32_16x16x32_bf16 a[208:211], v[24:27], v[40:43], a[208:211]
    ds_read_b128 v[20:23], v2 offset:21504
    v_and_b32_e64 v111, s54, v75
    v_mfma_f32_16x16x32_bf16 a[208:211], v[28:31], v[56:59], a[208:211]
    s_add_u32 s56, s56, 4096
    v_mul_f32_e64 v108, v108, v100
    v_mfma_f32_16x16x32_bf16 a[216:219], v[28:31], v[60:63], a[216:219]
    v_mul_f32 v109, v109, v101
    v_mul_f32 v110, v110, v102
    v_mfma_f32_16x16x32_bf16 a[216:219], v[24:27], v[44:47], a[216:219]
    s_waitcnt lgkmcnt(2)
    v_mul_f32 v111, v111, v103
    v_mfma_f32_16x16x32_bf16 a[220:223], v[8:11], v[44:47], a[220:223]
    ds_read_b128 v[24:27], v2 offset:22528
    ds_read_b128 v[28:31], v2 offset:23552
    v_mfma_f32_16x16x32_bf16 a[220:223], v[12:15], v[60:63], a[220:223]
    s_cmp_ge_u32 s56, s75
    v_cvt_pk_bf16_f32 v74, v108, v109
    v_cvt_pk_bf16_f32 v75, v110, v111
    v_mfma_f32_16x16x32_bf16 a[212:215], v[12:15], v[56:59], a[212:215]
    s_cselect_b32 s56, s64, s56
    v_lshlrev_b32_e64 v104, 16, v76
    v_mfma_f32_16x16x32_bf16 a[212:215], v[8:11], v[40:43], a[212:215]
    v_and_b32 v105, s54, v76
    v_lshlrev_b32 v106, 16, v77
    v_mfma_f32_16x16x32_bf16 a[204:207], v[8:11], v[36:39], a[204:207]
    v_and_b32_e64 v107, s54, v77
    v_mfma_f32_16x16x32_bf16 a[204:207], v[12:15], v[52:55], a[204:207]
    v_mul_f32 v104, v104, v96
    v_mul_f32 v105, v105, v97
    v_mfma_f32_16x16x32_bf16 a[196:199], v[12:15], v[48:51], a[196:199]
    s_add_u32 m0, s66, 49152
    v_mul_f32_e64 v106, v106, v98
    v_mfma_f32_16x16x32_bf16 a[196:199], v[8:11], v[32:35], a[196:199]
    s_waitcnt vmcnt(8) lgkmcnt(0)
    s_barrier
    v_mfma_f32_16x16x32_bf16 a[224:227], v[16:19], v[32:35], a[224:227]
    ds_read_b128 v[8:11], v2 offset:24576
    v_mul_f32_e64 v107, v107, v99
    v_mfma_f32_16x16x32_bf16 a[224:227], v[20:23], v[48:51], a[224:227]
    v_cvt_pk_bf16_f32 v76, v104, v105
    v_mfma_f32_16x16x32_bf16 a[232:235], v[20:23], v[52:55], a[232:235]
    ds_read_b128 v[12:15], v2 offset:25600
    v_cvt_pk_bf16_f32 v77, v106, v107
    v_mfma_f32_16x16x32_bf16 a[232:235], v[16:19], v[36:39], a[232:235]
    buffer_load_dwordx4 v1, s[28:31], s59 offen offset:0 sc1 lds
    v_mfma_f32_16x16x32_bf16 a[240:243], v[16:19], v[40:43], a[240:243]
    v_lshlrev_b32 v108, 16, v78
    v_and_b32 v109, s54, v78
    v_mfma_f32_16x16x32_bf16 a[240:243], v[20:23], v[56:59], a[240:243]
    v_lshlrev_b32_e64 v110, 16, v79
    v_mfma_f32_16x16x32_bf16 a[248:251], v[20:23], v[60:63], a[248:251]
    v_and_b32 v111, s54, v79
    v_mul_f32 v108, v108, v100
    v_mfma_f32_16x16x32_bf16 a[248:251], v[16:19], v[44:47], a[248:251]
    buffer_atomic_add v125, v1, s[48:51], 0 offen sc1
    v_mfma_f32_16x16x32_bf16 a[252:255], v[24:27], v[44:47], a[252:255]
    ds_read_b128 v[16:19], v2 offset:26624
    v_mfma_f32_16x16x32_bf16 a[252:255], v[28:31], v[60:63], a[252:255]
    v_mul_f32 v109, v109, v101
    v_mul_f32 v110, v110, v102
    v_mfma_f32_16x16x32_bf16 a[244:247], v[28:31], v[56:59], a[244:247]
    v_mul_f32_e64 v111, v111, v103
    v_mfma_f32_16x16x32_bf16 a[244:247], v[24:27], v[40:43], a[244:247]
    buffer_load_dwordx4 v1, s[28:31], s59 offen offset:1024 sc1 lds
    v_mfma_f32_16x16x32_bf16 a[236:239], v[24:27], v[36:39], a[236:239]
    ds_read_b128 v[20:23], v2 offset:27648
    v_cvt_pk_bf16_f32 v78, v108, v109
    v_mfma_f32_16x16x32_bf16 a[236:239], v[28:31], v[52:55], a[236:239]
    v_cvt_pk_bf16_f32 v79, v110, v111
    v_mfma_f32_16x16x32_bf16 a[228:231], v[28:31], v[48:51], a[228:231]
    v_mfma_f32_16x16x32_bf16 a[228:231], v[24:27], v[32:35], a[228:231]
    s_waitcnt lgkmcnt(2)
    v_mfma_f32_16x16x32_bf16 a[188:191], v[8:11], v[32:35], a[188:191]
    ds_read_b128 v[24:27], v2 offset:28672
    v_mfma_f32_16x16x32_bf16 a[188:191], v[12:15], v[48:51], a[188:191]
    buffer_load_dwordx4 v1, s[28:31], s59 offen offset:2048 sc1 lds
    v_mfma_f32_16x16x32_bf16 a[48:51], v[12:15], v[52:55], a[48:51]
    ds_read_b128 v[96:99], v6 offset:384
    ds_read_b128 v[100:103], v6 offset:400
    v_mfma_f32_16x16x32_bf16 a[48:51], v[8:11], v[36:39], a[48:51]
    ds_read_b64_tr_b16 v[80:81], v3 offset:0
    ds_read_b64_tr_b16 v[82:83], v4 offset:0
    v_mfma_f32_16x16x32_bf16 a[144:147], v[8:11], v[40:43], a[144:147]
    ds_read_b128 v[28:31], v2 offset:29696
    v_mfma_f32_16x16x32_bf16 a[144:147], v[12:15], v[56:59], a[144:147]
    s_add_u32 s59, s59, 3072
    v_mfma_f32_16x16x32_bf16 a[52:55], v[12:15], v[60:63], a[52:55]
    ds_read_b64_tr_b16 v[84:85], v4 offset:1024
    ds_read_b64_tr_b16 v[86:87], v3 offset:1024
    v_mfma_f32_16x16x32_bf16 a[52:55], v[8:11], v[44:47], a[52:55]
    s_waitcnt lgkmcnt(8)
    v_mfma_f32_16x16x32_bf16 a[100:103], v[16:19], v[44:47], a[100:103]
    ds_read_b128 v[8:11], v2 offset:30720
    v_mfma_f32_16x16x32_bf16 a[100:103], v[20:23], v[60:63], a[100:103]
    s_add_u32 m0, m0, 3072
    v_mfma_f32_16x16x32_bf16 a[4:7], v[20:23], v[56:59], a[4:7]
    ds_read_b64_tr_b16 v[88:89], v3 offset:2048
    ds_read_b64_tr_b16 v[90:91], v4 offset:2048
    v_mfma_f32_16x16x32_bf16 a[4:7], v[16:19], v[40:43], a[4:7]
    ds_read_b64_tr_b16 v[92:93], v4 offset:3072
    ds_read_b64_tr_b16 v[94:95], v3 offset:3072
    v_mfma_f32_16x16x32_bf16 a[96:99], v[16:19], v[36:39], a[96:99]
    ds_read_b128 v[12:15], v2 offset:31744
    v_mfma_f32_16x16x32_bf16 a[96:99], v[20:23], v[52:55], a[96:99]
    buffer_load_dwordx4 v1, s[28:31], s59 offen offset:0 sc1 lds
    v_mfma_f32_16x16x32_bf16 a[0:3], v[20:23], v[48:51], a[0:3]
    v_mfma_f32_16x16x32_bf16 a[0:3], v[16:19], v[32:35], a[0:3]
    s_waitcnt lgkmcnt(8)
    v_fmaak_f32 v96, v96, v7, 0x40088e99
    v_fmaak_f32 v97, v97, v7, 0x40088e99
    v_mfma_f32_16x16x32_bf16 a[148:151], v[24:27], v[32:35], a[148:151]
    ds_read_b128 v[16:19], v2 offset:32768
    v_fmaak_f32 v98, v98, v7, 0x40088e99
    v_mfma_f32_16x16x32_bf16 a[148:151], v[28:31], v[48:51], a[148:151]
    v_fmaak_f32 v99, v99, v7, 0x40088e99
    v_mfma_f32_16x16x32_bf16 a[56:59], v[28:31], v[52:55], a[56:59]
    v_fmaak_f32 v100, v100, v7, 0x40088e99
    v_fmaak_f32 v101, v101, v7, 0x40088e99
    v_mfma_f32_16x16x32_bf16 a[56:59], v[24:27], v[36:39], a[56:59]
    v_fmaak_f32 v102, v102, v7, 0x40088e99
    v_mfma_f32_16x16x32_bf16 a[152:155], v[24:27], v[40:43], a[152:155]
    ds_read_b128 v[20:23], v2 offset:33792
    v_fmaak_f32 v103, v103, v7, 0x40088e99
    v_mfma_f32_16x16x32_bf16 a[152:155], v[28:31], v[56:59], a[152:155]
    buffer_load_dwordx4 v1, s[28:31], s59 offen offset:1024 sc1 lds
    v_mfma_f32_16x16x32_bf16 a[60:63], v[28:31], v[60:63], a[60:63]
    v_lshlrev_b32 v104, 16, v80
    v_mfma_f32_16x16x32_bf16 a[60:63], v[24:27], v[44:47], a[60:63]
    s_waitcnt lgkmcnt(2)
    v_and_b32 v105, s54, v80
    v_lshlrev_b32_e64 v106, 16, v81
    v_mfma_f32_16x16x32_bf16 a[108:111], v[8:11], v[44:47], a[108:111]
    ds_read_b128 v[24:27], v2 offset:34816
    v_mfma_f32_16x16x32_bf16 a[108:111], v[12:15], v[60:63], a[108:111]
    v_and_b32 v107, s54, v81
    v_mul_f32 v104, v104, v96
    v_mfma_f32_16x16x32_bf16 a[12:15], v[12:15], v[56:59], a[12:15]
    v_mul_f32_e64 v105, v105, v97
    v_mfma_f32_16x16x32_bf16 a[12:15], v[8:11], v[40:43], a[12:15]
    v_mul_f32 v106, v106, v98
    v_mul_f32 v107, v107, v99
    v_mfma_f32_16x16x32_bf16 a[104:107], v[8:11], v[36:39], a[104:107]
    ds_read_b128 v[28:31], v2 offset:35840
    v_cvt_pk_bf16_f32 v80, v104, v105
    v_mfma_f32_16x16x32_bf16 a[104:107], v[12:15], v[52:55], a[104:107]
    v_cvt_pk_bf16_f32 v81, v106, v107
    v_mfma_f32_16x16x32_bf16 a[8:11], v[12:15], v[48:51], a[8:11]
    v_lshlrev_b32 v108, 16, v82
    v_and_b32 v109, s54, v82
    v_mfma_f32_16x16x32_bf16 a[8:11], v[8:11], v[32:35], a[8:11]
    s_waitcnt lgkmcnt(2)
    v_lshlrev_b32 v110, 16, v83
    v_mfma_f32_16x16x32_bf16 a[156:159], v[16:19], v[32:35], a[156:159]
    ds_read_b128 v[8:11], v2 offset:36864
    v_and_b32_e64 v111, s54, v83
    v_mfma_f32_16x16x32_bf16 a[156:159], v[20:23], v[48:51], a[156:159]
    buffer_load_dwordx4 v1, s[28:31], s59 offen offset:2048 sc1 lds
    v_mfma_f32_16x16x32_bf16 a[64:67], v[20:23], v[52:55], a[64:67]
    v_mul_f32_e64 v108, v108, v100
    v_mfma_f32_16x16x32_bf16 a[64:67], v[16:19], v[36:39], a[64:67]
    v_mul_f32 v109, v109, v101
    v_mul_f32 v110, v110, v102
    v_mfma_f32_16x16x32_bf16 a[160:163], v[16:19], v[40:43], a[160:163]
    ds_read_b128 v[12:15], v2 offset:37888
    v_mfma_f32_16x16x32_bf16 a[160:163], v[20:23], v[56:59], a[160:163]
    s_add_u32 m0, s71, 0
    v_mul_f32 v111, v111, v103
    v_cvt_pk_bf16_f32 v82, v108, v109
    v_mfma_f32_16x16x32_bf16 a[68:71], v[20:23], v[60:63], a[68:71]
    s_add_u32 s59, s59, 21504
    v_cvt_pk_bf16_f32 v83, v110, v111
    v_mfma_f32_16x16x32_bf16 a[68:71], v[16:19], v[44:47], a[68:71]
    s_waitcnt lgkmcnt(2)
    v_lshlrev_b32 v104, 16, v84
    v_and_b32_e64 v105, s54, v84
    v_mfma_f32_16x16x32_bf16 a[116:119], v[24:27], v[44:47], a[116:119]
    ds_read_b128 v[16:19], v2 offset:38912
    v_lshlrev_b32_e64 v106, 16, v85
    v_mfma_f32_16x16x32_bf16 a[116:119], v[28:31], v[60:63], a[116:119]
    v_and_b32_e64 v107, s54, v85
    v_mfma_f32_16x16x32_bf16 a[20:23], v[28:31], v[56:59], a[20:23]
    v_mul_f32_e64 v104, v104, v96
    v_mfma_f32_16x16x32_bf16 a[20:23], v[24:27], v[40:43], a[20:23]
    buffer_load_dwordx4 v1, s[32:35], s56 offen offset:0 lds
    v_mfma_f32_16x16x32_bf16 a[112:115], v[24:27], v[36:39], a[112:115]
    ds_read_b128 v[20:23], v2 offset:39936
    v_mul_f32_e64 v105, v105, v97
    v_mfma_f32_16x16x32_bf16 a[112:115], v[28:31], v[52:55], a[112:115]
    v_mul_f32 v106, v106, v98
    v_mul_f32 v107, v107, v99
    v_mfma_f32_16x16x32_bf16 a[16:19], v[28:31], v[48:51], a[16:19]
    v_cvt_pk_bf16_f32 v84, v104, v105
    v_mfma_f32_16x16x32_bf16 a[16:19], v[24:27], v[32:35], a[16:19]
    s_waitcnt lgkmcnt(2)
    v_cvt_pk_bf16_f32 v85, v106, v107
    v_lshlrev_b32 v108, 16, v86
    v_mfma_f32_16x16x32_bf16 a[164:167], v[8:11], v[32:35], a[164:167]
    ds_read_b128 v[24:27], v2 offset:40960
    v_mfma_f32_16x16x32_bf16 a[164:167], v[12:15], v[48:51], a[164:167]
    v_and_b32 v109, s54, v86
    v_lshlrev_b32 v110, 16, v87
    v_mfma_f32_16x16x32_bf16 a[72:75], v[12:15], v[52:55], a[72:75]
    v_and_b32_e64 v111, s54, v87
    v_mfma_f32_16x16x32_bf16 a[72:75], v[8:11], v[36:39], a[72:75]
    buffer_load_dwordx4 v1, s[32:35], s56 offen offset:1024 lds
    v_mfma_f32_16x16x32_bf16 a[168:171], v[8:11], v[40:43], a[168:171]
    ds_read_b128 v[28:31], v2 offset:41984
    v_mul_f32_e64 v108, v108, v100
    v_mfma_f32_16x16x32_bf16 a[168:171], v[12:15], v[56:59], a[168:171]
    v_mul_f32_e64 v109, v109, v101
    v_mfma_f32_16x16x32_bf16 a[76:79], v[12:15], v[60:63], a[76:79]
    v_mul_f32 v110, v110, v102
    v_mul_f32 v111, v111, v103
    v_mfma_f32_16x16x32_bf16 a[76:79], v[8:11], v[44:47], a[76:79]
    s_waitcnt lgkmcnt(2)
    v_cvt_pk_bf16_f32 v86, v108, v109
    v_mfma_f32_16x16x32_bf16 a[124:127], v[16:19], v[44:47], a[124:127]
    ds_read_b128 v[8:11], v2 offset:43008
    v_cvt_pk_bf16_f32 v87, v110, v111
    v_mfma_f32_16x16x32_bf16 a[124:127], v[20:23], v[60:63], a[124:127]
    v_lshlrev_b32 v104, 16, v88
    v_and_b32_e64 v105, s54, v88
    v_mfma_f32_16x16x32_bf16 a[28:31], v[20:23], v[56:59], a[28:31]
    v_lshlrev_b32_e64 v106, 16, v89
    v_mfma_f32_16x16x32_bf16 a[28:31], v[16:19], v[40:43], a[28:31]
    buffer_load_dwordx4 v1, s[32:35], s56 offen offset:2048 lds
    v_mfma_f32_16x16x32_bf16 a[120:123], v[16:19], v[36:39], a[120:123]
    ds_read_b128 v[12:15], v2 offset:44032
    v_and_b32_e64 v107, s54, v89
    v_mfma_f32_16x16x32_bf16 a[120:123], v[20:23], v[52:55], a[120:123]
    v_mul_f32_e64 v104, v104, v96
    v_mfma_f32_16x16x32_bf16 a[24:27], v[20:23], v[48:51], a[24:27]
    v_mul_f32 v105, v105, v97
    v_mul_f32 v106, v106, v98
    v_mfma_f32_16x16x32_bf16 a[24:27], v[16:19], v[32:35], a[24:27]
    s_waitcnt lgkmcnt(2)
    v_mul_f32 v107, v107, v99
    v_mfma_f32_16x16x32_bf16 a[172:175], v[24:27], v[32:35], a[172:175]
    ds_read_b128 v[16:19], v2 offset:45056
    v_cvt_pk_bf16_f32 v88, v104, v105
    v_mfma_f32_16x16x32_bf16 a[172:175], v[28:31], v[48:51], a[172:175]
    v_cvt_pk_bf16_f32 v89, v106, v107
    v_mfma_f32_16x16x32_bf16 a[80:83], v[28:31], v[52:55], a[80:83]
    v_lshlrev_b32 v108, 16, v90
    v_and_b32 v109, s54, v90
    v_mfma_f32_16x16x32_bf16 a[80:83], v[24:27], v[36:39], a[80:83]
    buffer_load_dwordx4 v1, s[32:35], s56 offen offset:3072 lds
    v_mfma_f32_16x16x32_bf16 a[176:179], v[24:27], v[40:43], a[176:179]
    ds_read_b128 v[20:23], v2 offset:46080
    v_lshlrev_b32_e64 v110, 16, v91
    v_mfma_f32_16x16x32_bf16 a[176:179], v[28:31], v[56:59], a[176:179]
    s_add_u32 s56, s56, 4096
    v_and_b32_e64 v111, s54, v91
    v_mfma_f32_16x16x32_bf16 a[84:87], v[28:31], v[60:63], a[84:87]
    v_mul_f32 v108, v108, v100
    v_mul_f32 v109, v109, v101
    v_mfma_f32_16x16x32_bf16 a[84:87], v[24:27], v[44:47], a[84:87]
    s_waitcnt lgkmcnt(2)
    v_mul_f32 v110, v110, v102
    v_mfma_f32_16x16x32_bf16 a[132:135], v[8:11], v[44:47], a[132:135]
    ds_read_b128 v[24:27], v2 offset:47104
    ds_read_b128 v[28:31], v2 offset:48128
    v_mfma_f32_16x16x32_bf16 a[132:135], v[12:15], v[60:63], a[132:135]
    v_mul_f32_e64 v111, v111, v103
    v_mfma_f32_16x16x32_bf16 a[36:39], v[12:15], v[56:59], a[36:39]
    v_cvt_pk_bf16_f32 v90, v108, v109
    v_cvt_pk_bf16_f32 v91, v110, v111
    v_mfma_f32_16x16x32_bf16 a[36:39], v[8:11], v[40:43], a[36:39]
    v_lshlrev_b32_e64 v104, 16, v92
    v_mfma_f32_16x16x32_bf16 a[128:131], v[8:11], v[36:39], a[128:131]
    v_and_b32 v105, s54, v92
    v_lshlrev_b32 v106, 16, v93
    v_mfma_f32_16x16x32_bf16 a[128:131], v[12:15], v[52:55], a[128:131]
    v_and_b32_e64 v107, s54, v93
    v_mfma_f32_16x16x32_bf16 a[32:35], v[12:15], v[48:51], a[32:35]
    s_add_u32 m0, s66, 73728
    v_mul_f32 v104, v104, v96
    v_mul_f32 v105, v105, v97
    v_mfma_f32_16x16x32_bf16 a[32:35], v[8:11], v[32:35], a[32:35]
    s_waitcnt vmcnt(15) lgkmcnt(0)
    s_barrier
    v_mfma_f32_16x16x32_bf16 a[180:183], v[16:19], v[32:35], a[180:183]
    ds_read_b128 v[8:11], v5 offset:0
    v_mul_f32_e64 v106, v106, v98
    v_mfma_f32_16x16x32_bf16 a[180:183], v[20:23], v[48:51], a[180:183]
    v_mul_f32_e64 v107, v107, v99
    v_mfma_f32_16x16x32_bf16 a[88:91], v[20:23], v[52:55], a[88:91]
    ds_read_b128 v[12:15], v5 offset:1024
    v_cvt_pk_bf16_f32 v92, v104, v105
    v_mfma_f32_16x16x32_bf16 a[88:91], v[16:19], v[36:39], a[88:91]
    buffer_load_dwordx4 v1, s[28:31], s59 offen offset:0 sc1 lds
    v_mfma_f32_16x16x32_bf16 a[184:187], v[16:19], v[40:43], a[184:187]
    v_cvt_pk_bf16_f32 v93, v106, v107
    v_mfma_f32_16x16x32_bf16 a[184:187], v[20:23], v[56:59], a[184:187]
    v_lshlrev_b32 v108, 16, v94
    v_and_b32 v109, s54, v94
    v_mfma_f32_16x16x32_bf16 a[92:95], v[20:23], v[60:63], a[92:95]
    v_lshlrev_b32_e64 v110, 16, v95
    v_mfma_f32_16x16x32_bf16 a[92:95], v[16:19], v[44:47], a[92:95]
    v_and_b32 v111, s54, v95
    v_mul_f32 v108, v108, v100
    v_mfma_f32_16x16x32_bf16 a[140:143], v[24:27], v[44:47], a[140:143]
    ds_read_b128 v[16:19], v5 offset:2048
    v_mfma_f32_16x16x32_bf16 a[140:143], v[28:31], v[60:63], a[140:143]
    v_mul_f32 v109, v109, v101
    v_mul_f32 v110, v110, v102
    v_mfma_f32_16x16x32_bf16 a[44:47], v[28:31], v[56:59], a[44:47]
    v_mul_f32_e64 v111, v111, v103
    v_mfma_f32_16x16x32_bf16 a[44:47], v[24:27], v[40:43], a[44:47]
    buffer_load_dwordx4 v1, s[28:31], s59 offen offset:1024 sc1 lds
    v_mfma_f32_16x16x32_bf16 a[136:139], v[24:27], v[36:39], a[136:139]
    ds_read_b128 v[20:23], v5 offset:3072
    v_cvt_pk_bf16_f32 v94, v108, v109
    v_mfma_f32_16x16x32_bf16 a[136:139], v[28:31], v[52:55], a[136:139]
    v_cvt_pk_bf16_f32 v95, v110, v111
    v_mfma_f32_16x16x32_bf16 a[40:43], v[28:31], v[48:51], a[40:43]
    v_mfma_f32_16x16x32_bf16 a[40:43], v[24:27], v[32:35], a[40:43]
    s_waitcnt lgkmcnt(2)
    v_mfma_f32_16x16x32_bf16 v[128:131], v[8:11], v[64:67], v[128:131]
    ds_read_b128 v[24:27], v5 offset:4096
    v_mfma_f32_16x16x32_bf16 v[128:131], v[12:15], v[80:83], v[128:131]
    buffer_load_dwordx4 v1, s[28:31], s59 offen offset:2048 sc1 lds
    v_mfma_f32_16x16x32_bf16 v[136:139], v[12:15], v[84:87], v[136:139]
    ds_read_b128 v[32:35], v6 offset:512
    ds_read_b128 v[36:39], v6 offset:528
    v_mfma_f32_16x16x32_bf16 v[136:139], v[8:11], v[68:71], v[136:139]
    ds_read_b64_tr_b16 v[96:97], v3 offset:16384
    ds_read_b64_tr_b16 v[98:99], v4 offset:16384
    v_mfma_f32_16x16x32_bf16 v[144:147], v[8:11], v[72:75], v[144:147]
    ds_read_b128 v[28:31], v5 offset:5120
    v_mfma_f32_16x16x32_bf16 v[144:147], v[12:15], v[88:91], v[144:147]
    s_add_u32 s59, s59, 3072
    v_mfma_f32_16x16x32_bf16 v[152:155], v[12:15], v[92:95], v[152:155]
    ds_read_b64_tr_b16 v[100:101], v4 offset:17408
    ds_read_b64_tr_b16 v[102:103], v3 offset:17408
    v_mfma_f32_16x16x32_bf16 v[152:155], v[8:11], v[76:79], v[152:155]
    s_waitcnt lgkmcnt(8)
    v_mfma_f32_16x16x32_bf16 v[156:159], v[16:19], v[76:79], v[156:159]
    ds_read_b128 v[8:11], v5 offset:6144
    v_mfma_f32_16x16x32_bf16 v[156:159], v[20:23], v[92:95], v[156:159]
    s_add_u32 m0, m0, 3072
    v_mfma_f32_16x16x32_bf16 v[148:151], v[20:23], v[88:91], v[148:151]
    ds_read_b64_tr_b16 v[104:105], v3 offset:18432
    ds_read_b64_tr_b16 v[106:107], v4 offset:18432
    v_mfma_f32_16x16x32_bf16 v[148:151], v[16:19], v[72:75], v[148:151]
    ds_read_b64_tr_b16 v[108:109], v4 offset:19456
    ds_read_b64_tr_b16 v[110:111], v3 offset:19456
    v_mfma_f32_16x16x32_bf16 v[140:143], v[16:19], v[68:71], v[140:143]
    ds_read_b128 v[12:15], v5 offset:7168
    v_mfma_f32_16x16x32_bf16 v[140:143], v[20:23], v[84:87], v[140:143]
    buffer_load_dwordx4 v1, s[28:31], s59 offen offset:0 sc1 lds
    v_mfma_f32_16x16x32_bf16 v[132:135], v[20:23], v[80:83], v[132:135]
    v_and_b32 v49, 7, v0
    v_lshlrev_b32 v49, 7, v49
    v_mfma_f32_16x16x32_bf16 v[132:135], v[16:19], v[64:67], v[132:135]
    s_waitcnt lgkmcnt(8)
    v_fmaak_f32 v32, v32, v7, 0x40088e99
    v_fmaak_f32 v33, v33, v7, 0x40088e99
    v_mfma_f32_16x16x32_bf16 v[160:163], v[24:27], v[64:67], v[160:163]
    ds_read_b128 v[16:19], v5 offset:8192
    v_fmaak_f32 v34, v34, v7, 0x40088e99
    v_mfma_f32_16x16x32_bf16 v[160:163], v[28:31], v[80:83], v[160:163]
    s_mov_b32 s67, 16384
    v_fmaak_f32 v35, v35, v7, 0x40088e99
    v_mfma_f32_16x16x32_bf16 v[168:171], v[28:31], v[84:87], v[168:171]
    v_fmaak_f32 v36, v36, v7, 0x40088e99
    v_fmaak_f32 v37, v37, v7, 0x40088e99
    v_mfma_f32_16x16x32_bf16 v[168:171], v[24:27], v[68:71], v[168:171]
    v_fmaak_f32 v38, v38, v7, 0x40088e99
    v_mfma_f32_16x16x32_bf16 v[176:179], v[24:27], v[72:75], v[176:179]
    ds_read_b128 v[20:23], v5 offset:9216
    v_fmaak_f32 v39, v39, v7, 0x40088e99
    v_mfma_f32_16x16x32_bf16 v[176:179], v[28:31], v[88:91], v[176:179]
    buffer_load_dwordx4 v1, s[28:31], s59 offen offset:1024 sc1 lds
    v_mfma_f32_16x16x32_bf16 v[184:187], v[28:31], v[92:95], v[184:187]
    v_lshlrev_b32 v40, 16, v96
    v_mfma_f32_16x16x32_bf16 v[184:187], v[24:27], v[76:79], v[184:187]
    s_waitcnt lgkmcnt(2)
    v_and_b32 v41, s54, v96
    v_lshlrev_b32_e64 v42, 16, v97
    v_mfma_f32_16x16x32_bf16 v[188:191], v[8:11], v[76:79], v[188:191]
    ds_read_b128 v[24:27], v5 offset:10240
    v_and_b32_e64 v43, s54, v97
    v_mfma_f32_16x16x32_bf16 v[188:191], v[12:15], v[92:95], v[188:191]
    v_mul_f32_e64 v40, v40, v32
    v_mfma_f32_16x16x32_bf16 v[180:183], v[12:15], v[88:91], v[180:183]
    v_mul_f32 v41, v41, v33
    v_mul_f32 v42, v42, v34
    v_mfma_f32_16x16x32_bf16 v[180:183], v[8:11], v[72:75], v[180:183]
    buffer_load_dword v48, v49, s[36:39], s67 offen sc1
    v_mfma_f32_16x16x32_bf16 v[172:175], v[8:11], v[68:71], v[172:175]
    ds_read_b128 v[28:31], v5 offset:11264
    v_mfma_f32_16x16x32_bf16 v[172:175], v[12:15], v[84:87], v[172:175]
    v_mul_f32_e64 v43, v43, v35
    v_cvt_pk_bf16_f32 v96, v40, v41
    v_mfma_f32_16x16x32_bf16 v[164:167], v[12:15], v[80:83], v[164:167]
    v_cvt_pk_bf16_f32 v97, v42, v43
    v_mfma_f32_16x16x32_bf16 v[164:167], v[8:11], v[64:67], v[164:167]
    s_waitcnt lgkmcnt(2)
    v_lshlrev_b32 v44, 16, v98
    v_and_b32_e64 v45, s54, v98
    v_mfma_f32_16x16x32_bf16 v[192:195], v[16:19], v[64:67], v[192:195]
    ds_read_b128 v[8:11], v5 offset:12288
    v_lshlrev_b32_e64 v46, 16, v99
    v_mfma_f32_16x16x32_bf16 v[192:195], v[20:23], v[80:83], v[192:195]
    buffer_load_dwordx4 v1, s[28:31], s59 offen offset:2048 sc1 lds
    v_mfma_f32_16x16x32_bf16 v[200:203], v[20:23], v[84:87], v[200:203]
    v_and_b32_e64 v47, s54, v99
    v_mfma_f32_16x16x32_bf16 v[200:203], v[16:19], v[68:71], v[200:203]
    v_mul_f32 v44, v44, v36
    v_mul_f32 v45, v45, v37
    v_mfma_f32_16x16x32_bf16 v[208:211], v[16:19], v[72:75], v[208:211]
    ds_read_b128 v[12:15], v5 offset:13312
    v_mfma_f32_16x16x32_bf16 v[208:211], v[20:23], v[88:91], v[208:211]
    s_add_u32 m0, s71, 16384
    v_mul_f32 v46, v46, v38
    v_mul_f32 v47, v47, v39
    v_mfma_f32_16x16x32_bf16 v[216:219], v[20:23], v[92:95], v[216:219]
    s_add_u32 s59, s59, 21504
    v_cvt_pk_bf16_f32 v98, v44, v45
    v_mfma_f32_16x16x32_bf16 v[216:219], v[16:19], v[76:79], v[216:219]
    s_waitcnt lgkmcnt(2)
    v_cvt_pk_bf16_f32 v99, v46, v47
    v_lshlrev_b32 v40, 16, v100
    v_mfma_f32_16x16x32_bf16 v[220:223], v[24:27], v[76:79], v[220:223]
    ds_read_b128 v[16:19], v5 offset:14336
    v_and_b32_e64 v41, s54, v100
    v_mfma_f32_16x16x32_bf16 v[220:223], v[28:31], v[92:95], v[220:223]
    v_lshlrev_b32_e64 v42, 16, v101
    v_mfma_f32_16x16x32_bf16 v[212:215], v[28:31], v[88:91], v[212:215]
    v_and_b32 v43, s54, v101
    v_mul_f32 v40, v40, v32
    v_mfma_f32_16x16x32_bf16 v[212:215], v[24:27], v[72:75], v[212:215]
    buffer_load_dwordx4 v1, s[32:35], s56 offen offset:0 lds
    v_mfma_f32_16x16x32_bf16 v[204:207], v[24:27], v[68:71], v[204:207]
    ds_read_b128 v[20:23], v5 offset:15360
    v_mfma_f32_16x16x32_bf16 v[204:207], v[28:31], v[84:87], v[204:207]
    v_mul_f32 v41, v41, v33
    v_mul_f32 v42, v42, v34
    v_mfma_f32_16x16x32_bf16 v[196:199], v[28:31], v[80:83], v[196:199]
    v_mul_f32_e64 v43, v43, v35
    v_mfma_f32_16x16x32_bf16 v[196:199], v[24:27], v[64:67], v[196:199]
    s_waitcnt lgkmcnt(2)
    v_cvt_pk_bf16_f32 v100, v40, v41
    v_cvt_pk_bf16_f32 v101, v42, v43
    v_mfma_f32_16x16x32_bf16 v[224:227], v[8:11], v[64:67], v[224:227]
    ds_read_b128 v[24:27], v5 offset:16384
    v_lshlrev_b32 v44, 16, v102
    v_mfma_f32_16x16x32_bf16 v[224:227], v[12:15], v[80:83], v[224:227]
    v_and_b32_e64 v45, s54, v102
    v_mfma_f32_16x16x32_bf16 v[232:235], v[12:15], v[84:87], v[232:235]
    v_lshlrev_b32 v46, 16, v103
    v_and_b32 v47, s54, v103
    v_mfma_f32_16x16x32_bf16 v[232:235], v[8:11], v[68:71], v[232:235]
    buffer_load_dwordx4 v1, s[32:35], s56 offen offset:1024 lds
    v_mfma_f32_16x16x32_bf16 v[240:243], v[8:11], v[72:75], v[240:243]
    ds_read_b128 v[28:31], v5 offset:17408
    v_mfma_f32_16x16x32_bf16 v[240:243], v[12:15], v[88:91], v[240:243]
    v_mul_f32 v44, v44, v36
    v_mul_f32 v45, v45, v37
    v_mfma_f32_16x16x32_bf16 v[248:251], v[12:15], v[92:95], v[248:251]
    v_mul_f32_e64 v46, v46, v38
    v_mfma_f32_16x16x32_bf16 v[248:251], v[8:11], v[76:79], v[248:251]
    s_waitcnt lgkmcnt(2)
    v_mul_f32 v47, v47, v39
    v_cvt_pk_bf16_f32 v102, v44, v45
    v_mfma_f32_16x16x32_bf16 v[252:255], v[16:19], v[76:79], v[252:255]
    ds_read_b128 v[8:11], v5 offset:18432
    v_mfma_f32_16x16x32_bf16 v[252:255], v[20:23], v[92:95], v[252:255]
    v_cvt_pk_bf16_f32 v103, v46, v47
    v_lshlrev_b32_e64 v40, 16, v104
    v_mfma_f32_16x16x32_bf16 v[244:247], v[20:23], v[88:91], v[244:247]
    v_and_b32_e64 v41, s54, v104
    v_mfma_f32_16x16x32_bf16 v[244:247], v[16:19], v[72:75], v[244:247]
    buffer_load_dwordx4 v1, s[32:35], s56 offen offset:2048 lds
    v_mfma_f32_16x16x32_bf16 v[236:239], v[16:19], v[68:71], v[236:239]
    ds_read_b128 v[12:15], v5 offset:19456
    v_lshlrev_b32_e64 v42, 16, v105
    v_mfma_f32_16x16x32_bf16 v[236:239], v[20:23], v[84:87], v[236:239]
    v_and_b32 v43, s54, v105
    v_mul_f32 v40, v40, v32
    v_mfma_f32_16x16x32_bf16 v[228:231], v[20:23], v[80:83], v[228:231]
    v_mul_f32_e64 v41, v41, v33
    v_mfma_f32_16x16x32_bf16 v[228:231], v[16:19], v[64:67], v[228:231]
    s_waitcnt lgkmcnt(2)
    v_mul_f32 v42, v42, v34
    v_mul_f32_e64 v43, v43, v35
    v_mfma_f32_16x16x32_bf16 a[192:195], v[24:27], v[64:67], a[192:195]
    ds_read_b128 v[16:19], v5 offset:20480
    v_mfma_f32_16x16x32_bf16 a[192:195], v[28:31], v[80:83], a[192:195]
    v_cvt_pk_bf16_f32 v104, v40, v41
    v_cvt_pk_bf16_f32 v105, v42, v43
    v_mfma_f32_16x16x32_bf16 a[200:203], v[28:31], v[84:87], a[200:203]
    v_lshlrev_b32_e64 v44, 16, v106
    v_mfma_f32_16x16x32_bf16 a[200:203], v[24:27], v[68:71], a[200:203]
    buffer_load_dwordx4 v1, s[32:35], s56 offen offset:3072 lds
    v_mfma_f32_16x16x32_bf16 a[208:211], v[24:27], v[72:75], a[208:211]
    ds_read_b128 v[20:23], v5 offset:21504
    v_and_b32_e64 v45, s54, v106
    v_mfma_f32_16x16x32_bf16 a[208:211], v[28:31], v[88:91], a[208:211]
    s_add_u32 s56, s56, 4096
    v_lshlrev_b32 v46, 16, v107
    v_and_b32 v47, s54, v107
    v_mfma_f32_16x16x32_bf16 a[216:219], v[28:31], v[92:95], a[216:219]
    v_mul_f32_e64 v44, v44, v36
    v_mfma_f32_16x16x32_bf16 a[216:219], v[24:27], v[76:79], a[216:219]
    s_waitcnt lgkmcnt(2)
    v_mul_f32 v45, v45, v37
    v_mul_f32_e64 v46, v46, v38
    v_mfma_f32_16x16x32_bf16 a[220:223], v[8:11], v[76:79], a[220:223]
    ds_read_b128 v[24:27], v5 offset:22528
    ds_read_b128 v[28:31], v5 offset:23552
    v_mfma_f32_16x16x32_bf16 a[220:223], v[12:15], v[92:95], a[220:223]
    v_mul_f32_e64 v47, v47, v39
    v_mfma_f32_16x16x32_bf16 a[212:215], v[12:15], v[88:91], a[212:215]
    v_cvt_pk_bf16_f32 v106, v44, v45
    v_cvt_pk_bf16_f32 v107, v46, v47
    v_mfma_f32_16x16x32_bf16 a[212:215], v[8:11], v[72:75], a[212:215]
    v_lshlrev_b32_e64 v40, 16, v108
    v_mfma_f32_16x16x32_bf16 a[204:207], v[8:11], v[68:71], a[204:207]
    v_and_b32 v41, s54, v108
    v_lshlrev_b32 v42, 16, v109
    v_mfma_f32_16x16x32_bf16 a[204:207], v[12:15], v[84:87], a[204:207]
    v_and_b32_e64 v43, s54, v109
    v_mfma_f32_16x16x32_bf16 a[196:199], v[12:15], v[80:83], a[196:199]
    s_add_u32 m0, s66, 98304
    v_mul_f32 v40, v40, v32
    v_mul_f32 v41, v41, v33
    v_mfma_f32_16x16x32_bf16 a[196:199], v[8:11], v[64:67], a[196:199]
    s_waitcnt vmcnt(15) lgkmcnt(0)
    s_barrier
    v_mfma_f32_16x16x32_bf16 a[224:227], v[16:19], v[64:67], a[224:227]
    ds_read_b128 v[8:11], v2 offset:0
    v_mfma_f32_16x16x32_bf16 a[224:227], v[20:23], v[80:83], a[224:227]
    v_mul_f32 v42, v42, v34
    v_mul_f32 v43, v43, v35
    v_mfma_f32_16x16x32_bf16 a[232:235], v[20:23], v[84:87], a[232:235]
    ds_read_b128 v[12:15], v2 offset:1024
    v_cvt_pk_bf16_f32 v108, v40, v41
    v_mfma_f32_16x16x32_bf16 a[232:235], v[16:19], v[68:71], a[232:235]
    buffer_load_dwordx4 v1, s[28:31], s59 offen offset:0 sc1 lds
    v_mfma_f32_16x16x32_bf16 a[240:243], v[16:19], v[72:75], a[240:243]
    v_cvt_pk_bf16_f32 v109, v42, v43
    v_mfma_f32_16x16x32_bf16 a[240:243], v[20:23], v[88:91], a[240:243]
    v_lshlrev_b32 v44, 16, v110
    v_and_b32 v45, s54, v110
    v_mfma_f32_16x16x32_bf16 a[248:251], v[20:23], v[92:95], a[248:251]
    v_lshlrev_b32_e64 v46, 16, v111
    v_mfma_f32_16x16x32_bf16 a[248:251], v[16:19], v[76:79], a[248:251]
    v_and_b32 v47, s54, v111
    v_mul_f32 v44, v44, v36
    v_mfma_f32_16x16x32_bf16 a[252:255], v[24:27], v[76:79], a[252:255]
    ds_read_b128 v[16:19], v2 offset:2048
    v_mfma_f32_16x16x32_bf16 a[252:255], v[28:31], v[92:95], a[252:255]
    v_mul_f32 v45, v45, v37
    v_mul_f32 v46, v46, v38
    v_mfma_f32_16x16x32_bf16 a[244:247], v[28:31], v[88:91], a[244:247]
    v_mul_f32_e64 v47, v47, v39
    v_mfma_f32_16x16x32_bf16 a[244:247], v[24:27], v[72:75], a[244:247]
    buffer_load_dwordx4 v1, s[28:31], s59 offen offset:1024 sc1 lds
    v_mfma_f32_16x16x32_bf16 a[236:239], v[24:27], v[68:71], a[236:239]
    ds_read_b128 v[20:23], v2 offset:3072
    v_cvt_pk_bf16_f32 v110, v44, v45
    v_mfma_f32_16x16x32_bf16 a[236:239], v[28:31], v[84:87], a[236:239]
    v_cvt_pk_bf16_f32 v111, v46, v47
    v_mfma_f32_16x16x32_bf16 a[228:231], v[28:31], v[80:83], a[228:231]
    v_mfma_f32_16x16x32_bf16 a[228:231], v[24:27], v[64:67], a[228:231]
    s_waitcnt lgkmcnt(2)
    v_mfma_f32_16x16x32_bf16 a[188:191], v[8:11], v[64:67], a[188:191]
    ds_read_b128 v[24:27], v2 offset:4096
    v_mfma_f32_16x16x32_bf16 a[188:191], v[12:15], v[80:83], a[188:191]
    buffer_load_dwordx4 v1, s[28:31], s59 offen offset:2048 sc1 lds
    v_mfma_f32_16x16x32_bf16 a[48:51], v[12:15], v[84:87], a[48:51]
    ds_read_b128 v[32:35], v6 offset:640
    ds_read_b128 v[36:39], v6 offset:656
    v_mfma_f32_16x16x32_bf16 a[48:51], v[8:11], v[68:71], a[48:51]
    ds_read_b64_tr_b16 v[112:113], v3 offset:32768
    ds_read_b64_tr_b16 v[114:115], v4 offset:32768
    v_mfma_f32_16x16x32_bf16 a[144:147], v[8:11], v[72:75], a[144:147]
    ds_read_b128 v[28:31], v2 offset:5120
    v_mfma_f32_16x16x32_bf16 a[144:147], v[12:15], v[88:91], a[144:147]
    s_add_u32 s59, s59, 3072
    v_mfma_f32_16x16x32_bf16 a[52:55], v[12:15], v[92:95], a[52:55]
    ds_read_b64_tr_b16 v[116:117], v4 offset:33792
    ds_read_b64_tr_b16 v[118:119], v3 offset:33792
    v_mfma_f32_16x16x32_bf16 a[52:55], v[8:11], v[76:79], a[52:55]
    s_waitcnt lgkmcnt(8)
    v_mfma_f32_16x16x32_bf16 a[100:103], v[16:19], v[76:79], a[100:103]
    ds_read_b128 v[8:11], v2 offset:6144
    v_mfma_f32_16x16x32_bf16 a[100:103], v[20:23], v[92:95], a[100:103]
    s_add_u32 m0, m0, 3072
    v_mfma_f32_16x16x32_bf16 a[4:7], v[20:23], v[88:91], a[4:7]
    ds_read_b64_tr_b16 v[120:121], v3 offset:34816
    ds_read_b64_tr_b16 v[122:123], v4 offset:34816
    v_mfma_f32_16x16x32_bf16 a[4:7], v[16:19], v[72:75], a[4:7]
    ds_read_b64_tr_b16 v[124:125], v4 offset:35840
    ds_read_b64_tr_b16 v[126:127], v3 offset:35840
    v_mfma_f32_16x16x32_bf16 a[96:99], v[16:19], v[68:71], a[96:99]
    ds_read_b128 v[12:15], v2 offset:7168
    v_mfma_f32_16x16x32_bf16 a[96:99], v[20:23], v[84:87], a[96:99]
    buffer_load_dwordx4 v1, s[28:31], s59 offen offset:0 sc1 lds
    v_mfma_f32_16x16x32_bf16 a[0:3], v[20:23], v[80:83], a[0:3]
    v_mfma_f32_16x16x32_bf16 a[0:3], v[16:19], v[64:67], a[0:3]
    s_waitcnt lgkmcnt(8)
    v_fmaak_f32 v32, v32, v7, 0x40088e99
    v_fmaak_f32 v33, v33, v7, 0x40088e99
    v_mfma_f32_16x16x32_bf16 a[148:151], v[24:27], v[64:67], a[148:151]
    ds_read_b128 v[16:19], v2 offset:8192
    v_fmaak_f32 v34, v34, v7, 0x40088e99
    v_mfma_f32_16x16x32_bf16 a[148:151], v[28:31], v[80:83], a[148:151]
    v_fmaak_f32 v35, v35, v7, 0x40088e99
    v_mfma_f32_16x16x32_bf16 a[56:59], v[28:31], v[84:87], a[56:59]
    v_fmaak_f32 v36, v36, v7, 0x40088e99
    v_fmaak_f32 v37, v37, v7, 0x40088e99
    v_mfma_f32_16x16x32_bf16 a[56:59], v[24:27], v[68:71], a[56:59]
    v_fmaak_f32 v38, v38, v7, 0x40088e99
    v_mfma_f32_16x16x32_bf16 a[152:155], v[24:27], v[72:75], a[152:155]
    ds_read_b128 v[20:23], v2 offset:9216
    v_fmaak_f32 v39, v39, v7, 0x40088e99
    v_mfma_f32_16x16x32_bf16 a[152:155], v[28:31], v[88:91], a[152:155]
    buffer_load_dwordx4 v1, s[28:31], s59 offen offset:1024 sc1 lds
    v_mfma_f32_16x16x32_bf16 a[60:63], v[28:31], v[92:95], a[60:63]
    v_lshlrev_b32 v40, 16, v112
    v_mfma_f32_16x16x32_bf16 a[60:63], v[24:27], v[76:79], a[60:63]
    s_waitcnt lgkmcnt(2)
    v_and_b32 v41, s54, v112
    v_lshlrev_b32_e64 v42, 16, v113
    v_mfma_f32_16x16x32_bf16 a[108:111], v[8:11], v[76:79], a[108:111]
    ds_read_b128 v[24:27], v2 offset:10240
    v_mfma_f32_16x16x32_bf16 a[108:111], v[12:15], v[92:95], a[108:111]
    v_and_b32 v43, s54, v113
    v_mul_f32 v40, v40, v32
    v_mfma_f32_16x16x32_bf16 a[12:15], v[12:15], v[88:91], a[12:15]
    v_mul_f32_e64 v41, v41, v33
    v_mfma_f32_16x16x32_bf16 a[12:15], v[8:11], v[72:75], a[12:15]
    v_mul_f32 v42, v42, v34
    v_mul_f32 v43, v43, v35
    v_mfma_f32_16x16x32_bf16 a[104:107], v[8:11], v[68:71], a[104:107]
    ds_read_b128 v[28:31], v2 offset:11264
    v_cvt_pk_bf16_f32 v112, v40, v41
    v_mfma_f32_16x16x32_bf16 a[104:107], v[12:15], v[84:87], a[104:107]
    v_cvt_pk_bf16_f32 v113, v42, v43
    v_mfma_f32_16x16x32_bf16 a[8:11], v[12:15], v[80:83], a[8:11]
    v_lshlrev_b32 v44, 16, v114
    v_and_b32 v45, s54, v114
    v_mfma_f32_16x16x32_bf16 a[8:11], v[8:11], v[64:67], a[8:11]
    s_waitcnt lgkmcnt(2)
    v_lshlrev_b32 v46, 16, v115
    v_mfma_f32_16x16x32_bf16 a[156:159], v[16:19], v[64:67], a[156:159]
    ds_read_b128 v[8:11], v2 offset:12288
    v_and_b32_e64 v47, s54, v115
    v_mfma_f32_16x16x32_bf16 a[156:159], v[20:23], v[80:83], a[156:159]
    buffer_load_dwordx4 v1, s[28:31], s59 offen offset:2048 sc1 lds
    v_mfma_f32_16x16x32_bf16 a[64:67], v[20:23], v[84:87], a[64:67]
    v_mul_f32_e64 v44, v44, v36
    v_mfma_f32_16x16x32_bf16 a[64:67], v[16:19], v[68:71], a[64:67]
    v_mul_f32 v45, v45, v37
    v_mul_f32 v46, v46, v38
    v_mfma_f32_16x16x32_bf16 a[160:163], v[16:19], v[72:75], a[160:163]
    ds_read_b128 v[12:15], v2 offset:13312
    v_mfma_f32_16x16x32_bf16 a[160:163], v[20:23], v[88:91], a[160:163]
    s_add_u32 m0, s71, 32768
    v_mul_f32_e64 v47, v47, v39
    v_cvt_pk_bf16_f32 v114, v44, v45
    v_mfma_f32_16x16x32_bf16 a[68:71], v[20:23], v[92:95], a[68:71]
    s_add_u32 s59, s59, 21504
    v_cvt_pk_bf16_f32 v115, v46, v47
    v_mfma_f32_16x16x32_bf16 a[68:71], v[16:19], v[76:79], a[68:71]
    s_waitcnt lgkmcnt(2)
    v_lshlrev_b32 v40, 16, v116
    v_and_b32_e64 v41, s54, v116
    v_mfma_f32_16x16x32_bf16 a[116:119], v[24:27], v[76:79], a[116:119]
    ds_read_b128 v[16:19], v2 offset:14336
    v_lshlrev_b32_e64 v42, 16, v117
    v_mfma_f32_16x16x32_bf16 a[116:119], v[28:31], v[92:95], a[116:119]
    v_and_b32_e64 v43, s54, v117
    v_mfma_f32_16x16x32_bf16 a[20:23], v[28:31], v[88:91], a[20:23]
    v_mul_f32_e64 v40, v40, v32
    v_mfma_f32_16x16x32_bf16 a[20:23], v[24:27], v[72:75], a[20:23]
    buffer_load_dwordx4 v1, s[32:35], s56 offen offset:0 lds
    v_mfma_f32_16x16x32_bf16 a[112:115], v[24:27], v[68:71], a[112:115]
    ds_read_b128 v[20:23], v2 offset:15360
    v_mul_f32_e64 v41, v41, v33
    v_mfma_f32_16x16x32_bf16 a[112:115], v[28:31], v[84:87], a[112:115]
    s_cmp_ge_u32 s59, 1179648
    v_mul_f32 v42, v42, v34
    v_mul_f32 v43, v43, v35
    v_mfma_f32_16x16x32_bf16 a[16:19], v[28:31], v[80:83], a[16:19]
    s_cselect_b32 s59, s66, s59
    v_cvt_pk_bf16_f32 v116, v40, v41
    v_mfma_f32_16x16x32_bf16 a[16:19], v[24:27], v[64:67], a[16:19]
    s_waitcnt lgkmcnt(2)
    v_cvt_pk_bf16_f32 v117, v42, v43
    v_lshlrev_b32_e64 v44, 16, v118
    v_mfma_f32_16x16x32_bf16 a[164:167], v[8:11], v[64:67], a[164:167]
    ds_read_b128 v[24:27], v2 offset:16384
    v_mfma_f32_16x16x32_bf16 a[164:167], v[12:15], v[80:83], a[164:167]
    s_add_u32 s28, s28, 2097152
    v_and_b32 v45, s54, v118
    v_lshlrev_b32 v46, 16, v119
    v_mfma_f32_16x16x32_bf16 a[72:75], v[12:15], v[84:87], a[72:75]
    s_addc_u32 s29, s29, 0
    v_and_b32 v47, s54, v119
    v_mfma_f32_16x16x32_bf16 a[72:75], v[8:11], v[68:71], a[72:75]
    buffer_load_dwordx4 v1, s[32:35], s56 offen offset:1024 lds
    v_mfma_f32_16x16x32_bf16 a[168:171], v[8:11], v[72:75], a[168:171]
    ds_read_b128 v[28:31], v2 offset:17408
    v_mul_f32_e64 v44, v44, v36
    v_mfma_f32_16x16x32_bf16 a[168:171], v[12:15], v[88:91], a[168:171]
    v_mul_f32_e64 v45, v45, v37
    v_mfma_f32_16x16x32_bf16 a[76:79], v[12:15], v[92:95], a[76:79]
    v_mul_f32 v46, v46, v38
    v_mul_f32 v47, v47, v39
    v_mfma_f32_16x16x32_bf16 a[76:79], v[8:11], v[76:79], a[76:79]
    s_waitcnt lgkmcnt(2)
    v_cvt_pk_bf16_f32 v118, v44, v45
    v_mfma_f32_16x16x32_bf16 a[124:127], v[16:19], v[76:79], a[124:127]
    ds_read_b128 v[8:11], v2 offset:18432
    v_cvt_pk_bf16_f32 v119, v46, v47
    v_mfma_f32_16x16x32_bf16 a[124:127], v[20:23], v[92:95], a[124:127]
    v_lshlrev_b32 v40, 16, v120
    v_and_b32_e64 v41, s54, v120
    v_mfma_f32_16x16x32_bf16 a[28:31], v[20:23], v[88:91], a[28:31]
    v_lshlrev_b32_e64 v42, 16, v121
    v_mfma_f32_16x16x32_bf16 a[28:31], v[16:19], v[72:75], a[28:31]
    buffer_load_dwordx4 v1, s[32:35], s56 offen offset:2048 lds
    v_mfma_f32_16x16x32_bf16 a[120:123], v[16:19], v[68:71], a[120:123]
    ds_read_b128 v[12:15], v2 offset:19456
    v_and_b32_e64 v43, s54, v121
    v_mfma_f32_16x16x32_bf16 a[120:123], v[20:23], v[84:87], a[120:123]
    v_mul_f32_e64 v40, v40, v32
    v_mfma_f32_16x16x32_bf16 a[24:27], v[20:23], v[80:83], a[24:27]
    v_mul_f32 v41, v41, v33
    v_mul_f32 v42, v42, v34
    v_mfma_f32_16x16x32_bf16 a[24:27], v[16:19], v[64:67], a[24:27]
    s_waitcnt lgkmcnt(2)
    v_mul_f32 v43, v43, v35
    v_mfma_f32_16x16x32_bf16 a[172:175], v[24:27], v[64:67], a[172:175]
    ds_read_b128 v[16:19], v2 offset:20480
    v_cvt_pk_bf16_f32 v120, v40, v41
    v_mfma_f32_16x16x32_bf16 a[172:175], v[28:31], v[80:83], a[172:175]
    v_cvt_pk_bf16_f32 v121, v42, v43
    v_mfma_f32_16x16x32_bf16 a[80:83], v[28:31], v[84:87], a[80:83]
    v_lshlrev_b32 v44, 16, v122
    v_and_b32 v45, s54, v122
    v_mfma_f32_16x16x32_bf16 a[80:83], v[24:27], v[68:71], a[80:83]
    buffer_load_dwordx4 v1, s[32:35], s56 offen offset:3072 lds
    v_mfma_f32_16x16x32_bf16 a[176:179], v[24:27], v[72:75], a[176:179]
    ds_read_b128 v[20:23], v2 offset:21504
    v_lshlrev_b32_e64 v46, 16, v123
    v_mfma_f32_16x16x32_bf16 a[176:179], v[28:31], v[88:91], a[176:179]
    s_add_u32 s56, s56, 4096
    v_and_b32_e64 v47, s54, v123
    v_mfma_f32_16x16x32_bf16 a[84:87], v[28:31], v[92:95], a[84:87]
    v_mul_f32 v44, v44, v36
    v_mul_f32 v45, v45, v37
    v_mfma_f32_16x16x32_bf16 a[84:87], v[24:27], v[76:79], a[84:87]
    s_waitcnt lgkmcnt(2)
    v_mul_f32 v46, v46, v38
    v_mfma_f32_16x16x32_bf16 a[132:135], v[8:11], v[76:79], a[132:135]
    ds_read_b128 v[24:27], v2 offset:22528
    ds_read_b128 v[28:31], v2 offset:23552
    v_mfma_f32_16x16x32_bf16 a[132:135], v[12:15], v[92:95], a[132:135]
    v_mul_f32_e64 v47, v47, v39
    v_mfma_f32_16x16x32_bf16 a[36:39], v[12:15], v[88:91], a[36:39]
    v_cvt_pk_bf16_f32 v122, v44, v45
    v_cvt_pk_bf16_f32 v123, v46, v47
    v_mfma_f32_16x16x32_bf16 a[36:39], v[8:11], v[72:75], a[36:39]
    v_lshlrev_b32_e64 v40, 16, v124
    v_mfma_f32_16x16x32_bf16 a[128:131], v[8:11], v[68:71], a[128:131]
    v_and_b32 v41, s54, v124
    v_lshlrev_b32 v42, 16, v125
    v_mfma_f32_16x16x32_bf16 a[128:131], v[12:15], v[84:87], a[128:131]
    v_and_b32_e64 v43, s54, v125
    v_mfma_f32_16x16x32_bf16 a[32:35], v[12:15], v[80:83], a[32:35]
    s_add_u32 m0, s66, 49152
    v_mul_f32 v40, v40, v32
    v_mul_f32 v41, v41, v33
    v_mfma_f32_16x16x32_bf16 a[32:35], v[8:11], v[64:67], a[32:35]
    s_waitcnt vmcnt(14) lgkmcnt(0)
    s_barrier
    v_cmp_gt_u32_e64 vcc, 18, v48
    v_mfma_f32_16x16x32_bf16 a[180:183], v[16:19], v[64:67], a[180:183]
    ds_read_b128 v[8:11], v2 offset:24576
    v_mul_f32_e64 v42, v42, v34
    v_mfma_f32_16x16x32_bf16 a[180:183], v[20:23], v[80:83], a[180:183]
    s_cbranch_vccnz L3_slow
L3_back:
    v_mul_f32 v43, v43, v35
    v_mfma_f32_16x16x32_bf16 a[88:91], v[20:23], v[84:87], a[88:91]
    ds_read_b128 v[12:15], v2 offset:25600
    v_cvt_pk_bf16_f32 v124, v40, v41
    v_mfma_f32_16x16x32_bf16 a[88:91], v[16:19], v[68:71], a[88:91]
    buffer_load_dwordx4 v1, s[28:31], s59 offen offset:0 sc1 lds
    v_mfma_f32_16x16x32_bf16 a[184:187], v[16:19], v[72:75], a[184:187]
    v_cvt_pk_bf16_f32 v125, v42, v43
    v_mfma_f32_16x16x32_bf16 a[184:187], v[20:23], v[88:91], a[184:187]
    v_lshlrev_b32 v44, 16, v126
    v_and_b32 v45, s54, v126
    v_mfma_f32_16x16x32_bf16 a[92:95], v[20:23], v[92:95], a[92:95]
    v_lshlrev_b32_e64 v46, 16, v127
    v_mfma_f32_16x16x32_bf16 a[92:95], v[16:19], v[76:79], a[92:95]
    v_and_b32 v47, s54, v127
    v_mul_f32 v44, v44, v36
    v_mfma_f32_16x16x32_bf16 a[140:143], v[24:27], v[76:79], a[140:143]
    ds_read_b128 v[16:19], v2 offset:26624
    v_mfma_f32_16x16x32_bf16 a[140:143], v[28:31], v[92:95], a[140:143]
    v_mul_f32 v45, v45, v37
    v_mul_f32 v46, v46, v38
    v_mfma_f32_16x16x32_bf16 a[44:47], v[28:31], v[88:91], a[44:47]
    v_mul_f32_e64 v47, v47, v39
    v_mfma_f32_16x16x32_bf16 a[44:47], v[24:27], v[72:75], a[44:47]
    buffer_load_dwordx4 v1, s[28:31], s59 offen offset:1024 sc1 lds
    v_mfma_f32_16x16x32_bf16 a[136:139], v[24:27], v[68:71], a[136:139]
    ds_read_b128 v[20:23], v2 offset:27648
    v_cvt_pk_bf16_f32 v126, v44, v45
    v_mfma_f32_16x16x32_bf16 a[136:139], v[28:31], v[84:87], a[136:139]
    v_cvt_pk_bf16_f32 v127, v46, v47
    v_mfma_f32_16x16x32_bf16 a[40:43], v[28:31], v[80:83], a[40:43]
    v_mfma_f32_16x16x32_bf16 a[40:43], v[24:27], v[64:67], a[40:43]
    s_waitcnt lgkmcnt(2)
    v_mfma_f32_16x16x32_bf16 v[128:131], v[8:11], v[96:99], v[128:131]
    ds_read_b128 v[24:27], v2 offset:28672
    v_mfma_f32_16x16x32_bf16 v[128:131], v[12:15], v[112:115], v[128:131]
    buffer_load_dwordx4 v1, s[28:31], s59 offen offset:2048 sc1 lds
    v_mfma_f32_16x16x32_bf16 v[136:139], v[12:15], v[116:119], v[136:139]
    ds_read_b64_tr_b16 v[32:33], v3 offset:0
    v_mfma_f32_16x16x32_bf16 v[136:139], v[8:11], v[100:103], v[136:139]
    ds_read_b64_tr_b16 v[34:35], v4 offset:0
    v_mfma_f32_16x16x32_bf16 v[144:147], v[8:11], v[104:107], v[144:147]
    ds_read_b128 v[28:31], v2 offset:29696
    v_mfma_f32_16x16x32_bf16 v[144:147], v[12:15], v[120:123], v[144:147]
    s_add_u32 s59, s59, 3072
    v_mfma_f32_16x16x32_bf16 v[152:155], v[12:15], v[124:127], v[152:155]
    ds_read_b64_tr_b16 v[36:37], v4 offset:1024
    v_mfma_f32_16x16x32_bf16 v[152:155], v[8:11], v[108:111], v[152:155]
    s_waitcnt lgkmcnt(5)
    v_mfma_f32_16x16x32_bf16 v[156:159], v[16:19], v[108:111], v[156:159]
    ds_read_b128 v[8:11], v2 offset:30720
    v_mfma_f32_16x16x32_bf16 v[156:159], v[20:23], v[124:127], v[156:159]
    s_add_u32 m0, m0, 3072
    v_mfma_f32_16x16x32_bf16 v[148:151], v[20:23], v[120:123], v[148:151]
    ds_read_b64_tr_b16 v[38:39], v3 offset:1024
    v_mfma_f32_16x16x32_bf16 v[148:151], v[16:19], v[104:107], v[148:151]
    ds_read_b64_tr_b16 v[40:41], v3 offset:2048
    v_mfma_f32_16x16x32_bf16 v[140:143], v[16:19], v[100:103], v[140:143]
    ds_read_b128 v[12:15], v2 offset:31744
    v_mfma_f32_16x16x32_bf16 v[140:143], v[20:23], v[116:119], v[140:143]
    buffer_load_dwordx4 v1, s[28:31], s59 offen offset:0 sc1 lds
    v_mfma_f32_16x16x32_bf16 v[132:135], v[20:23], v[112:115], v[132:135]
    ds_read_b64_tr_b16 v[42:43], v4 offset:2048
    v_mfma_f32_16x16x32_bf16 v[132:135], v[16:19], v[96:99], v[132:135]
    s_waitcnt lgkmcnt(6)
    v_mfma_f32_16x16x32_bf16 v[160:163], v[24:27], v[96:99], v[160:163]
    ds_read_b128 v[16:19], v2 offset:32768
    v_mfma_f32_16x16x32_bf16 v[160:163], v[28:31], v[112:115], v[160:163]
    ds_read_b64_tr_b16 v[44:45], v4 offset:3072
    v_mfma_f32_16x16x32_bf16 v[168:171], v[28:31], v[116:119], v[168:171]
    ds_read_b64_tr_b16 v[46:47], v3 offset:3072
    v_mfma_f32_16x16x32_bf16 v[168:171], v[24:27], v[100:103], v[168:171]
    v_mfma_f32_16x16x32_bf16 v[176:179], v[24:27], v[104:107], v[176:179]
    ds_read_b128 v[20:23], v2 offset:33792
    v_mfma_f32_16x16x32_bf16 v[176:179], v[28:31], v[120:123], v[176:179]
    buffer_load_dwordx4 v1, s[28:31], s59 offen offset:1024 sc1 lds
    v_mfma_f32_16x16x32_bf16 v[184:187], v[28:31], v[124:127], v[184:187]
    v_mfma_f32_16x16x32_bf16 v[184:187], v[24:27], v[108:111], v[184:187]
    s_waitcnt lgkmcnt(5)
    v_mfma_f32_16x16x32_bf16 v[188:191], v[8:11], v[108:111], v[188:191]
    ds_read_b128 v[24:27], v2 offset:34816
    v_mfma_f32_16x16x32_bf16 v[188:191], v[12:15], v[124:127], v[188:191]
    s_getpc_b64 s[22:23]
Lpc_L3_main:
    s_add_u32 s22, s22, L3_main-Lpc_L3_main
    s_addc_u32 s23, s23, 0
    v_lshlrev_b32 v80, 5, v0
    v_mov_b32 v81, s23
    v_add_co_u32 v80, vcc, s22, v80
    s_nop 1
    v_addc_co_u32_e64 v81, vcc, 0, v81, vcc
    global_load_dword v80, v[80:81], off
    v_mfma_f32_16x16x32_bf16 v[180:183], v[12:15], v[120:123], v[180:183]
    v_mfma_f32_16x16x32_bf16 v[180:183], v[8:11], v[104:107], v[180:183]
    v_mfma_f32_16x16x32_bf16 v[172:175], v[8:11], v[100:103], v[172:175]
    ds_read_b128 v[28:31], v2 offset:35840
    v_mfma_f32_16x16x32_bf16 v[172:175], v[12:15], v[116:119], v[172:175]
    v_mfma_f32_16x16x32_bf16 v[164:167], v[12:15], v[112:115], v[164:167]
    v_mfma_f32_16x16x32_bf16 v[164:167], v[8:11], v[96:99], v[164:167]
    s_waitcnt lgkmcnt(2)
    v_mfma_f32_16x16x32_bf16 v[192:195], v[16:19], v[96:99], v[192:195]
    ds_read_b128 v[8:11], v2 offset:36864
    v_mfma_f32_16x16x32_bf16 v[192:195], v[20:23], v[112:115], v[192:195]
    buffer_load_dwordx4 v1, s[28:31], s59 offen offset:2048 sc1 lds
    v_mfma_f32_16x16x32_bf16 v[200:203], v[20:23], v[116:119], v[200:203]
    v_mfma_f32_16x16x32_bf16 v[200:203], v[16:19], v[100:103], v[200:203]
    v_mfma_f32_16x16x32_bf16 v[208:211], v[16:19], v[104:107], v[208:211]
    ds_read_b128 v[12:15], v2 offset:37888
    v_mfma_f32_16x16x32_bf16 v[208:211], v[20:23], v[120:123], v[208:211]
    s_add_u32 m0, s71, 0
    v_mfma_f32_16x16x32_bf16 v[216:219], v[20:23], v[124:127], v[216:219]
    s_add_u32 s59, s59, 21504
    v_mfma_f32_16x16x32_bf16 v[216:219], v[16:19], v[108:111], v[216:219]
    s_waitcnt lgkmcnt(2)
    v_mfma_f32_16x16x32_bf16 v[220:223], v[24:27], v[108:111], v[220:223]
    ds_read_b128 v[16:19], v2 offset:38912
    v_mfma_f32_16x16x32_bf16 v[220:223], v[28:31], v[124:127], v[220:223]
    v_mfma_f32_16x16x32_bf16 v[212:215], v[28:31], v[120:123], v[212:215]
    v_mfma_f32_16x16x32_bf16 v[212:215], v[24:27], v[104:107], v[212:215]
    buffer_load_dwordx4 v1, s[32:35], s56 offen offset:0 lds
    v_mfma_f32_16x16x32_bf16 v[204:207], v[24:27], v[100:103], v[204:207]
    ds_read_b128 v[20:23], v2 offset:39936
    v_mfma_f32_16x16x32_bf16 v[204:207], v[28:31], v[116:119], v[204:207]
    v_mfma_f32_16x16x32_bf16 v[196:199], v[28:31], v[112:115], v[196:199]
    v_mfma_f32_16x16x32_bf16 v[196:199], v[24:27], v[96:99], v[196:199]
    s_waitcnt lgkmcnt(2)
    v_mfma_f32_16x16x32_bf16 v[224:227], v[8:11], v[96:99], v[224:227]
    ds_read_b128 v[24:27], v2 offset:40960
    v_mfma_f32_16x16x32_bf16 v[224:227], v[12:15], v[112:115], v[224:227]
    v_mfma_f32_16x16x32_bf16 v[232:235], v[12:15], v[116:119], v[232:235]
    v_mfma_f32_16x16x32_bf16 v[232:235], v[8:11], v[100:103], v[232:235]
    buffer_load_dwordx4 v1, s[32:35], s56 offen offset:1024 lds
    v_mfma_f32_16x16x32_bf16 v[240:243], v[8:11], v[104:107], v[240:243]
    ds_read_b128 v[28:31], v2 offset:41984
    v_mfma_f32_16x16x32_bf16 v[240:243], v[12:15], v[120:123], v[240:243]
    v_mfma_f32_16x16x32_bf16 v[248:251], v[12:15], v[124:127], v[248:251]
    v_mfma_f32_16x16x32_bf16 v[248:251], v[8:11], v[108:111], v[248:251]
    s_waitcnt lgkmcnt(2)
    v_mfma_f32_16x16x32_bf16 v[252:255], v[16:19], v[108:111], v[252:255]
    ds_read_b128 v[8:11], v2 offset:43008
    v_mfma_f32_16x16x32_bf16 v[252:255], v[20:23], v[124:127], v[252:255]
    v_mfma_f32_16x16x32_bf16 v[244:247], v[20:23], v[120:123], v[244:247]
    v_mfma_f32_16x16x32_bf16 v[244:247], v[16:19], v[104:107], v[244:247]
    buffer_load_dwordx4 v1, s[32:35], s56 offen offset:2048 lds
    v_mfma_f32_16x16x32_bf16 v[236:239], v[16:19], v[100:103], v[236:239]
    ds_read_b128 v[12:15], v2 offset:44032
    v_mfma_f32_16x16x32_bf16 v[236:239], v[20:23], v[116:119], v[236:239]
    v_mfma_f32_16x16x32_bf16 v[228:231], v[20:23], v[112:115], v[228:231]
    v_mfma_f32_16x16x32_bf16 v[228:231], v[16:19], v[96:99], v[228:231]
    s_waitcnt lgkmcnt(2)
    v_mfma_f32_16x16x32_bf16 a[192:195], v[24:27], v[96:99], a[192:195]
    ds_read_b128 v[16:19], v2 offset:45056
    v_mfma_f32_16x16x32_bf16 a[192:195], v[28:31], v[112:115], a[192:195]
    v_mfma_f32_16x16x32_bf16 a[200:203], v[28:31], v[116:119], a[200:203]
    v_mfma_f32_16x16x32_bf16 a[200:203], v[24:27], v[100:103], a[200:203]
    buffer_load_dwordx4 v1, s[32:35], s56 offen offset:3072 lds
    v_mfma_f32_16x16x32_bf16 a[208:211], v[24:27], v[104:107], a[208:211]
    ds_read_b128 v[20:23], v2 offset:46080
    v_mfma_f32_16x16x32_bf16 a[208:211], v[28:31], v[120:123], a[208:211]
    s_add_u32 s56, s56, 4096
    v_mfma_f32_16x16x32_bf16 a[216:219], v[28:31], v[124:127], a[216:219]
    v_mfma_f32_16x16x32_bf16 a[216:219], v[24:27], v[108:111], a[216:219]
    s_waitcnt lgkmcnt(2)
    v_mfma_f32_16x16x32_bf16 a[220:223], v[8:11], v[108:111], a[220:223]
    ds_read_b128 v[24:27], v2 offset:47104
    ds_read_b128 v[28:31], v2 offset:48128
    v_mfma_f32_16x16x32_bf16 a[220:223], v[12:15], v[124:127], a[220:223]
    v_mfma_f32_16x16x32_bf16 a[212:215], v[12:15], v[120:123], a[212:215]
    v_mfma_f32_16x16x32_bf16 a[212:215], v[8:11], v[104:107], a[212:215]
    v_mfma_f32_16x16x32_bf16 a[204:207], v[8:11], v[100:103], a[204:207]
    v_mfma_f32_16x16x32_bf16 a[204:207], v[12:15], v[116:119], a[204:207]
    v_mfma_f32_16x16x32_bf16 a[196:199], v[12:15], v[112:115], a[196:199]
    s_add_u32 m0, s66, 73728
    v_mfma_f32_16x16x32_bf16 a[196:199], v[8:11], v[96:99], a[196:199]
    s_waitcnt vmcnt(15) lgkmcnt(0)
    s_barrier
    v_mfma_f32_16x16x32_bf16 a[224:227], v[16:19], v[96:99], a[224:227]
    ds_read_b128 v[8:11], v5 offset:0
    v_mfma_f32_16x16x32_bf16 a[224:227], v[20:23], v[112:115], a[224:227]
    ds_read_b64_tr_b16 v[48:49], v3 offset:16384
    v_mfma_f32_16x16x32_bf16 a[232:235], v[20:23], v[116:119], a[232:235]
    ds_read_b128 v[12:15], v5 offset:1024
    v_mfma_f32_16x16x32_bf16 a[232:235], v[16:19], v[100:103], a[232:235]
    buffer_load_dwordx4 v1, s[28:31], s59 offen offset:0 sc1 lds
    v_mfma_f32_16x16x32_bf16 a[240:243], v[16:19], v[104:107], a[240:243]
    ds_read_b64_tr_b16 v[50:51], v4 offset:16384
    v_mfma_f32_16x16x32_bf16 a[240:243], v[20:23], v[120:123], a[240:243]
    ds_read_b64_tr_b16 v[52:53], v4 offset:17408
    v_mfma_f32_16x16x32_bf16 a[248:251], v[20:23], v[124:127], a[248:251]
    ds_read_b64_tr_b16 v[54:55], v3 offset:17408
    v_mfma_f32_16x16x32_bf16 a[248:251], v[16:19], v[108:111], a[248:251]
    v_mfma_f32_16x16x32_bf16 a[252:255], v[24:27], v[108:111], a[252:255]
    ds_read_b128 v[16:19], v5 offset:2048
    v_mfma_f32_16x16x32_bf16 a[252:255], v[28:31], v[124:127], a[252:255]
    ds_read_b64_tr_b16 v[56:57], v3 offset:18432
    v_mfma_f32_16x16x32_bf16 a[244:247], v[28:31], v[120:123], a[244:247]
    ds_read_b64_tr_b16 v[58:59], v4 offset:18432
    v_mfma_f32_16x16x32_bf16 a[244:247], v[24:27], v[104:107], a[244:247]
    buffer_load_dwordx4 v1, s[28:31], s59 offen offset:1024 sc1 lds
    v_mfma_f32_16x16x32_bf16 a[236:239], v[24:27], v[100:103], a[236:239]
    ds_read_b128 v[20:23], v5 offset:3072
    v_mfma_f32_16x16x32_bf16 a[236:239], v[28:31], v[116:119], a[236:239]
    ds_read_b64_tr_b16 v[60:61], v4 offset:19456
    v_mfma_f32_16x16x32_bf16 a[228:231], v[28:31], v[112:115], a[228:231]
    ds_read_b64_tr_b16 v[62:63], v3 offset:19456
    v_mfma_f32_16x16x32_bf16 a[228:231], v[24:27], v[96:99], a[228:231]
    s_waitcnt lgkmcnt(9)
    v_mfma_f32_16x16x32_bf16 a[188:191], v[8:11], v[96:99], a[188:191]
    ds_read_b128 v[24:27], v5 offset:4096
    v_mfma_f32_16x16x32_bf16 a[188:191], v[12:15], v[112:115], a[188:191]
    buffer_load_dwordx4 v1, s[28:31], s59 offen offset:2048 sc1 lds
    v_mfma_f32_16x16x32_bf16 a[48:51], v[12:15], v[116:119], a[48:51]
    v_mfma_f32_16x16x32_bf16 a[48:51], v[8:11], v[100:103], a[48:51]
    v_mfma_f32_16x16x32_bf16 a[144:147], v[8:11], v[104:107], a[144:147]
    ds_read_b128 v[28:31], v5 offset:5120
    v_mfma_f32_16x16x32_bf16 a[144:147], v[12:15], v[120:123], a[144:147]
    s_add_u32 s59, s59, 3072
    v_mfma_f32_16x16x32_bf16 a[52:55], v[12:15], v[124:127], a[52:55]
    v_mfma_f32_16x16x32_bf16 a[52:55], v[8:11], v[108:111], a[52:55]
    s_waitcnt lgkmcnt(4)
    v_mfma_f32_16x16x32_bf16 a[100:103], v[16:19], v[108:111], a[100:103]
    ds_read_b128 v[8:11], v5 offset:6144
    v_mfma_f32_16x16x32_bf16 a[100:103], v[20:23], v[124:127], a[100:103]
    s_add_u32 m0, m0, 3072
    v_mfma_f32_16x16x32_bf16 a[4:7], v[20:23], v[120:123], a[4:7]
    v_mfma_f32_16x16x32_bf16 a[4:7], v[16:19], v[104:107], a[4:7]
    v_mfma_f32_16x16x32_bf16 a[96:99], v[16:19], v[100:103], a[96:99]
    ds_read_b128 v[12:15], v5 offset:7168
    v_mfma_f32_16x16x32_bf16 a[96:99], v[20:23], v[116:119], a[96:99]
    buffer_load_dwordx4 v1, s[28:31], s59 offen offset:0 sc1 lds
    v_mfma_f32_16x16x32_bf16 a[0:3], v[20:23], v[112:115], a[0:3]
    v_mfma_f32_16x16x32_bf16 a[0:3], v[16:19], v[96:99], a[0:3]
    s_waitcnt lgkmcnt(2)
    v_mfma_f32_16x16x32_bf16 a[148:151], v[24:27], v[96:99], a[148:151]
    ds_read_b128 v[16:19], v5 offset:8192
    v_mfma_f32_16x16x32_bf16 a[148:151], v[28:31], v[112:115], a[148:151]
    v_mfma_f32_16x16x32_bf16 a[56:59], v[28:31], v[116:119], a[56:59]
    v_mfma_f32_16x16x32_bf16 a[56:59], v[24:27], v[100:103], a[56:59]
    s_waitcnt vmcnt(15)
    v_mfma_f32_16x16x32_bf16 a[152:155], v[24:27], v[104:107], a[152:155]
    ds_read_b128 v[20:23], v5 offset:9216
    v_mfma_f32_16x16x32_bf16 a[152:155], v[28:31], v[120:123], a[152:155]
    buffer_load_dwordx4 v1, s[28:31], s59 offen offset:1024 sc1 lds
    v_mfma_f32_16x16x32_bf16 a[60:63], v[28:31], v[124:127], a[60:63]
    ds_read_b64_tr_b16 v[64:65], v3 offset:32768
    ds_read_b64_tr_b16 v[66:67], v4 offset:32768
    v_mfma_f32_16x16x32_bf16 a[60:63], v[24:27], v[108:111], a[60:63]
    s_waitcnt lgkmcnt(4)
    v_mfma_f32_16x16x32_bf16 a[108:111], v[8:11], v[108:111], a[108:111]
    ds_read_b128 v[24:27], v5 offset:10240
    v_mfma_f32_16x16x32_bf16 a[108:111], v[12:15], v[124:127], a[108:111]
    ds_read_b64_tr_b16 v[68:69], v4 offset:33792
    ds_read_b64_tr_b16 v[70:71], v3 offset:33792
    v_mfma_f32_16x16x32_bf16 a[12:15], v[12:15], v[120:123], a[12:15]
    ds_read_b64_tr_b16 v[72:73], v3 offset:34816
    ds_read_b64_tr_b16 v[74:75], v4 offset:34816
    v_mfma_f32_16x16x32_bf16 a[12:15], v[8:11], v[104:107], a[12:15]
    ds_read_b64_tr_b16 v[76:77], v4 offset:35840
    ds_read_b64_tr_b16 v[78:79], v3 offset:35840
    v_mfma_f32_16x16x32_bf16 a[104:107], v[8:11], v[100:103], a[104:107]
    ds_read_b128 v[28:31], v5 offset:11264
    v_mfma_f32_16x16x32_bf16 a[104:107], v[12:15], v[116:119], a[104:107]
    v_mfma_f32_16x16x32_bf16 a[8:11], v[12:15], v[112:115], a[8:11]
    v_mfma_f32_16x16x32_bf16 a[8:11], v[8:11], v[96:99], a[8:11]
    s_waitcnt lgkmcnt(10)
    v_mfma_f32_16x16x32_bf16 a[156:159], v[16:19], v[96:99], a[156:159]
    ds_read_b128 v[8:11], v5 offset:12288
    v_mfma_f32_16x16x32_bf16 a[156:159], v[20:23], v[112:115], a[156:159]
    buffer_load_dwordx4 v1, s[28:31], s59 offen offset:2048 sc1 lds
    v_mfma_f32_16x16x32_bf16 a[64:67], v[20:23], v[116:119], a[64:67]
    v_mfma_f32_16x16x32_bf16 a[64:67], v[16:19], v[100:103], a[64:67]
    s_add_u32 m0, s71, 16384
    v_mfma_f32_16x16x32_bf16 a[160:163], v[16:19], v[104:107], a[160:163]
    ds_read_b128 v[12:15], v5 offset:13312
    v_mfma_f32_16x16x32_bf16 a[160:163], v[20:23], v[120:123], a[160:163]
    buffer_load_dwordx4 v1, s[32:35], s56 offen offset:0 lds
    v_mfma_f32_16x16x32_bf16 a[68:71], v[20:23], v[124:127], a[68:71]
    s_add_u32 s59, s59, 21504
    v_mfma_f32_16x16x32_bf16 a[68:71], v[16:19], v[108:111], a[68:71]
    s_waitcnt lgkmcnt(2)
    v_mfma_f32_16x16x32_bf16 a[116:119], v[24:27], v[108:111], a[116:119]
    ds_read_b128 v[16:19], v5 offset:14336
    v_mfma_f32_16x16x32_bf16 a[116:119], v[28:31], v[124:127], a[116:119]
    v_mfma_f32_16x16x32_bf16 a[20:23], v[28:31], v[120:123], a[20:23]
    v_mfma_f32_16x16x32_bf16 a[20:23], v[24:27], v[104:107], a[20:23]
    buffer_load_dwordx4 v1, s[32:35], s56 offen offset:1024 lds
    v_mfma_f32_16x16x32_bf16 a[112:115], v[24:27], v[100:103], a[112:115]
    ds_read_b128 v[20:23], v5 offset:15360
    v_mfma_f32_16x16x32_bf16 a[112:115], v[28:31], v[116:119], a[112:115]
    v_mfma_f32_16x16x32_bf16 a[16:19], v[28:31], v[112:115], a[16:19]
    v_mfma_f32_16x16x32_bf16 a[16:19], v[24:27], v[96:99], a[16:19]
    s_waitcnt lgkmcnt(2)
    v_mfma_f32_16x16x32_bf16 a[164:167], v[8:11], v[96:99], a[164:167]
    ds_read_b128 v[24:27], v5 offset:16384
    v_mfma_f32_16x16x32_bf16 a[164:167], v[12:15], v[112:115], a[164:167]
    buffer_load_dwordx4 v1, s[32:35], s56 offen offset:2048 lds
    v_mfma_f32_16x16x32_bf16 a[72:75], v[12:15], v[116:119], a[72:75]
    v_mfma_f32_16x16x32_bf16 a[72:75], v[8:11], v[100:103], a[72:75]
    v_mfma_f32_16x16x32_bf16 a[168:171], v[8:11], v[104:107], a[168:171]
    ds_read_b128 v[28:31], v5 offset:17408
    v_mfma_f32_16x16x32_bf16 a[168:171], v[12:15], v[120:123], a[168:171]
    buffer_load_dwordx4 v1, s[32:35], s56 offen offset:3072 lds
    v_mfma_f32_16x16x32_bf16 a[76:79], v[12:15], v[124:127], a[76:79]
    s_add_u32 s56, s56, 4096
    v_mfma_f32_16x16x32_bf16 a[76:79], v[8:11], v[108:111], a[76:79]
    s_waitcnt lgkmcnt(2)
    v_mfma_f32_16x16x32_bf16 a[124:127], v[16:19], v[108:111], a[124:127]
    ds_read_b128 v[8:11], v5 offset:18432
    v_mfma_f32_16x16x32_bf16 a[124:127], v[20:23], v[124:127], a[124:127]
    s_add_u32 m0, s71, 32768
    v_mfma_f32_16x16x32_bf16 a[28:31], v[20:23], v[120:123], a[28:31]
    v_mfma_f32_16x16x32_bf16 a[28:31], v[16:19], v[104:107], a[28:31]
    buffer_load_dwordx4 v1, s[32:35], s56 offen offset:0 lds
    v_mfma_f32_16x16x32_bf16 a[120:123], v[16:19], v[100:103], a[120:123]
    ds_read_b128 v[12:15], v5 offset:19456
    v_mfma_f32_16x16x32_bf16 a[120:123], v[20:23], v[116:119], a[120:123]
    v_mfma_f32_16x16x32_bf16 a[24:27], v[20:23], v[112:115], a[24:27]
    v_mfma_f32_16x16x32_bf16 a[24:27], v[16:19], v[96:99], a[24:27]
    s_waitcnt lgkmcnt(2)
    v_mfma_f32_16x16x32_bf16 a[172:175], v[24:27], v[96:99], a[172:175]
    ds_read_b128 v[16:19], v5 offset:20480
    v_mfma_f32_16x16x32_bf16 a[172:175], v[28:31], v[112:115], a[172:175]
    buffer_load_dwordx4 v1, s[32:35], s56 offen offset:1024 lds
    v_mfma_f32_16x16x32_bf16 a[80:83], v[28:31], v[116:119], a[80:83]
    v_mfma_f32_16x16x32_bf16 a[80:83], v[24:27], v[100:103], a[80:83]
    v_mfma_f32_16x16x32_bf16 a[176:179], v[24:27], v[104:107], a[176:179]
    ds_read_b128 v[20:23], v5 offset:21504
    v_mfma_f32_16x16x32_bf16 a[176:179], v[28:31], v[120:123], a[176:179]
    buffer_load_dwordx4 v1, s[32:35], s56 offen offset:2048 lds
    v_mfma_f32_16x16x32_bf16 a[84:87], v[28:31], v[124:127], a[84:87]
    v_mfma_f32_16x16x32_bf16 a[84:87], v[24:27], v[108:111], a[84:87]
    s_waitcnt lgkmcnt(2)
    v_mfma_f32_16x16x32_bf16 a[132:135], v[8:11], v[108:111], a[132:135]
    ds_read_b128 v[24:27], v5 offset:22528
    ds_read_b128 v[28:31], v5 offset:23552
    v_mfma_f32_16x16x32_bf16 a[132:135], v[12:15], v[124:127], a[132:135]
    buffer_load_dwordx4 v1, s[32:35], s56 offen offset:3072 lds
    v_mfma_f32_16x16x32_bf16 a[36:39], v[12:15], v[120:123], a[36:39]
    s_add_u32 s56, s56, 4096
    v_mfma_f32_16x16x32_bf16 a[36:39], v[8:11], v[104:107], a[36:39]
    s_cmp_ge_u32 s56, s75
    v_mfma_f32_16x16x32_bf16 a[128:131], v[8:11], v[100:103], a[128:131]
    s_cselect_b32 s56, s64, s56
    v_mfma_f32_16x16x32_bf16 a[128:131], v[12:15], v[116:119], a[128:131]
    v_mfma_f32_16x16x32_bf16 a[32:35], v[12:15], v[112:115], a[32:35]
    s_add_u32 m0, s66, 98304
    v_mfma_f32_16x16x32_bf16 a[32:35], v[8:11], v[96:99], a[32:35]
    s_waitcnt vmcnt(14) lgkmcnt(0)
    s_barrier
    v_mfma_f32_16x16x32_bf16 a[180:183], v[16:19], v[96:99], a[180:183]
    ds_read_b128 v[8:11], v2 offset:0
    v_mfma_f32_16x16x32_bf16 a[180:183], v[20:23], v[112:115], a[180:183]
    v_mfma_f32_16x16x32_bf16 a[88:91], v[20:23], v[116:119], a[88:91]
    ds_read_b128 v[12:15], v2 offset:1024
    v_mfma_f32_16x16x32_bf16 a[88:91], v[16:19], v[100:103], a[88:91]
    buffer_load_dwordx4 v1, s[28:31], s59 offen offset:0 sc1 lds
    v_mfma_f32_16x16x32_bf16 a[184:187], v[16:19], v[104:107], a[184:187]
    v_mfma_f32_16x16x32_bf16 a[184:187], v[20:23], v[120:123], a[184:187]
    v_mfma_f32_16x16x32_bf16 a[92:95], v[20:23], v[124:127], a[92:95]
    v_mfma_f32_16x16x32_bf16 a[92:95], v[16:19], v[108:111], a[92:95]
    v_mfma_f32_16x16x32_bf16 a[140:143], v[24:27], v[108:111], a[140:143]
    ds_read_b128 v[16:19], v2 offset:2048
    v_mfma_f32_16x16x32_bf16 a[140:143], v[28:31], v[124:127], a[140:143]
    v_mfma_f32_16x16x32_bf16 a[44:47], v[28:31], v[120:123], a[44:47]
    v_mfma_f32_16x16x32_bf16 a[44:47], v[24:27], v[104:107], a[44:47]
    buffer_load_dwordx4 v1, s[28:31], s59 offen offset:1024 sc1 lds
    v_mfma_f32_16x16x32_bf16 a[136:139], v[24:27], v[100:103], a[136:139]
    v_mfma_f32_16x16x32_bf16 a[136:139], v[28:31], v[116:119], a[136:139]
    v_mfma_f32_16x16x32_bf16 a[40:43], v[28:31], v[112:115], a[40:43]
    v_mfma_f32_16x16x32_bf16 a[40:43], v[24:27], v[96:99], a[40:43]
    s_waitcnt lgkmcnt(0)
.p2align 3
L3_main:
    v_mfma_f32_16x16x32_bf16 v[128:131], v[8:11], v[32:35], v[128:131]
    ds_read_b128 v[20:23], v2 offset:3072
    v_mfma_f32_16x16x32_bf16 v[128:131], v[12:15], v[48:51], v[128:131]
    ds_read_b128 v[24:27], v2 offset:4096
    v_mfma_f32_16x16x32_bf16 v[128:131], v[16:19], v[64:67], v[128:131]
    buffer_load_dwordx4 v1, s[28:31], s59 offen offset:2048 sc1 lds
    v_mfma_f32_16x16x32_bf16 v[136:139], v[16:19], v[68:71], v[136:139]
    ds_read_b128 v[28:31], v2 offset:5120
    v_mfma_f32_16x16x32_bf16 v[136:139], v[12:15], v[52:55], v[136:139]
    s_add_u32 s59, s59, 3072
    v_mfma_f32_16x16x32_bf16 v[136:139], v[8:11], v[36:39], v[136:139]
    ds_read_b64_tr_b16 v[80:81], v3 offset:0
    v_mfma_f32_16x16x32_bf16 v[144:147], v[8:11], v[40:43], v[144:147]
    s_add_u32 m0, m0, 3072
    v_mfma_f32_16x16x32_bf16 v[144:147], v[12:15], v[56:59], v[144:147]
    ds_read_b64_tr_b16 v[82:83], v4 offset:0
    v_mfma_f32_16x16x32_bf16 v[144:147], v[16:19], v[72:75], v[144:147]
    ds_read_b64_tr_b16 v[84:85], v4 offset:1024
    v_mfma_f32_16x16x32_bf16 v[152:155], v[16:19], v[76:79], v[152:155]
    ds_read_b64_tr_b16 v[86:87], v3 offset:1024
    v_mfma_f32_16x16x32_bf16 v[152:155], v[12:15], v[60:63], v[152:155]
    ds_read_b64_tr_b16 v[88:89], v3 offset:2048
    v_mfma_f32_16x16x32_bf16 v[152:155], v[8:11], v[44:47], v[152:155]
    s_waitcnt lgkmcnt(5)
    v_mfma_f32_16x16x32_bf16 v[156:159], v[20:23], v[44:47], v[156:159]
    ds_read_b128 v[8:11], v2 offset:6144
    v_mfma_f32_16x16x32_bf16 v[156:159], v[24:27], v[60:63], v[156:159]
    ds_read_b128 v[12:15], v2 offset:7168
    v_mfma_f32_16x16x32_bf16 v[156:159], v[28:31], v[76:79], v[156:159]
    buffer_load_dwordx4 v1, s[28:31], s59 offen offset:0 sc1 lds
    v_mfma_f32_16x16x32_bf16 v[148:151], v[28:31], v[72:75], v[148:151]
    ds_read_b128 v[16:19], v2 offset:8192
    v_mfma_f32_16x16x32_bf16 v[148:151], v[24:27], v[56:59], v[148:151]
    ds_read_b64_tr_b16 v[90:91], v4 offset:2048
    v_mfma_f32_16x16x32_bf16 v[148:151], v[20:23], v[40:43], v[148:151]
    ds_read_b64_tr_b16 v[92:93], v4 offset:3072
    v_mfma_f32_16x16x32_bf16 v[140:143], v[20:23], v[36:39], v[140:143]
    ds_read_b64_tr_b16 v[94:95], v3 offset:3072
    v_mfma_f32_16x16x32_bf16 v[140:143], v[24:27], v[52:55], v[140:143]
    v_mfma_f32_16x16x32_bf16 v[140:143], v[28:31], v[68:71], v[140:143]
    buffer_load_dwordx4 v1, s[28:31], s59 offen offset:1024 sc1 lds
    v_mfma_f32_16x16x32_bf16 v[132:135], v[28:31], v[64:67], v[132:135]
    v_mfma_f32_16x16x32_bf16 v[132:135], v[24:27], v[48:51], v[132:135]
    v_mfma_f32_16x16x32_bf16 v[132:135], v[20:23], v[32:35], v[132:135]
    s_waitcnt lgkmcnt(3)
    v_mfma_f32_16x16x32_bf16 v[160:163], v[8:11], v[32:35], v[160:163]
    ds_read_b128 v[20:23], v2 offset:9216
    v_mfma_f32_16x16x32_bf16 v[160:163], v[12:15], v[48:51], v[160:163]
    ds_read_b128 v[24:27], v2 offset:10240
    v_mfma_f32_16x16x32_bf16 v[160:163], v[16:19], v[64:67], v[160:163]
    v_mfma_f32_16x16x32_bf16 v[168:171], v[16:19], v[68:71], v[168:171]
    ds_read_b128 v[28:31], v2 offset:11264
    v_mfma_f32_16x16x32_bf16 v[168:171], v[12:15], v[52:55], v[168:171]
    v_mfma_f32_16x16x32_bf16 v[168:171], v[8:11], v[36:39], v[168:171]
    v_mfma_f32_16x16x32_bf16 v[176:179], v[8:11], v[40:43], v[176:179]
    v_mfma_f32_16x16x32_bf16 v[176:179], v[12:15], v[56:59], v[176:179]
    v_mfma_f32_16x16x32_bf16 v[176:179], v[16:19], v[72:75], v[176:179]
    buffer_load_dwordx4 v1, s[28:31], s59 offen offset:2048 sc1 lds
    v_mfma_f32_16x16x32_bf16 v[184:187], v[16:19], v[76:79], v[184:187]
    s_add_u32 s59, s59, 21504
    v_mfma_f32_16x16x32_bf16 v[184:187], v[12:15], v[60:63], v[184:187]
    v_mfma_f32_16x16x32_bf16 v[184:187], v[8:11], v[44:47], v[184:187]
    s_waitcnt lgkmcnt(0)
    v_mfma_f32_16x16x32_bf16 v[188:191], v[20:23], v[44:47], v[188:191]
    ds_read_b128 v[8:11], v2 offset:12288
    v_mfma_f32_16x16x32_bf16 v[188:191], v[24:27], v[60:63], v[188:191]
    ds_read_b128 v[12:15], v2 offset:13312
    v_mfma_f32_16x16x32_bf16 v[188:191], v[28:31], v[76:79], v[188:191]
    s_add_u32 m0, s71, 0
    v_mfma_f32_16x16x32_bf16 v[180:183], v[28:31], v[72:75], v[180:183]
    ds_read_b128 v[16:19], v2 offset:14336
    v_mfma_f32_16x16x32_bf16 v[180:183], v[24:27], v[56:59], v[180:183]
    v_mfma_f32_16x16x32_bf16 v[180:183], v[20:23], v[40:43], v[180:183]
    buffer_load_dwordx4 v1, s[32:35], s56 offen offset:0 nt lds
    v_mfma_f32_16x16x32_bf16 v[172:175], v[20:23], v[36:39], v[172:175]
    v_mfma_f32_16x16x32_bf16 v[172:175], v[24:27], v[52:55], v[172:175]
    v_mfma_f32_16x16x32_bf16 v[172:175], v[28:31], v[68:71], v[172:175]
    v_mfma_f32_16x16x32_bf16 v[164:167], v[28:31], v[64:67], v[164:167]
    v_mfma_f32_16x16x32_bf16 v[164:167], v[24:27], v[48:51], v[164:167]
    v_mfma_f32_16x16x32_bf16 v[164:167], v[20:23], v[32:35], v[164:167]
    s_waitcnt lgkmcnt(0)
    v_mfma_f32_16x16x32_bf16 v[192:195], v[8:11], v[32:35], v[192:195]
    ds_read_b128 v[20:23], v2 offset:15360
    v_mfma_f32_16x16x32_bf16 v[192:195], v[12:15], v[48:51], v[192:195]
    ds_read_b128 v[24:27], v2 offset:16384
    v_mfma_f32_16x16x32_bf16 v[192:195], v[16:19], v[64:67], v[192:195]
    buffer_load_dwordx4 v1, s[32:35], s56 offen offset:1024 lds
    v_mfma_f32_16x16x32_bf16 v[200:203], v[16:19], v[68:71], v[200:203]
    ds_read_b128 v[28:31], v2 offset:17408
    v_mfma_f32_16x16x32_bf16 v[200:203], v[12:15], v[52:55], v[200:203]
    v_mfma_f32_16x16x32_bf16 v[200:203], v[8:11], v[36:39], v[200:203]
    v_mfma_f32_16x16x32_bf16 v[208:211], v[8:11], v[40:43], v[208:211]
    v_mfma_f32_16x16x32_bf16 v[208:211], v[12:15], v[56:59], v[208:211]
    v_mfma_f32_16x16x32_bf16 v[208:211], v[16:19], v[72:75], v[208:211]
    v_mfma_f32_16x16x32_bf16 v[216:219], v[16:19], v[76:79], v[216:219]
    v_mfma_f32_16x16x32_bf16 v[216:219], v[12:15], v[60:63], v[216:219]
    v_mfma_f32_16x16x32_bf16 v[216:219], v[8:11], v[44:47], v[216:219]
    s_waitcnt lgkmcnt(0)
    v_mfma_f32_16x16x32_bf16 v[220:223], v[20:23], v[44:47], v[220:223]
    ds_read_b128 v[8:11], v2 offset:18432
    v_mfma_f32_16x16x32_bf16 v[220:223], v[24:27], v[60:63], v[220:223]
    ds_read_b128 v[12:15], v2 offset:19456
    v_mfma_f32_16x16x32_bf16 v[220:223], v[28:31], v[76:79], v[220:223]
    buffer_load_dwordx4 v1, s[32:35], s56 offen offset:2048 lds
    v_mfma_f32_16x16x32_bf16 v[212:215], v[28:31], v[72:75], v[212:215]
    ds_read_b128 v[16:19], v2 offset:20480
    v_mfma_f32_16x16x32_bf16 v[212:215], v[24:27], v[56:59], v[212:215]
    v_mfma_f32_16x16x32_bf16 v[212:215], v[20:23], v[40:43], v[212:215]
    v_mfma_f32_16x16x32_bf16 v[204:207], v[20:23], v[36:39], v[204:207]
    v_mfma_f32_16x16x32_bf16 v[204:207], v[24:27], v[52:55], v[204:207]
    v_mfma_f32_16x16x32_bf16 v[204:207], v[28:31], v[68:71], v[204:207]
    buffer_load_dwordx4 v1, s[32:35], s56 offen offset:3072 lds
    v_mfma_f32_16x16x32_bf16 v[196:199], v[28:31], v[64:67], v[196:199]
    s_add_u32 s56, s56, 4096
    v_mfma_f32_16x16x32_bf16 v[196:199], v[24:27], v[48:51], v[196:199]
    v_mfma_f32_16x16x32_bf16 v[196:199], v[20:23], v[32:35], v[196:199]
    s_waitcnt lgkmcnt(0)
    v_mfma_f32_16x16x32_bf16 v[224:227], v[8:11], v[32:35], v[224:227]
    ds_read_b128 v[20:23], v2 offset:21504
    v_mfma_f32_16x16x32_bf16 v[224:227], v[12:15], v[48:51], v[224:227]
    ds_read_b128 v[24:27], v2 offset:22528
    v_mfma_f32_16x16x32_bf16 v[224:227], v[16:19], v[64:67], v[224:227]
    v_mfma_f32_16x16x32_bf16 v[232:235], v[16:19], v[68:71], v[232:235]
    ds_read_b128 v[28:31], v2 offset:23552
    v_mfma_f32_16x16x32_bf16 v[232:235], v[12:15], v[52:55], v[232:235]
    v_mfma_f32_16x16x32_bf16 v[232:235], v[8:11], v[36:39], v[232:235]
    v_mfma_f32_16x16x32_bf16 v[240:243], v[8:11], v[40:43], v[240:243]
    v_mfma_f32_16x16x32_bf16 v[240:243], v[12:15], v[56:59], v[240:243]
    v_mfma_f32_16x16x32_bf16 v[240:243], v[16:19], v[72:75], v[240:243]
    s_add_u32 m0, s66, 49152
    v_mfma_f32_16x16x32_bf16 v[248:251], v[16:19], v[76:79], v[248:251]
    v_mfma_f32_16x16x32_bf16 v[248:251], v[12:15], v[60:63], v[248:251]
    v_mfma_f32_16x16x32_bf16 v[248:251], v[8:11], v[44:47], v[248:251]
    s_waitcnt vmcnt(14) lgkmcnt(0)
    s_barrier
    v_mfma_f32_16x16x32_bf16 v[252:255], v[20:23], v[44:47], v[252:255]
    ds_read_b128 v[8:11], v2 offset:24576
    v_mfma_f32_16x16x32_bf16 v[252:255], v[24:27], v[60:63], v[252:255]
    ds_read_b128 v[12:15], v2 offset:25600
    v_mfma_f32_16x16x32_bf16 v[252:255], v[28:31], v[76:79], v[252:255]
    buffer_load_dwordx4 v1, s[28:31], s59 offen offset:0 sc1 lds
    v_mfma_f32_16x16x32_bf16 v[244:247], v[28:31], v[72:75], v[244:247]
    ds_read_b128 v[16:19], v2 offset:26624
    v_mfma_f32_16x16x32_bf16 v[244:247], v[24:27], v[56:59], v[244:247]
    v_mfma_f32_16x16x32_bf16 v[244:247], v[20:23], v[40:43], v[244:247]
    v_mfma_f32_16x16x32_bf16 v[236:239], v[20:23], v[36:39], v[236:239]
    v_mfma_f32_16x16x32_bf16 v[236:239], v[24:27], v[52:55], v[236:239]
    v_mfma_f32_16x16x32_bf16 v[236:239], v[28:31], v[68:71], v[236:239]
    buffer_load_dwordx4 v1, s[28:31], s59 offen offset:1024 sc1 lds
    v_mfma_f32_16x16x32_bf16 v[228:231], v[28:31], v[64:67], v[228:231]
    v_mfma_f32_16x16x32_bf16 v[228:231], v[24:27], v[48:51], v[228:231]
    v_mfma_f32_16x16x32_bf16 v[228:231], v[20:23], v[32:35], v[228:231]
    s_waitcnt lgkmcnt(0)
    v_mfma_f32_16x16x32_bf16 a[192:195], v[8:11], v[32:35], a[192:195]
    ds_read_b128 v[20:23], v2 offset:27648
    v_mfma_f32_16x16x32_bf16 a[192:195], v[12:15], v[48:51], a[192:195]
    ds_read_b128 v[24:27], v2 offset:28672
    v_mfma_f32_16x16x32_bf16 a[192:195], v[16:19], v[64:67], a[192:195]
    buffer_load_dwordx4 v1, s[28:31], s59 offen offset:2048 sc1 lds
    v_mfma_f32_16x16x32_bf16 a[200:203], v[16:19], v[68:71], a[200:203]
    ds_read_b128 v[28:31], v2 offset:29696
    v_mfma_f32_16x16x32_bf16 a[200:203], v[12:15], v[52:55], a[200:203]
    s_add_u32 s59, s59, 3072
    v_mfma_f32_16x16x32_bf16 a[200:203], v[8:11], v[36:39], a[200:203]
    ds_read_b64_tr_b16 v[96:97], v3 offset:16384
    v_mfma_f32_16x16x32_bf16 a[208:211], v[8:11], v[40:43], a[208:211]
    s_add_u32 m0, m0, 3072
    v_mfma_f32_16x16x32_bf16 a[208:211], v[12:15], v[56:59], a[208:211]
    ds_read_b64_tr_b16 v[98:99], v4 offset:16384
    v_mfma_f32_16x16x32_bf16 a[208:211], v[16:19], v[72:75], a[208:211]
    ds_read_b64_tr_b16 v[100:101], v4 offset:17408
    v_mfma_f32_16x16x32_bf16 a[216:219], v[16:19], v[76:79], a[216:219]
    ds_read_b64_tr_b16 v[102:103], v3 offset:17408
    v_mfma_f32_16x16x32_bf16 a[216:219], v[12:15], v[60:63], a[216:219]
    ds_read_b64_tr_b16 v[104:105], v3 offset:18432
    v_mfma_f32_16x16x32_bf16 a[216:219], v[8:11], v[44:47], a[216:219]
    s_waitcnt lgkmcnt(5)
    v_mfma_f32_16x16x32_bf16 a[220:223], v[20:23], v[44:47], a[220:223]
    ds_read_b128 v[8:11], v2 offset:30720
    v_mfma_f32_16x16x32_bf16 a[220:223], v[24:27], v[60:63], a[220:223]
    ds_read_b128 v[12:15], v2 offset:31744
    v_mfma_f32_16x16x32_bf16 a[220:223], v[28:31], v[76:79], a[220:223]
    buffer_load_dwordx4 v1, s[28:31], s59 offen offset:0 sc1 lds
    v_mfma_f32_16x16x32_bf16 a[212:215], v[28:31], v[72:75], a[212:215]
    ds_read_b128 v[16:19], v2 offset:32768
    v_mfma_f32_16x16x32_bf16 a[212:215], v[24:27], v[56:59], a[212:215]
    ds_read_b64_tr_b16 v[106:107], v4 offset:18432
    v_mfma_f32_16x16x32_bf16 a[212:215], v[20:23], v[40:43], a[212:215]
    ds_read_b64_tr_b16 v[108:109], v4 offset:19456
    v_mfma_f32_16x16x32_bf16 a[204:207], v[20:23], v[36:39], a[204:207]
    ds_read_b64_tr_b16 v[110:111], v3 offset:19456
    v_mfma_f32_16x16x32_bf16 a[204:207], v[24:27], v[52:55], a[204:207]
    v_mfma_f32_16x16x32_bf16 a[204:207], v[28:31], v[68:71], a[204:207]
    buffer_load_dwordx4 v1, s[28:31], s59 offen offset:1024 sc1 lds
    v_mfma_f32_16x16x32_bf16 a[196:199], v[28:31], v[64:67], a[196:199]
    v_mfma_f32_16x16x32_bf16 a[196:199], v[24:27], v[48:51], a[196:199]
    v_mfma_f32_16x16x32_bf16 a[196:199], v[20:23], v[32:35], a[196:199]
    s_waitcnt lgkmcnt(3)
    v_mfma_f32_16x16x32_bf16 a[224:227], v[8:11], v[32:35], a[224:227]
    ds_read_b128 v[20:23], v2 offset:33792
    v_mfma_f32_16x16x32_bf16 a[224:227], v[12:15], v[48:51], a[224:227]
    ds_read_b128 v[24:27], v2 offset:34816
    v_mfma_f32_16x16x32_bf16 a[224:227], v[16:19], v[64:67], a[224:227]
    v_mfma_f32_16x16x32_bf16 a[232:235], v[16:19], v[68:71], a[232:235]
    ds_read_b128 v[28:31], v2 offset:35840
    v_mfma_f32_16x16x32_bf16 a[232:235], v[12:15], v[52:55], a[232:235]
    v_mfma_f32_16x16x32_bf16 a[232:235], v[8:11], v[36:39], a[232:235]
    v_mfma_f32_16x16x32_bf16 a[240:243], v[8:11], v[40:43], a[240:243]
    v_mfma_f32_16x16x32_bf16 a[240:243], v[12:15], v[56:59], a[240:243]
    v_mfma_f32_16x16x32_bf16 a[240:243], v[16:19], v[72:75], a[240:243]
    buffer_load_dwordx4 v1, s[28:31], s59 offen offset:2048 sc1 lds
    v_mfma_f32_16x16x32_bf16 a[248:251], v[16:19], v[76:79], a[248:251]
    s_add_u32 s59, s59, 21504
    v_mfma_f32_16x16x32_bf16 a[248:251], v[12:15], v[60:63], a[248:251]
    v_mfma_f32_16x16x32_bf16 a[248:251], v[8:11], v[44:47], a[248:251]
    s_waitcnt lgkmcnt(0)
    v_mfma_f32_16x16x32_bf16 a[252:255], v[20:23], v[44:47], a[252:255]
    ds_read_b128 v[8:11], v2 offset:36864
    v_mfma_f32_16x16x32_bf16 a[252:255], v[24:27], v[60:63], a[252:255]
    ds_read_b128 v[12:15], v2 offset:37888
    v_mfma_f32_16x16x32_bf16 a[252:255], v[28:31], v[76:79], a[252:255]
    s_add_u32 m0, s71, 16384
    v_mfma_f32_16x16x32_bf16 a[244:247], v[28:31], v[72:75], a[244:247]
    ds_read_b128 v[16:19], v2 offset:38912
    v_mfma_f32_16x16x32_bf16 a[244:247], v[24:27], v[56:59], a[244:247]
    v_mfma_f32_16x16x32_bf16 a[244:247], v[20:23], v[40:43], a[244:247]
    buffer_load_dwordx4 v1, s[32:35], s56 offen offset:0 nt lds
    v_mfma_f32_16x16x32_bf16 a[236:239], v[20:23], v[36:39], a[236:239]
    v_mfma_f32_16x16x32_bf16 a[236:239], v[24:27], v[52:55], a[236:239]
    v_mfma_f32_16x16x32_bf16 a[236:239], v[28:31], v[68:71], a[236:239]
    v_mfma_f32_16x16x32_bf16 a[228:231], v[28:31], v[64:67], a[228:231]
    v_mfma_f32_16x16x32_bf16 a[228:231], v[24:27], v[48:51], a[228:231]
    v_mfma_f32_16x16x32_bf16 a[228:231], v[20:23], v[32:35], a[228:231]
    s_waitcnt lgkmcnt(0)
    v_mfma_f32_16x16x32_bf16 a[188:191], v[8:11], v[32:35], a[188:191]
    ds_read_b128 v[20:23], v2 offset:39936
    v_mfma_f32_16x16x32_bf16 a[188:191], v[12:15], v[48:51], a[188:191]
    ds_read_b128 v[24:27], v2 offset:40960
    v_mfma_f32_16x16x32_bf16 a[188:191], v[16:19], v[64:67], a[188:191]
    buffer_load_dwordx4 v1, s[32:35], s56 offen offset:1024 lds
    v_mfma_f32_16x16x32_bf16 a[48:51], v[16:19], v[68:71], a[48:51]
    ds_read_b128 v[28:31], v2 offset:41984
    v_mfma_f32_16x16x32_bf16 a[48:51], v[12:15], v[52:55], a[48:51]
    v_mfma_f32_16x16x32_bf16 a[48:51], v[8:11], v[36:39], a[48:51]
    v_mfma_f32_16x16x32_bf16 a[144:147], v[8:11], v[40:43], a[144:147]
    v_mfma_f32_16x16x32_bf16 a[144:147], v[12:15], v[56:59], a[144:147]
    v_mfma_f32_16x16x32_bf16 a[144:147], v[16:19], v[72:75], a[144:147]
    v_mfma_f32_16x16x32_bf16 a[52:55], v[16:19], v[76:79], a[52:55]
    v_mfma_f32_16x16x32_bf16 a[52:55], v[12:15], v[60:63], a[52:55]
    v_mfma_f32_16x16x32_bf16 a[52:55], v[8:11], v[44:47], a[52:55]
    s_waitcnt lgkmcnt(0)
    v_mfma_f32_16x16x32_bf16 a[100:103], v[20:23], v[44:47], a[100:103]
    ds_read_b128 v[8:11], v2 offset:43008
    v_mfma_f32_16x16x32_bf16 a[100:103], v[24:27], v[60:63], a[100:103]
    ds_read_b128 v[12:15], v2 offset:44032
    v_mfma_f32_16x16x32_bf16 a[100:103], v[28:31], v[76:79], a[100:103]
    buffer_load_dwordx4 v1, s[32:35], s56 offen offset:2048 lds
    v_mfma_f32_16x16x32_bf16 a[4:7], v[28:31], v[72:75], a[4:7]
    ds_read_b128 v[16:19], v2 offset:45056
    v_mfma_f32_16x16x32_bf16 a[4:7], v[24:27], v[56:59], a[4:7]
    v_mfma_f32_16x16x32_bf16 a[4:7], v[20:23], v[40:43], a[4:7]
    v_mfma_f32_16x16x32_bf16 a[96:99], v[20:23], v[36:39], a[96:99]
    v_mfma_f32_16x16x32_bf16 a[96:99], v[24:27], v[52:55], a[96:99]
    v_mfma_f32_16x16x32_bf16 a[96:99], v[28:31], v[68:71], a[96:99]
    buffer_load_dwordx4 v1, s[32:35], s56 offen offset:3072 lds
    v_mfma_f32_16x16x32_bf16 a[0:3], v[28:31], v[64:67], a[0:3]
    s_add_u32 s56, s56, 4096
    v_mfma_f32_16x16x32_bf16 a[0:3], v[24:27], v[48:51], a[0:3]
    v_mfma_f32_16x16x32_bf16 a[0:3], v[20:23], v[32:35], a[0:3]
    s_waitcnt lgkmcnt(0)
    v_mfma_f32_16x16x32_bf16 a[148:151], v[8:11], v[32:35], a[148:151]
    ds_read_b128 v[20:23], v2 offset:46080
    v_mfma_f32_16x16x32_bf16 a[148:151], v[12:15], v[48:51], a[148:151]
    ds_read_b128 v[24:27], v2 offset:47104
    v_mfma_f32_16x16x32_bf16 a[148:151], v[16:19], v[64:67], a[148:151]
    v_mfma_f32_16x16x32_bf16 a[56:59], v[16:19], v[68:71], a[56:59]
    ds_read_b128 v[28:31], v2 offset:48128
    v_mfma_f32_16x16x32_bf16 a[56:59], v[12:15], v[52:55], a[56:59]
    v_mfma_f32_16x16x32_bf16 a[56:59], v[8:11], v[36:39], a[56:59]
    v_mfma_f32_16x16x32_bf16 a[152:155], v[8:11], v[40:43], a[152:155]
    v_mfma_f32_16x16x32_bf16 a[152:155], v[12:15], v[56:59], a[152:155]
    v_mfma_f32_16x16x32_bf16 a[152:155], v[16:19], v[72:75], a[152:155]
    s_add_u32 m0, s66, 73728
    v_mfma_f32_16x16x32_bf16 a[60:63], v[16:19], v[76:79], a[60:63]
    v_mfma_f32_16x16x32_bf16 a[60:63], v[12:15], v[60:63], a[60:63]
    v_mfma_f32_16x16x32_bf16 a[60:63], v[8:11], v[44:47], a[60:63]
    s_waitcnt vmcnt(14) lgkmcnt(0)
    s_barrier
    v_mfma_f32_16x16x32_bf16 a[108:111], v[20:23], v[44:47], a[108:111]
    ds_read_b128 v[8:11], v5 offset:0
    v_mfma_f32_16x16x32_bf16 a[108:111], v[24:27], v[60:63], a[108:111]
    ds_read_b128 v[12:15], v5 offset:1024
    v_mfma_f32_16x16x32_bf16 a[108:111], v[28:31], v[76:79], a[108:111]
    buffer_load_dwordx4 v1, s[28:31], s59 offen offset:0 sc1 lds
    v_mfma_f32_16x16x32_bf16 a[12:15], v[28:31], v[72:75], a[12:15]
    ds_read_b128 v[16:19], v5 offset:2048
    v_mfma_f32_16x16x32_bf16 a[12:15], v[24:27], v[56:59], a[12:15]
    v_mfma_f32_16x16x32_bf16 a[12:15], v[20:23], v[40:43], a[12:15]
    v_mfma_f32_16x16x32_bf16 a[104:107], v[20:23], v[36:39], a[104:107]
    v_mfma_f32_16x16x32_bf16 a[104:107], v[24:27], v[52:55], a[104:107]
    v_mfma_f32_16x16x32_bf16 a[104:107], v[28:31], v[68:71], a[104:107]
    buffer_load_dwordx4 v1, s[28:31], s59 offen offset:1024 sc1 lds
    v_mfma_f32_16x16x32_bf16 a[8:11], v[28:31], v[64:67], a[8:11]
    v_mfma_f32_16x16x32_bf16 a[8:11], v[24:27], v[48:51], a[8:11]
    v_mfma_f32_16x16x32_bf16 a[8:11], v[20:23], v[32:35], a[8:11]
    s_waitcnt lgkmcnt(0)
    v_mfma_f32_16x16x32_bf16 a[156:159], v[8:11], v[32:35], a[156:159]
    ds_read_b128 v[20:23], v5 offset:3072
    v_mfma_f32_16x16x32_bf16 a[156:159], v[12:15], v[48:51], a[156:159]
    ds_read_b128 v[24:27], v5 offset:4096
    v_mfma_f32_16x16x32_bf16 a[156:159], v[16:19], v[64:67], a[156:159]
    buffer_load_dwordx4 v1, s[28:31], s59 offen offset:2048 sc1 lds
    v_mfma_f32_16x16x32_bf16 a[64:67], v[16:19], v[68:71], a[64:67]
    ds_read_b128 v[28:31], v5 offset:5120
    v_mfma_f32_16x16x32_bf16 a[64:67], v[12:15], v[52:55], a[64:67]
    s_add_u32 s59, s59, 3072
    v_mfma_f32_16x16x32_bf16 a[64:67], v[8:11], v[36:39], a[64:67]
    ds_read_b64_tr_b16 v[112:113], v3 offset:32768
    v_mfma_f32_16x16x32_bf16 a[160:163], v[8:11], v[40:43], a[160:163]
    s_add_u32 m0, m0, 3072
    v_mfma_f32_16x16x32_bf16 a[160:163], v[12:15], v[56:59], a[160:163]
    ds_read_b64_tr_b16 v[114:115], v4 offset:32768
    v_mfma_f32_16x16x32_bf16 a[160:163], v[16:19], v[72:75], a[160:163]
    ds_read_b64_tr_b16 v[116:117], v4 offset:33792
    v_mfma_f32_16x16x32_bf16 a[68:71], v[16:19], v[76:79], a[68:71]
    ds_read_b64_tr_b16 v[118:119], v3 offset:33792
    v_mfma_f32_16x16x32_bf16 a[68:71], v[12:15], v[60:63], a[68:71]
    ds_read_b64_tr_b16 v[120:121], v3 offset:34816
    v_mfma_f32_16x16x32_bf16 a[68:71], v[8:11], v[44:47], a[68:71]
    s_waitcnt lgkmcnt(5)
    v_mfma_f32_16x16x32_bf16 a[116:119], v[20:23], v[44:47], a[116:119]
    ds_read_b128 v[8:11], v5 offset:6144
    v_mfma_f32_16x16x32_bf16 a[116:119], v[24:27], v[60:63], a[116:119]
    ds_read_b128 v[12:15], v5 offset:7168
    v_mfma_f32_16x16x32_bf16 a[116:119], v[28:31], v[76:79], a[116:119]
    buffer_load_dwordx4 v1, s[28:31], s59 offen offset:0 sc1 lds
    v_mfma_f32_16x16x32_bf16 a[20:23], v[28:31], v[72:75], a[20:23]
    ds_read_b128 v[16:19], v5 offset:8192
    v_mfma_f32_16x16x32_bf16 a[20:23], v[24:27], v[56:59], a[20:23]
    ds_read_b64_tr_b16 v[122:123], v4 offset:34816
    v_mfma_f32_16x16x32_bf16 a[20:23], v[20:23], v[40:43], a[20:23]
    ds_read_b64_tr_b16 v[124:125], v4 offset:35840
    v_mfma_f32_16x16x32_bf16 a[112:115], v[20:23], v[36:39], a[112:115]
    ds_read_b64_tr_b16 v[126:127], v3 offset:35840
    v_mfma_f32_16x16x32_bf16 a[112:115], v[24:27], v[52:55], a[112:115]
    v_mfma_f32_16x16x32_bf16 a[112:115], v[28:31], v[68:71], a[112:115]
    buffer_load_dwordx4 v1, s[28:31], s59 offen offset:1024 sc1 lds
    v_mfma_f32_16x16x32_bf16 a[16:19], v[28:31], v[64:67], a[16:19]
    v_mfma_f32_16x16x32_bf16 a[16:19], v[24:27], v[48:51], a[16:19]
    v_mfma_f32_16x16x32_bf16 a[16:19], v[20:23], v[32:35], a[16:19]
    s_waitcnt lgkmcnt(3)
    v_mfma_f32_16x16x32_bf16 a[164:167], v[8:11], v[32:35], a[164:167]
    ds_read_b128 v[20:23], v5 offset:9216
    v_mfma_f32_16x16x32_bf16 a[164:167], v[12:15], v[48:51], a[164:167]
    ds_read_b128 v[24:27], v5 offset:10240
    v_mfma_f32_16x16x32_bf16 a[164:167], v[16:19], v[64:67], a[164:167]
    v_mfma_f32_16x16x32_bf16 a[72:75], v[16:19], v[68:71], a[72:75]
    ds_read_b128 v[28:31], v5 offset:11264
    v_mfma_f32_16x16x32_bf16 a[72:75], v[12:15], v[52:55], a[72:75]
    v_mfma_f32_16x16x32_bf16 a[72:75], v[8:11], v[36:39], a[72:75]
    v_mfma_f32_16x16x32_bf16 a[168:171], v[8:11], v[40:43], a[168:171]
    v_mfma_f32_16x16x32_bf16 a[168:171], v[12:15], v[56:59], a[168:171]
    v_mfma_f32_16x16x32_bf16 a[168:171], v[16:19], v[72:75], a[168:171]
    buffer_load_dwordx4 v1, s[28:31], s59 offen offset:2048 sc1 lds
    v_mfma_f32_16x16x32_bf16 a[76:79], v[16:19], v[76:79], a[76:79]
    s_add_u32 s59, s59, 21504
    v_mfma_f32_16x16x32_bf16 a[76:79], v[12:15], v[60:63], a[76:79]
    v_mfma_f32_16x16x32_bf16 a[76:79], v[8:11], v[44:47], a[76:79]
    s_waitcnt lgkmcnt(0)
    v_mfma_f32_16x16x32_bf16 a[124:127], v[20:23], v[44:47], a[124:127]
    ds_read_b128 v[8:11], v5 offset:12288
    v_mfma_f32_16x16x32_bf16 a[124:127], v[24:27], v[60:63], a[124:127]
    ds_read_b128 v[12:15], v5 offset:13312
    v_mfma_f32_16x16x32_bf16 a[124:127], v[28:31], v[76:79], a[124:127]
    s_add_u32 m0, s71, 32768
    v_mfma_f32_16x16x32_bf16 a[28:31], v[28:31], v[72:75], a[28:31]
    ds_read_b128 v[16:19], v5 offset:14336
    v_mfma_f32_16x16x32_bf16 a[28:31], v[24:27], v[56:59], a[28:31]
    v_mfma_f32_16x16x32_bf16 a[28:31], v[20:23], v[40:43], a[28:31]
    buffer_load_dwordx4 v1, s[32:35], s56 offen offset:0 nt lds
    v_mfma_f32_16x16x32_bf16 a[120:123], v[20:23], v[36:39], a[120:123]
    v_mfma_f32_16x16x32_bf16 a[120:123], v[24:27], v[52:55], a[120:123]
    v_mfma_f32_16x16x32_bf16 a[120:123], v[28:31], v[68:71], a[120:123]
    v_mfma_f32_16x16x32_bf16 a[24:27], v[28:31], v[64:67], a[24:27]
    v_mfma_f32_16x16x32_bf16 a[24:27], v[24:27], v[48:51], a[24:27]
    v_mfma_f32_16x16x32_bf16 a[24:27], v[20:23], v[32:35], a[24:27]
    s_waitcnt lgkmcnt(0)
    v_mfma_f32_16x16x32_bf16 a[172:175], v[8:11], v[32:35], a[172:175]
    ds_read_b128 v[20:23], v5 offset:15360
    v_mfma_f32_16x16x32_bf16 a[172:175], v[12:15], v[48:51], a[172:175]
    ds_read_b128 v[24:27], v5 offset:16384
    v_mfma_f32_16x16x32_bf16 a[172:175], v[16:19], v[64:67], a[172:175]
    buffer_load_dwordx4 v1, s[32:35], s56 offen offset:1024 lds
    v_mfma_f32_16x16x32_bf16 a[80:83], v[16:19], v[68:71], a[80:83]
    ds_read_b128 v[28:31], v5 offset:17408
    v_mfma_f32_16x16x32_bf16 a[80:83], v[12:15], v[52:55], a[80:83]
    v_mfma_f32_16x16x32_bf16 a[80:83], v[8:11], v[36:39], a[80:83]
    v_mfma_f32_16x16x32_bf16 a[176:179], v[8:11], v[40:43], a[176:179]
    v_mfma_f32_16x16x32_bf16 a[176:179], v[12:15], v[56:59], a[176:179]
    v_mfma_f32_16x16x32_bf16 a[176:179], v[16:19], v[72:75], a[176:179]
    v_mfma_f32_16x16x32_bf16 a[84:87], v[16:19], v[76:79], a[84:87]
    v_mfma_f32_16x16x32_bf16 a[84:87], v[12:15], v[60:63], a[84:87]
    v_mfma_f32_16x16x32_bf16 a[84:87], v[8:11], v[44:47], a[84:87]
    s_waitcnt lgkmcnt(0)
    v_mfma_f32_16x16x32_bf16 a[132:135], v[20:23], v[44:47], a[132:135]
    ds_read_b128 v[8:11], v5 offset:18432
    v_mfma_f32_16x16x32_bf16 a[132:135], v[24:27], v[60:63], a[132:135]
    ds_read_b128 v[12:15], v5 offset:19456
    v_mfma_f32_16x16x32_bf16 a[132:135], v[28:31], v[76:79], a[132:135]
    buffer_load_dwordx4 v1, s[32:35], s56 offen offset:2048 lds
    v_mfma_f32_16x16x32_bf16 a[36:39], v[28:31], v[72:75], a[36:39]
    ds_read_b128 v[16:19], v5 offset:20480
    v_mfma_f32_16x16x32_bf16 a[36:39], v[24:27], v[56:59], a[36:39]
    v_mfma_f32_16x16x32_bf16 a[36:39], v[20:23], v[40:43], a[36:39]
    v_mfma_f32_16x16x32_bf16 a[128:131], v[20:23], v[36:39], a[128:131]
    v_mfma_f32_16x16x32_bf16 a[128:131], v[24:27], v[52:55], a[128:131]
    v_mfma_f32_16x16x32_bf16 a[128:131], v[28:31], v[68:71], a[128:131]
    buffer_load_dwordx4 v1, s[32:35], s56 offen offset:3072 lds
    v_mfma_f32_16x16x32_bf16 a[32:35], v[28:31], v[64:67], a[32:35]
    s_add_u32 s56, s56, 4096
    v_mfma_f32_16x16x32_bf16 a[32:35], v[24:27], v[48:51], a[32:35]
    v_mfma_f32_16x16x32_bf16 a[32:35], v[20:23], v[32:35], a[32:35]
    s_waitcnt lgkmcnt(0)
    v_mfma_f32_16x16x32_bf16 a[180:183], v[8:11], v[32:35], a[180:183]
    ds_read_b128 v[20:23], v5 offset:21504
    v_mfma_f32_16x16x32_bf16 a[180:183], v[12:15], v[48:51], a[180:183]
    ds_read_b128 v[24:27], v5 offset:22528
    v_mfma_f32_16x16x32_bf16 a[180:183], v[16:19], v[64:67], a[180:183]
    v_mfma_f32_16x16x32_bf16 a[88:91], v[16:19], v[68:71], a[88:91]
    ds_read_b128 v[28:31], v5 offset:23552
    v_mfma_f32_16x16x32_bf16 a[88:91], v[12:15], v[52:55], a[88:91]
    v_mfma_f32_16x16x32_bf16 a[88:91], v[8:11], v[36:39], a[88:91]
    v_mfma_f32_16x16x32_bf16 a[184:187], v[8:11], v[40:43], a[184:187]
    v_mfma_f32_16x16x32_bf16 a[184:187], v[12:15], v[56:59], a[184:187]
    v_mfma_f32_16x16x32_bf16 a[184:187], v[16:19], v[72:75], a[184:187]
    s_add_u32 m0, s66, 98304
    v_mfma_f32_16x16x32_bf16 a[92:95], v[16:19], v[76:79], a[92:95]
    v_mfma_f32_16x16x32_bf16 a[92:95], v[12:15], v[60:63], a[92:95]
    v_mfma_f32_16x16x32_bf16 a[92:95], v[8:11], v[44:47], a[92:95]
    s_waitcnt vmcnt(14) lgkmcnt(0)
    s_barrier
    v_mfma_f32_16x16x32_bf16 a[140:143], v[20:23], v[44:47], a[140:143]
    ds_read_b128 v[8:11], v2 offset:0
    v_mfma_f32_16x16x32_bf16 a[140:143], v[24:27], v[60:63], a[140:143]
    ds_read_b128 v[12:15], v2 offset:1024
    v_mfma_f32_16x16x32_bf16 a[140:143], v[28:31], v[76:79], a[140:143]
    buffer_load_dwordx4 v1, s[28:31], s59 offen offset:0 sc1 lds
    v_mfma_f32_16x16x32_bf16 a[44:47], v[28:31], v[72:75], a[44:47]
    ds_read_b128 v[16:19], v2 offset:2048
    v_mfma_f32_16x16x32_bf16 a[44:47], v[24:27], v[56:59], a[44:47]
    v_mfma_f32_16x16x32_bf16 a[44:47], v[20:23], v[40:43], a[44:47]
    v_mfma_f32_16x16x32_bf16 a[136:139], v[20:23], v[36:39], a[136:139]
    v_mfma_f32_16x16x32_bf16 a[136:139], v[24:27], v[52:55], a[136:139]
    v_mfma_f32_16x16x32_bf16 a[136:139], v[28:31], v[68:71], a[136:139]
    buffer_load_dwordx4 v1, s[28:31], s59 offen offset:1024 sc1 lds
    v_mfma_f32_16x16x32_bf16 a[40:43], v[28:31], v[64:67], a[40:43]
    v_mfma_f32_16x16x32_bf16 a[40:43], v[24:27], v[48:51], a[40:43]
    v_mfma_f32_16x16x32_bf16 a[40:43], v[20:23], v[32:35], a[40:43]
    s_waitcnt lgkmcnt(0)
    v_mfma_f32_16x16x32_bf16 v[128:131], v[8:11], v[80:83], v[128:131]
    ds_read_b128 v[20:23], v2 offset:3072
    v_mfma_f32_16x16x32_bf16 v[128:131], v[12:15], v[96:99], v[128:131]
    ds_read_b128 v[24:27], v2 offset:4096
    v_mfma_f32_16x16x32_bf16 v[128:131], v[16:19], v[112:115], v[128:131]
    buffer_load_dwordx4 v1, s[28:31], s59 offen offset:2048 sc1 lds
    v_mfma_f32_16x16x32_bf16 v[136:139], v[16:19], v[116:119], v[136:139]
    ds_read_b128 v[28:31], v2 offset:5120
    v_mfma_f32_16x16x32_bf16 v[136:139], v[12:15], v[100:103], v[136:139]
    s_add_u32 s59, s59, 3072
    v_mfma_f32_16x16x32_bf16 v[136:139], v[8:11], v[84:87], v[136:139]
    ds_read_b64_tr_b16 v[32:33], v3 offset:0
    v_mfma_f32_16x16x32_bf16 v[144:147], v[8:11], v[88:91], v[144:147]
    s_add_u32 m0, m0, 3072
    v_mfma_f32_16x16x32_bf16 v[144:147], v[12:15], v[104:107], v[144:147]
    ds_read_b64_tr_b16 v[34:35], v4 offset:0
    v_mfma_f32_16x16x32_bf16 v[144:147], v[16:19], v[120:123], v[144:147]
    ds_read_b64_tr_b16 v[36:37], v4 offset:1024
    v_mfma_f32_16x16x32_bf16 v[152:155], v[16:19], v[124:127], v[152:155]
    ds_read_b64_tr_b16 v[38:39], v3 offset:1024
    v_mfma_f32_16x16x32_bf16 v[152:155], v[12:15], v[108:111], v[152:155]
    ds_read_b64_tr_b16 v[40:41], v3 offset:2048
    v_mfma_f32_16x16x32_bf16 v[152:155], v[8:11], v[92:95], v[152:155]
    s_waitcnt lgkmcnt(5)
    v_mfma_f32_16x16x32_bf16 v[156:159], v[20:23], v[92:95], v[156:159]
    ds_read_b128 v[8:11], v2 offset:6144
    v_mfma_f32_16x16x32_bf16 v[156:159], v[24:27], v[108:111], v[156:159]
    ds_read_b128 v[12:15], v2 offset:7168
    v_mfma_f32_16x16x32_bf16 v[156:159], v[28:31], v[124:127], v[156:159]
    buffer_load_dwordx4 v1, s[28:31], s59 offen offset:0 sc1 lds
    v_mfma_f32_16x16x32_bf16 v[148:151], v[28:31], v[120:123], v[148:151]
    ds_read_b128 v[16:19], v2 offset:8192
    v_mfma_f32_16x16x32_bf16 v[148:151], v[24:27], v[104:107], v[148:151]
    ds_read_b64_tr_b16 v[42:43], v4 offset:2048
    v_mfma_f32_16x16x32_bf16 v[148:151], v[20:23], v[88:91], v[148:151]
    ds_read_b64_tr_b16 v[44:45], v4 offset:3072
    v_mfma_f32_16x16x32_bf16 v[140:143], v[20:23], v[84:87], v[140:143]
    ds_read_b64_tr_b16 v[46:47], v3 offset:3072
    v_mfma_f32_16x16x32_bf16 v[140:143], v[24:27], v[100:103], v[140:143]
    v_mfma_f32_16x16x32_bf16 v[140:143], v[28:31], v[116:119], v[140:143]
    buffer_load_dwordx4 v1, s[28:31], s59 offen offset:1024 sc1 lds
    v_mfma_f32_16x16x32_bf16 v[132:135], v[28:31], v[112:115], v[132:135]
    v_mfma_f32_16x16x32_bf16 v[132:135], v[24:27], v[96:99], v[132:135]
    v_mfma_f32_16x16x32_bf16 v[132:135], v[20:23], v[80:83], v[132:135]
    s_waitcnt lgkmcnt(3)
    v_mfma_f32_16x16x32_bf16 v[160:163], v[8:11], v[80:83], v[160:163]
    ds_read_b128 v[20:23], v2 offset:9216
    v_mfma_f32_16x16x32_bf16 v[160:163], v[12:15], v[96:99], v[160:163]
    ds_read_b128 v[24:27], v2 offset:10240
    v_mfma_f32_16x16x32_bf16 v[160:163], v[16:19], v[112:115], v[160:163]
    v_mfma_f32_16x16x32_bf16 v[168:171], v[16:19], v[116:119], v[168:171]
    ds_read_b128 v[28:31], v2 offset:11264
    v_mfma_f32_16x16x32_bf16 v[168:171], v[12:15], v[100:103], v[168:171]
    v_mfma_f32_16x16x32_bf16 v[168:171], v[8:11], v[84:87], v[168:171]
    v_mfma_f32_16x16x32_bf16 v[176:179], v[8:11], v[88:91], v[176:179]
    v_mfma_f32_16x16x32_bf16 v[176:179], v[12:15], v[104:107], v[176:179]
    v_mfma_f32_16x16x32_bf16 v[176:179], v[16:19], v[120:123], v[176:179]
    buffer_load_dwordx4 v1, s[28:31], s59 offen offset:2048 sc1 lds
    v_mfma_f32_16x16x32_bf16 v[184:187], v[16:19], v[124:127], v[184:187]
    s_add_u32 s59, s59, 21504
    v_mfma_f32_16x16x32_bf16 v[184:187], v[12:15], v[108:111], v[184:187]
    v_mfma_f32_16x16x32_bf16 v[184:187], v[8:11], v[92:95], v[184:187]
    s_waitcnt lgkmcnt(0)
    v_mfma_f32_16x16x32_bf16 v[188:191], v[20:23], v[92:95], v[188:191]
    ds_read_b128 v[8:11], v2 offset:12288
    v_mfma_f32_16x16x32_bf16 v[188:191], v[24:27], v[108:111], v[188:191]
    ds_read_b128 v[12:15], v2 offset:13312
    v_mfma_f32_16x16x32_bf16 v[188:191], v[28:31], v[124:127], v[188:191]
    s_add_u32 m0, s71, 0
    v_mfma_f32_16x16x32_bf16 v[180:183], v[28:31], v[120:123], v[180:183]
    ds_read_b128 v[16:19], v2 offset:14336
    v_mfma_f32_16x16x32_bf16 v[180:183], v[24:27], v[104:107], v[180:183]
    v_mfma_f32_16x16x32_bf16 v[180:183], v[20:23], v[88:91], v[180:183]
    buffer_load_dwordx4 v1, s[32:35], s56 offen offset:0 nt lds
    v_mfma_f32_16x16x32_bf16 v[172:175], v[20:23], v[84:87], v[172:175]
    s_cmp_ge_u32 s59, 1179648
    v_mfma_f32_16x16x32_bf16 v[172:175], v[24:27], v[100:103], v[172:175]
    s_cselect_b32 s59, s66, s59
    v_mfma_f32_16x16x32_bf16 v[172:175], v[28:31], v[116:119], v[172:175]
    v_mfma_f32_16x16x32_bf16 v[164:167], v[28:31], v[112:115], v[164:167]
    v_mfma_f32_16x16x32_bf16 v[164:167], v[24:27], v[96:99], v[164:167]
    v_mfma_f32_16x16x32_bf16 v[164:167], v[20:23], v[80:83], v[164:167]
    s_waitcnt lgkmcnt(0)
    v_mfma_f32_16x16x32_bf16 v[192:195], v[8:11], v[80:83], v[192:195]
    ds_read_b128 v[20:23], v2 offset:15360
    v_mfma_f32_16x16x32_bf16 v[192:195], v[12:15], v[96:99], v[192:195]
    ds_read_b128 v[24:27], v2 offset:16384
    v_mfma_f32_16x16x32_bf16 v[192:195], v[16:19], v[112:115], v[192:195]
    buffer_load_dwordx4 v1, s[32:35], s56 offen offset:1024 lds
    v_mfma_f32_16x16x32_bf16 v[200:203], v[16:19], v[116:119], v[200:203]
    ds_read_b128 v[28:31], v2 offset:17408
    v_mfma_f32_16x16x32_bf16 v[200:203], v[12:15], v[100:103], v[200:203]
    v_mfma_f32_16x16x32_bf16 v[200:203], v[8:11], v[84:87], v[200:203]
    v_mfma_f32_16x16x32_bf16 v[208:211], v[8:11], v[88:91], v[208:211]
    v_mfma_f32_16x16x32_bf16 v[208:211], v[12:15], v[104:107], v[208:211]
    v_mfma_f32_16x16x32_bf16 v[208:211], v[16:19], v[120:123], v[208:211]
    v_mfma_f32_16x16x32_bf16 v[216:219], v[16:19], v[124:127], v[216:219]
    v_mfma_f32_16x16x32_bf16 v[216:219], v[12:15], v[108:111], v[216:219]
    v_mfma_f32_16x16x32_bf16 v[216:219], v[8:11], v[92:95], v[216:219]
    s_waitcnt lgkmcnt(0)
    v_mfma_f32_16x16x32_bf16 v[220:223], v[20:23], v[92:95], v[220:223]
    ds_read_b128 v[8:11], v2 offset:18432
    v_mfma_f32_16x16x32_bf16 v[220:223], v[24:27], v[108:111], v[220:223]
    ds_read_b128 v[12:15], v2 offset:19456
    v_mfma_f32_16x16x32_bf16 v[220:223], v[28:31], v[124:127], v[220:223]
    buffer_load_dwordx4 v1, s[32:35], s56 offen offset:2048 lds
    v_mfma_f32_16x16x32_bf16 v[212:215], v[28:31], v[120:123], v[212:215]
    ds_read_b128 v[16:19], v2 offset:20480
    v_mfma_f32_16x16x32_bf16 v[212:215], v[24:27], v[104:107], v[212:215]
    v_mfma_f32_16x16x32_bf16 v[212:215], v[20:23], v[88:91], v[212:215]
    v_mfma_f32_16x16x32_bf16 v[204:207], v[20:23], v[84:87], v[204:207]
    v_mfma_f32_16x16x32_bf16 v[204:207], v[24:27], v[100:103], v[204:207]
    v_mfma_f32_16x16x32_bf16 v[204:207], v[28:31], v[116:119], v[204:207]
    buffer_load_dwordx4 v1, s[32:35], s56 offen offset:3072 lds
    v_mfma_f32_16x16x32_bf16 v[196:199], v[28:31], v[112:115], v[196:199]
    s_add_u32 s56, s56, 4096
    v_mfma_f32_16x16x32_bf16 v[196:199], v[24:27], v[96:99], v[196:199]
    v_mfma_f32_16x16x32_bf16 v[196:199], v[20:23], v[80:83], v[196:199]
    s_waitcnt lgkmcnt(0)
    v_mfma_f32_16x16x32_bf16 v[224:227], v[8:11], v[80:83], v[224:227]
    ds_read_b128 v[20:23], v2 offset:21504
    v_mfma_f32_16x16x32_bf16 v[224:227], v[12:15], v[96:99], v[224:227]
    ds_read_b128 v[24:27], v2 offset:22528
    v_mfma_f32_16x16x32_bf16 v[224:227], v[16:19], v[112:115], v[224:227]
    v_mfma_f32_16x16x32_bf16 v[232:235], v[16:19], v[116:119], v[232:235]
    ds_read_b128 v[28:31], v2 offset:23552
    v_mfma_f32_16x16x32_bf16 v[232:235], v[12:15], v[100:103], v[232:235]
    v_mfma_f32_16x16x32_bf16 v[232:235], v[8:11], v[84:87], v[232:235]
    v_mfma_f32_16x16x32_bf16 v[240:243], v[8:11], v[88:91], v[240:243]
    v_mfma_f32_16x16x32_bf16 v[240:243], v[12:15], v[104:107], v[240:243]
    v_mfma_f32_16x16x32_bf16 v[240:243], v[16:19], v[120:123], v[240:243]
    s_add_u32 m0, s66, 49152
    v_mfma_f32_16x16x32_bf16 v[248:251], v[16:19], v[124:127], v[248:251]
    v_mfma_f32_16x16x32_bf16 v[248:251], v[12:15], v[108:111], v[248:251]
    v_mfma_f32_16x16x32_bf16 v[248:251], v[8:11], v[92:95], v[248:251]
    s_waitcnt vmcnt(14) lgkmcnt(0)
    s_barrier
    v_mfma_f32_16x16x32_bf16 v[252:255], v[20:23], v[92:95], v[252:255]
    ds_read_b128 v[8:11], v2 offset:24576
    v_mfma_f32_16x16x32_bf16 v[252:255], v[24:27], v[108:111], v[252:255]
    ds_read_b128 v[12:15], v2 offset:25600
    v_mfma_f32_16x16x32_bf16 v[252:255], v[28:31], v[124:127], v[252:255]
    buffer_load_dwordx4 v1, s[28:31], s59 offen offset:0 sc1 lds
    v_mfma_f32_16x16x32_bf16 v[244:247], v[28:31], v[120:123], v[244:247]
    ds_read_b128 v[16:19], v2 offset:26624
    v_mfma_f32_16x16x32_bf16 v[244:247], v[24:27], v[104:107], v[244:247]
    v_mfma_f32_16x16x32_bf16 v[244:247], v[20:23], v[88:91], v[244:247]
    v_mfma_f32_16x16x32_bf16 v[236:239], v[20:23], v[84:87], v[236:239]
    v_mfma_f32_16x16x32_bf16 v[236:239], v[24:27], v[100:103], v[236:239]
    v_mfma_f32_16x16x32_bf16 v[236:239], v[28:31], v[116:119], v[236:239]
    buffer_load_dwordx4 v1, s[28:31], s59 offen offset:1024 sc1 lds
    v_mfma_f32_16x16x32_bf16 v[228:231], v[28:31], v[112:115], v[228:231]
    v_mfma_f32_16x16x32_bf16 v[228:231], v[24:27], v[96:99], v[228:231]
    v_mfma_f32_16x16x32_bf16 v[228:231], v[20:23], v[80:83], v[228:231]
    s_waitcnt lgkmcnt(0)
    v_mfma_f32_16x16x32_bf16 a[192:195], v[8:11], v[80:83], a[192:195]
    ds_read_b128 v[20:23], v2 offset:27648
    v_mfma_f32_16x16x32_bf16 a[192:195], v[12:15], v[96:99], a[192:195]
    ds_read_b128 v[24:27], v2 offset:28672
    v_mfma_f32_16x16x32_bf16 a[192:195], v[16:19], v[112:115], a[192:195]
    buffer_load_dwordx4 v1, s[28:31], s59 offen offset:2048 sc1 lds
    v_mfma_f32_16x16x32_bf16 a[200:203], v[16:19], v[116:119], a[200:203]
    ds_read_b128 v[28:31], v2 offset:29696
    v_mfma_f32_16x16x32_bf16 a[200:203], v[12:15], v[100:103], a[200:203]
    s_add_u32 s59, s59, 3072
    v_mfma_f32_16x16x32_bf16 a[200:203], v[8:11], v[84:87], a[200:203]
    ds_read_b64_tr_b16 v[48:49], v3 offset:16384
    v_mfma_f32_16x16x32_bf16 a[208:211], v[8:11], v[88:91], a[208:211]
    s_add_u32 m0, m0, 3072
    v_mfma_f32_16x16x32_bf16 a[208:211], v[12:15], v[104:107], a[208:211]
    ds_read_b64_tr_b16 v[50:51], v4 offset:16384
    v_mfma_f32_16x16x32_bf16 a[208:211], v[16:19], v[120:123], a[208:211]
    ds_read_b64_tr_b16 v[52:53], v4 offset:17408
    v_mfma_f32_16x16x32_bf16 a[216:219], v[16:19], v[124:127], a[216:219]
    ds_read_b64_tr_b16 v[54:55], v3 offset:17408
    v_mfma_f32_16x16x32_bf16 a[216:219], v[12:15], v[108:111], a[216:219]
    ds_read_b64_tr_b16 v[56:57], v3 offset:18432
    v_mfma_f32_16x16x32_bf16 a[216:219], v[8:11], v[92:95], a[216:219]
    s_waitcnt lgkmcnt(5)
    v_mfma_f32_16x16x32_bf16 a[220:223], v[20:23], v[92:95], a[220:223]
    ds_read_b128 v[8:11], v2 offset:30720
    v_mfma_f32_16x16x32_bf16 a[220:223], v[24:27], v[108:111], a[220:223]
    ds_read_b128 v[12:15], v2 offset:31744
    v_mfma_f32_16x16x32_bf16 a[220:223], v[28:31], v[124:127], a[220:223]
    buffer_load_dwordx4 v1, s[28:31], s59 offen offset:0 sc1 lds
    v_mfma_f32_16x16x32_bf16 a[212:215], v[28:31], v[120:123], a[212:215]
    ds_read_b128 v[16:19], v2 offset:32768
    v_mfma_f32_16x16x32_bf16 a[212:215], v[24:27], v[104:107], a[212:215]
    ds_read_b64_tr_b16 v[58:59], v4 offset:18432
    v_mfma_f32_16x16x32_bf16 a[212:215], v[20:23], v[88:91], a[212:215]
    ds_read_b64_tr_b16 v[60:61], v4 offset:19456
    v_mfma_f32_16x16x32_bf16 a[204:207], v[20:23], v[84:87], a[204:207]
    ds_read_b64_tr_b16 v[62:63], v3 offset:19456
    v_mfma_f32_16x16x32_bf16 a[204:207], v[24:27], v[100:103], a[204:207]
    v_mfma_f32_16x16x32_bf16 a[204:207], v[28:31], v[116:119], a[204:207]
    buffer_load_dwordx4 v1, s[28:31], s59 offen offset:1024 sc1 lds
    v_mfma_f32_16x16x32_bf16 a[196:199], v[28:31], v[112:115], a[196:199]
    v_mfma_f32_16x16x32_bf16 a[196:199], v[24:27], v[96:99], a[196:199]
    v_mfma_f32_16x16x32_bf16 a[196:199], v[20:23], v[80:83], a[196:199]
    s_waitcnt lgkmcnt(3)
    v_mfma_f32_16x16x32_bf16 a[224:227], v[8:11], v[80:83], a[224:227]
    ds_read_b128 v[20:23], v2 offset:33792
    v_mfma_f32_16x16x32_bf16 a[224:227], v[12:15], v[96:99], a[224:227]
    ds_read_b128 v[24:27], v2 offset:34816
    v_mfma_f32_16x16x32_bf16 a[224:227], v[16:19], v[112:115], a[224:227]
    v_mfma_f32_16x16x32_bf16 a[232:235], v[16:19], v[116:119], a[232:235]
    ds_read_b128 v[28:31], v2 offset:35840
    v_mfma_f32_16x16x32_bf16 a[232:235], v[12:15], v[100:103], a[232:235]
    v_mfma_f32_16x16x32_bf16 a[232:235], v[8:11], v[84:87], a[232:235]
    v_mfma_f32_16x16x32_bf16 a[240:243], v[8:11], v[88:91], a[240:243]
    v_mfma_f32_16x16x32_bf16 a[240:243], v[12:15], v[104:107], a[240:243]
    v_mfma_f32_16x16x32_bf16 a[240:243], v[16:19], v[120:123], a[240:243]
    buffer_load_dwordx4 v1, s[28:31], s59 offen offset:2048 sc1 lds
    v_mfma_f32_16x16x32_bf16 a[248:251], v[16:19], v[124:127], a[248:251]
    s_add_u32 s59, s59, s73
    v_mfma_f32_16x16x32_bf16 a[248:251], v[12:15], v[108:111], a[248:251]
    v_mfma_f32_16x16x32_bf16 a[248:251], v[8:11], v[92:95], a[248:251]
    s_waitcnt lgkmcnt(0)
    v_mfma_f32_16x16x32_bf16 a[252:255], v[20:23], v[92:95], a[252:255]
    ds_read_b128 v[8:11], v2 offset:36864
    v_mfma_f32_16x16x32_bf16 a[252:255], v[24:27], v[108:111], a[252:255]
    ds_read_b128 v[12:15], v2 offset:37888
    v_mfma_f32_16x16x32_bf16 a[252:255], v[28:31], v[124:127], a[252:255]
    s_add_u32 m0, s71, 16384
    v_mfma_f32_16x16x32_bf16 a[244:247], v[28:31], v[120:123], a[244:247]
    ds_read_b128 v[16:19], v2 offset:38912
    v_mfma_f32_16x16x32_bf16 a[244:247], v[24:27], v[104:107], a[244:247]
    v_mfma_f32_16x16x32_bf16 a[244:247], v[20:23], v[88:91], a[244:247]
    buffer_load_dwordx4 v1, s[32:35], s56 offen offset:0 nt lds
    v_mfma_f32_16x16x32_bf16 a[236:239], v[20:23], v[84:87], a[236:239]
    v_mfma_f32_16x16x32_bf16 a[236:239], v[24:27], v[100:103], a[236:239]
    v_mfma_f32_16x16x32_bf16 a[236:239], v[28:31], v[116:119], a[236:239]
    v_mfma_f32_16x16x32_bf16 a[228:231], v[28:31], v[112:115], a[228:231]
    v_mfma_f32_16x16x32_bf16 a[228:231], v[24:27], v[96:99], a[228:231]
    v_mfma_f32_16x16x32_bf16 a[228:231], v[20:23], v[80:83], a[228:231]
    s_waitcnt lgkmcnt(0)
    v_mfma_f32_16x16x32_bf16 a[188:191], v[8:11], v[80:83], a[188:191]
    ds_read_b128 v[20:23], v2 offset:39936
    v_mfma_f32_16x16x32_bf16 a[188:191], v[12:15], v[96:99], a[188:191]
    ds_read_b128 v[24:27], v2 offset:40960
    v_mfma_f32_16x16x32_bf16 a[188:191], v[16:19], v[112:115], a[188:191]
    buffer_load_dwordx4 v1, s[32:35], s56 offen offset:1024 lds
    v_mfma_f32_16x16x32_bf16 a[48:51], v[16:19], v[116:119], a[48:51]
    ds_read_b128 v[28:31], v2 offset:41984
    v_mfma_f32_16x16x32_bf16 a[48:51], v[12:15], v[100:103], a[48:51]
    v_mfma_f32_16x16x32_bf16 a[48:51], v[8:11], v[84:87], a[48:51]
    v_mfma_f32_16x16x32_bf16 a[144:147], v[8:11], v[88:91], a[144:147]
    v_mfma_f32_16x16x32_bf16 a[144:147], v[12:15], v[104:107], a[144:147]
    v_mfma_f32_16x16x32_bf16 a[144:147], v[16:19], v[120:123], a[144:147]
    v_mfma_f32_16x16x32_bf16 a[52:55], v[16:19], v[124:127], a[52:55]
    v_mfma_f32_16x16x32_bf16 a[52:55], v[12:15], v[108:111], a[52:55]
    v_mfma_f32_16x16x32_bf16 a[52:55], v[8:11], v[92:95], a[52:55]
    s_waitcnt lgkmcnt(0)
    v_mfma_f32_16x16x32_bf16 a[100:103], v[20:23], v[92:95], a[100:103]
    ds_read_b128 v[8:11], v2 offset:43008
    v_mfma_f32_16x16x32_bf16 a[100:103], v[24:27], v[108:111], a[100:103]
    ds_read_b128 v[12:15], v2 offset:44032
    v_mfma_f32_16x16x32_bf16 a[100:103], v[28:31], v[124:127], a[100:103]
    buffer_load_dwordx4 v1, s[32:35], s56 offen offset:2048 lds
    v_mfma_f32_16x16x32_bf16 a[4:7], v[28:31], v[120:123], a[4:7]
    ds_read_b128 v[16:19], v2 offset:45056
    v_mfma_f32_16x16x32_bf16 a[4:7], v[24:27], v[104:107], a[4:7]
    v_mfma_f32_16x16x32_bf16 a[4:7], v[20:23], v[88:91], a[4:7]
    v_mfma_f32_16x16x32_bf16 a[96:99], v[20:23], v[84:87], a[96:99]
    v_mfma_f32_16x16x32_bf16 a[96:99], v[24:27], v[100:103], a[96:99]
    v_mfma_f32_16x16x32_bf16 a[96:99], v[28:31], v[116:119], a[96:99]
    buffer_load_dwordx4 v1, s[32:35], s56 offen offset:3072 lds
    v_mfma_f32_16x16x32_bf16 a[0:3], v[28:31], v[112:115], a[0:3]
    s_add_u32 s56, s56, 4096
    v_mfma_f32_16x16x32_bf16 a[0:3], v[24:27], v[96:99], a[0:3]
    v_mfma_f32_16x16x32_bf16 a[0:3], v[20:23], v[80:83], a[0:3]
    s_waitcnt lgkmcnt(0)
    v_mfma_f32_16x16x32_bf16 a[148:151], v[8:11], v[80:83], a[148:151]
    ds_read_b128 v[20:23], v2 offset:46080
    v_mfma_f32_16x16x32_bf16 a[148:151], v[12:15], v[96:99], a[148:151]
    ds_read_b128 v[24:27], v2 offset:47104
    v_mfma_f32_16x16x32_bf16 a[148:151], v[16:19], v[112:115], a[148:151]
    v_mfma_f32_16x16x32_bf16 a[56:59], v[16:19], v[116:119], a[56:59]
    ds_read_b128 v[28:31], v2 offset:48128
    v_mfma_f32_16x16x32_bf16 a[56:59], v[12:15], v[100:103], a[56:59]
    v_mfma_f32_16x16x32_bf16 a[56:59], v[8:11], v[84:87], a[56:59]
    v_mfma_f32_16x16x32_bf16 a[152:155], v[8:11], v[88:91], a[152:155]
    v_mfma_f32_16x16x32_bf16 a[152:155], v[12:15], v[104:107], a[152:155]
    v_mfma_f32_16x16x32_bf16 a[152:155], v[16:19], v[120:123], a[152:155]
    s_add_u32 m0, s66, 73728
    v_mfma_f32_16x16x32_bf16 a[60:63], v[16:19], v[124:127], a[60:63]
    v_mfma_f32_16x16x32_bf16 a[60:63], v[12:15], v[108:111], a[60:63]
    v_mfma_f32_16x16x32_bf16 a[60:63], v[8:11], v[92:95], a[60:63]
    s_waitcnt vmcnt(14) lgkmcnt(0)
    s_barrier
    v_mfma_f32_16x16x32_bf16 a[108:111], v[20:23], v[92:95], a[108:111]
    ds_read_b128 v[8:11], v5 offset:0
    v_mfma_f32_16x16x32_bf16 a[108:111], v[24:27], v[108:111], a[108:111]
    ds_read_b128 v[12:15], v5 offset:1024
    v_mfma_f32_16x16x32_bf16 a[108:111], v[28:31], v[124:127], a[108:111]
    buffer_load_dwordx4 v1, s[28:31], s59 offen offset:0 sc1 lds
    v_mfma_f32_16x16x32_bf16 a[12:15], v[28:31], v[120:123], a[12:15]
    ds_read_b128 v[16:19], v5 offset:2048
    v_mfma_f32_16x16x32_bf16 a[12:15], v[24:27], v[104:107], a[12:15]
    v_mfma_f32_16x16x32_bf16 a[12:15], v[20:23], v[88:91], a[12:15]
    v_mfma_f32_16x16x32_bf16 a[104:107], v[20:23], v[84:87], a[104:107]
    v_mfma_f32_16x16x32_bf16 a[104:107], v[24:27], v[100:103], a[104:107]
    v_mfma_f32_16x16x32_bf16 a[104:107], v[28:31], v[116:119], a[104:107]
    buffer_load_dwordx4 v1, s[28:31], s59 offen offset:1024 sc1 lds
    v_mfma_f32_16x16x32_bf16 a[8:11], v[28:31], v[112:115], a[8:11]
    v_mfma_f32_16x16x32_bf16 a[8:11], v[24:27], v[96:99], a[8:11]
    v_mfma_f32_16x16x32_bf16 a[8:11], v[20:23], v[80:83], a[8:11]
    s_waitcnt lgkmcnt(0)
    v_mfma_f32_16x16x32_bf16 a[156:159], v[8:11], v[80:83], a[156:159]
    ds_read_b128 v[20:23], v5 offset:3072
    v_mfma_f32_16x16x32_bf16 a[156:159], v[12:15], v[96:99], a[156:159]
    ds_read_b128 v[24:27], v5 offset:4096
    v_mfma_f32_16x16x32_bf16 a[156:159], v[16:19], v[112:115], a[156:159]
    buffer_load_dwordx4 v1, s[28:31], s59 offen offset:2048 sc1 lds
    v_mfma_f32_16x16x32_bf16 a[64:67], v[16:19], v[116:119], a[64:67]
    ds_read_b128 v[28:31], v5 offset:5120
    v_mfma_f32_16x16x32_bf16 a[64:67], v[12:15], v[100:103], a[64:67]
    s_add_u32 s59, s59, 3072
    v_mfma_f32_16x16x32_bf16 a[64:67], v[8:11], v[84:87], a[64:67]
    ds_read_b64_tr_b16 v[64:65], v3 offset:32768
    v_mfma_f32_16x16x32_bf16 a[160:163], v[8:11], v[88:91], a[160:163]
    s_add_u32 m0, m0, 3072
    v_mfma_f32_16x16x32_bf16 a[160:163], v[12:15], v[104:107], a[160:163]
    ds_read_b64_tr_b16 v[66:67], v4 offset:32768
    v_mfma_f32_16x16x32_bf16 a[160:163], v[16:19], v[120:123], a[160:163]
    ds_read_b64_tr_b16 v[68:69], v4 offset:33792
    v_mfma_f32_16x16x32_bf16 a[68:71], v[16:19], v[124:127], a[68:71]
    ds_read_b64_tr_b16 v[70:71], v3 offset:33792
    v_mfma_f32_16x16x32_bf16 a[68:71], v[12:15], v[108:111], a[68:71]
    ds_read_b64_tr_b16 v[72:73], v3 offset:34816
    v_mfma_f32_16x16x32_bf16 a[68:71], v[8:11], v[92:95], a[68:71]
    s_waitcnt lgkmcnt(5)
    v_mfma_f32_16x16x32_bf16 a[116:119], v[20:23], v[92:95], a[116:119]
    ds_read_b128 v[8:11], v5 offset:6144
    v_mfma_f32_16x16x32_bf16 a[116:119], v[24:27], v[108:111], a[116:119]
    ds_read_b128 v[12:15], v5 offset:7168
    v_mfma_f32_16x16x32_bf16 a[116:119], v[28:31], v[124:127], a[116:119]
    buffer_load_dwordx4 v1, s[28:31], s59 offen offset:0 sc1 lds
    v_mfma_f32_16x16x32_bf16 a[20:23], v[28:31], v[120:123], a[20:23]
    ds_read_b128 v[16:19], v5 offset:8192
    v_mfma_f32_16x16x32_bf16 a[20:23], v[24:27], v[104:107], a[20:23]
    ds_read_b64_tr_b16 v[74:75], v4 offset:34816
    v_mfma_f32_16x16x32_bf16 a[20:23], v[20:23], v[88:91], a[20:23]
    ds_read_b64_tr_b16 v[76:77], v4 offset:35840
    v_mfma_f32_16x16x32_bf16 a[112:115], v[20:23], v[84:87], a[112:115]
    ds_read_b64_tr_b16 v[78:79], v3 offset:35840
    v_mfma_f32_16x16x32_bf16 a[112:115], v[24:27], v[100:103], a[112:115]
    v_mfma_f32_16x16x32_bf16 a[112:115], v[28:31], v[116:119], a[112:115]
    buffer_load_dwordx4 v1, s[28:31], s59 offen offset:1024 sc1 lds
    v_mfma_f32_16x16x32_bf16 a[16:19], v[28:31], v[112:115], a[16:19]
    v_mfma_f32_16x16x32_bf16 a[16:19], v[24:27], v[96:99], a[16:19]
    v_mfma_f32_16x16x32_bf16 a[16:19], v[20:23], v[80:83], a[16:19]
    s_waitcnt lgkmcnt(3)
    v_mfma_f32_16x16x32_bf16 a[164:167], v[8:11], v[80:83], a[164:167]
    ds_read_b128 v[20:23], v5 offset:9216
    v_mfma_f32_16x16x32_bf16 a[164:167], v[12:15], v[96:99], a[164:167]
    ds_read_b128 v[24:27], v5 offset:10240
    v_mfma_f32_16x16x32_bf16 a[164:167], v[16:19], v[112:115], a[164:167]
    v_mfma_f32_16x16x32_bf16 a[72:75], v[16:19], v[116:119], a[72:75]
    ds_read_b128 v[28:31], v5 offset:11264
    v_mfma_f32_16x16x32_bf16 a[72:75], v[12:15], v[100:103], a[72:75]
    v_mfma_f32_16x16x32_bf16 a[72:75], v[8:11], v[84:87], a[72:75]
    v_mfma_f32_16x16x32_bf16 a[168:171], v[8:11], v[88:91], a[168:171]
    v_mfma_f32_16x16x32_bf16 a[168:171], v[12:15], v[104:107], a[168:171]
    v_mfma_f32_16x16x32_bf16 a[168:171], v[16:19], v[120:123], a[168:171]
    buffer_load_dwordx4 v1, s[28:31], s59 offen offset:2048 sc1 lds
    v_mfma_f32_16x16x32_bf16 a[76:79], v[16:19], v[124:127], a[76:79]
    s_add_u32 s59, s59, s60
    v_mfma_f32_16x16x32_bf16 a[76:79], v[12:15], v[108:111], a[76:79]
    v_mfma_f32_16x16x32_bf16 a[76:79], v[8:11], v[92:95], a[76:79]
    s_waitcnt lgkmcnt(0)
    v_mfma_f32_16x16x32_bf16 a[124:127], v[20:23], v[92:95], a[124:127]
    ds_read_b128 v[8:11], v5 offset:12288
    v_mfma_f32_16x16x32_bf16 a[124:127], v[24:27], v[108:111], a[124:127]
    ds_read_b128 v[12:15], v5 offset:13312
    v_mfma_f32_16x16x32_bf16 a[124:127], v[28:31], v[124:127], a[124:127]
    s_add_u32 m0, s71, 32768
    v_mfma_f32_16x16x32_bf16 a[28:31], v[28:31], v[120:123], a[28:31]
    ds_read_b128 v[16:19], v5 offset:14336
    v_mfma_f32_16x16x32_bf16 a[28:31], v[24:27], v[104:107], a[28:31]
    v_mfma_f32_16x16x32_bf16 a[28:31], v[20:23], v[88:91], a[28:31]
    buffer_load_dwordx4 v1, s[32:35], s56 offen offset:0 nt lds
    v_mfma_f32_16x16x32_bf16 a[120:123], v[20:23], v[84:87], a[120:123]
    v_mfma_f32_16x16x32_bf16 a[120:123], v[24:27], v[100:103], a[120:123]
    v_mfma_f32_16x16x32_bf16 a[120:123], v[28:31], v[116:119], a[120:123]
    v_mfma_f32_16x16x32_bf16 a[24:27], v[28:31], v[112:115], a[24:27]
    v_mfma_f32_16x16x32_bf16 a[24:27], v[24:27], v[96:99], a[24:27]
    v_mfma_f32_16x16x32_bf16 a[24:27], v[20:23], v[80:83], a[24:27]
    s_waitcnt lgkmcnt(0)
    v_mfma_f32_16x16x32_bf16 a[172:175], v[8:11], v[80:83], a[172:175]
    ds_read_b128 v[20:23], v5 offset:15360
    v_mfma_f32_16x16x32_bf16 a[172:175], v[12:15], v[96:99], a[172:175]
    ds_read_b128 v[24:27], v5 offset:16384
    v_mfma_f32_16x16x32_bf16 a[172:175], v[16:19], v[112:115], a[172:175]
    buffer_load_dwordx4 v1, s[32:35], s56 offen offset:1024 lds
    v_mfma_f32_16x16x32_bf16 a[80:83], v[16:19], v[116:119], a[80:83]
    ds_read_b128 v[28:31], v5 offset:17408
    v_mfma_f32_16x16x32_bf16 a[80:83], v[12:15], v[100:103], a[80:83]
    v_mfma_f32_16x16x32_bf16 a[80:83], v[8:11], v[84:87], a[80:83]
    v_mfma_f32_16x16x32_bf16 a[176:179], v[8:11], v[88:91], a[176:179]
    v_mfma_f32_16x16x32_bf16 a[176:179], v[12:15], v[104:107], a[176:179]
    v_mfma_f32_16x16x32_bf16 a[176:179], v[16:19], v[120:123], a[176:179]
    v_mfma_f32_16x16x32_bf16 a[84:87], v[16:19], v[124:127], a[84:87]
    v_mfma_f32_16x16x32_bf16 a[84:87], v[12:15], v[108:111], a[84:87]
    v_mfma_f32_16x16x32_bf16 a[84:87], v[8:11], v[92:95], a[84:87]
    s_waitcnt lgkmcnt(0)
    v_mfma_f32_16x16x32_bf16 a[132:135], v[20:23], v[92:95], a[132:135]
    ds_read_b128 v[8:11], v5 offset:18432
    v_mfma_f32_16x16x32_bf16 a[132:135], v[24:27], v[108:111], a[132:135]
    ds_read_b128 v[12:15], v5 offset:19456
    v_mfma_f32_16x16x32_bf16 a[132:135], v[28:31], v[124:127], a[132:135]
    buffer_load_dwordx4 v1, s[32:35], s56 offen offset:2048 lds
    v_mfma_f32_16x16x32_bf16 a[36:39], v[28:31], v[120:123], a[36:39]
    ds_read_b128 v[16:19], v5 offset:20480
    v_mfma_f32_16x16x32_bf16 a[36:39], v[24:27], v[104:107], a[36:39]
    v_mfma_f32_16x16x32_bf16 a[36:39], v[20:23], v[88:91], a[36:39]
    v_mfma_f32_16x16x32_bf16 a[128:131], v[20:23], v[84:87], a[128:131]
    v_mfma_f32_16x16x32_bf16 a[128:131], v[24:27], v[100:103], a[128:131]
    v_mfma_f32_16x16x32_bf16 a[128:131], v[28:31], v[116:119], a[128:131]
    buffer_load_dwordx4 v1, s[32:35], s56 offen offset:3072 lds
    v_mfma_f32_16x16x32_bf16 a[32:35], v[28:31], v[112:115], a[32:35]
    s_add_u32 s56, s56, 4096
    v_mfma_f32_16x16x32_bf16 a[32:35], v[24:27], v[96:99], a[32:35]
    v_mfma_f32_16x16x32_bf16 a[32:35], v[20:23], v[80:83], a[32:35]
    s_waitcnt lgkmcnt(0)
    v_mfma_f32_16x16x32_bf16 a[180:183], v[8:11], v[80:83], a[180:183]
    ds_read_b128 v[20:23], v5 offset:21504
    v_mfma_f32_16x16x32_bf16 a[180:183], v[12:15], v[96:99], a[180:183]
    ds_read_b128 v[24:27], v5 offset:22528
    v_mfma_f32_16x16x32_bf16 a[180:183], v[16:19], v[112:115], a[180:183]
    s_cmp_ge_u32 s56, s75
    v_mfma_f32_16x16x32_bf16 a[88:91], v[16:19], v[116:119], a[88:91]
    ds_read_b128 v[28:31], v5 offset:23552
    v_mfma_f32_16x16x32_bf16 a[88:91], v[12:15], v[100:103], a[88:91]
    s_cselect_b32 s56, s64, s56
    v_mfma_f32_16x16x32_bf16 a[88:91], v[8:11], v[84:87], a[88:91]
    v_mfma_f32_16x16x32_bf16 a[184:187], v[8:11], v[88:91], a[184:187]
    v_mfma_f32_16x16x32_bf16 a[184:187], v[12:15], v[104:107], a[184:187]
    v_mfma_f32_16x16x32_bf16 a[184:187], v[16:19], v[120:123], a[184:187]
    s_add_u32 m0, s66, 98304
    v_mfma_f32_16x16x32_bf16 a[92:95], v[16:19], v[124:127], a[92:95]
    v_mfma_f32_16x16x32_bf16 a[92:95], v[12:15], v[108:111], a[92:95]
    v_mfma_f32_16x16x32_bf16 a[92:95], v[8:11], v[92:95], a[92:95]
    s_waitcnt vmcnt(14) lgkmcnt(0)
    s_barrier
    v_mfma_f32_16x16x32_bf16 a[140:143], v[20:23], v[92:95], a[140:143]
    ds_read_b128 v[8:11], v2 offset:0
    v_mfma_f32_16x16x32_bf16 a[140:143], v[24:27], v[108:111], a[140:143]
    ds_read_b128 v[12:15], v2 offset:1024
    v_mfma_f32_16x16x32_bf16 a[140:143], v[28:31], v[124:127], a[140:143]
    buffer_load_dwordx4 v1, s[28:31], s59 offen offset:0 sc1 lds
    v_mfma_f32_16x16x32_bf16 a[44:47], v[28:31], v[120:123], a[44:47]
    ds_read_b128 v[16:19], v2 offset:2048
    v_mfma_f32_16x16x32_bf16 a[44:47], v[24:27], v[104:107], a[44:47]
    s_sub_u32 s62, s62, 1
    v_mfma_f32_16x16x32_bf16 a[44:47], v[20:23], v[88:91], a[44:47]
    v_mfma_f32_16x16x32_bf16 a[136:139], v[20:23], v[84:87], a[136:139]
    s_cmp_gt_u32 s62, 1
    v_mfma_f32_16x16x32_bf16 a[136:139], v[24:27], v[100:103], a[136:139]
    v_mfma_f32_16x16x32_bf16 a[136:139], v[28:31], v[116:119], a[136:139]
    buffer_load_dwordx4 v1, s[28:31], s59 offen offset:1024 sc1 lds
    v_mfma_f32_16x16x32_bf16 a[40:43], v[28:31], v[112:115], a[40:43]
    v_mfma_f32_16x16x32_bf16 a[40:43], v[24:27], v[96:99], a[40:43]
    v_mfma_f32_16x16x32_bf16 a[40:43], v[20:23], v[80:83], a[40:43]
    s_waitcnt lgkmcnt(0)
    s_cbranch_scc1 L3_main
    s_cmp_eq_u32 s62, 0
    s_cbranch_scc1 L3_last
    s_mov_b32 s73, 70656
    s_lshr_b32 s60, s3, 1
    s_mul_i32 s60, s60, 61440
    s_sub_u32 s60, s60, 52224
    s_getpc_b64 s[22:23]
Lpc_b:
    v_lshlrev_b32 v6, 6, v0
    v_mov_b32 v7, s23
    v_min_u32 v6, L_end-Lpc_b, v6
    v_add_co_u32 v6, vcc, s22, v6
    s_nop 1
    v_addc_co_u32_e64 v7, vcc, 0, v7, vcc
    global_load_dword v6, v[6:7], off
    s_branch L3_main
.p2align 6
L3_last:
    v_mfma_f32_16x16x32_bf16 v[128:131], v[8:11], v[32:35], v[128:131]
    ds_read_b128 v[20:23], v2 offset:3072
    v_mfma_f32_16x16x32_bf16 v[128:131], v[12:15], v[48:51], v[128:131]
    ds_read_b128 v[24:27], v2 offset:4096
    v_mfma_f32_16x16x32_bf16 v[128:131], v[16:19], v[64:67], v[128:131]
    buffer_load_dwordx4 v1, s[28:31], s59 offen offset:2048 sc1 lds
    v_mfma_f32_16x16x32_bf16 v[136:139], v[16:19], v[68:71], v[136:139]
    ds_read_b128 v[28:31], v2 offset:5120
    v_mfma_f32_16x16x32_bf16 v[136:139], v[12:15], v[52:55], v[136:139]
    s_add_u32 s59, s59, 3072
    v_mfma_f32_16x16x32_bf16 v[136:139], v[8:11], v[36:39], v[136:139]
    s_waitcnt lgkmcnt(3)
    v_mfma_f32_16x16x32_bf16 v[144:147], v[8:11], v[40:43], v[144:147]
    s_add_u32 m0, m0, 3072
    v_mfma_f32_16x16x32_bf16 v[144:147], v[12:15], v[56:59], v[144:147]
    ds_read_b64_tr_b16 v[80:81], v3 offset:0
    v_mfma_f32_16x16x32_bf16 v[144:147], v[16:19], v[72:75], v[144:147]
    ds_read_b64_tr_b16 v[82:83], v4 offset:0
    v_mfma_f32_16x16x32_bf16 v[152:155], v[16:19], v[76:79], v[152:155]
    ds_read_b64_tr_b16 v[84:85], v4 offset:1024
    v_mfma_f32_16x16x32_bf16 v[152:155], v[12:15], v[60:63], v[152:155]
    ds_read_b64_tr_b16 v[86:87], v3 offset:1024
    v_mfma_f32_16x16x32_bf16 v[152:155], v[8:11], v[44:47], v[152:155]
    s_waitcnt lgkmcnt(4)
    v_mfma_f32_16x16x32_bf16 v[156:159], v[20:23], v[44:47], v[156:159]
    ds_read_b128 v[8:11], v2 offset:6144
    v_mfma_f32_16x16x32_bf16 v[156:159], v[24:27], v[60:63], v[156:159]
    ds_read_b128 v[12:15], v2 offset:7168
    v_mfma_f32_16x16x32_bf16 v[156:159], v[28:31], v[76:79], v[156:159]
    buffer_load_dwordx4 v1, s[28:31], s59 offen offset:0 sc1 lds
    v_mfma_f32_16x16x32_bf16 v[148:151], v[28:31], v[72:75], v[148:151]
    ds_read_b128 v[16:19], v2 offset:8192
    v_mfma_f32_16x16x32_bf16 v[148:151], v[24:27], v[56:59], v[148:151]
    ds_read_b64_tr_b16 v[88:89], v3 offset:2048
    v_mfma_f32_16x16x32_bf16 v[148:151], v[20:23], v[40:43], v[148:151]
    s_waitcnt lgkmcnt(8)
    v_mfma_f32_16x16x32_bf16 v[140:143], v[20:23], v[36:39], v[140:143]
    ds_read_b64_tr_b16 v[90:91], v4 offset:2048
    v_mfma_f32_16x16x32_bf16 v[140:143], v[24:27], v[52:55], v[140:143]
    ds_read_b64_tr_b16 v[92:93], v4 offset:3072
    v_mfma_f32_16x16x32_bf16 v[140:143], v[28:31], v[68:71], v[140:143]
    buffer_load_dwordx4 v1, s[28:31], s59 offen offset:1024 sc1 lds
    v_mfma_f32_16x16x32_bf16 v[132:135], v[28:31], v[64:67], v[132:135]
    ds_read_b64_tr_b16 v[94:95], v3 offset:3072
    v_mfma_f32_16x16x32_bf16 v[132:135], v[24:27], v[48:51], v[132:135]
    v_mfma_f32_16x16x32_bf16 v[132:135], v[20:23], v[32:35], v[132:135]
    s_waitcnt lgkmcnt(4)
    v_mfma_f32_16x16x32_bf16 v[160:163], v[8:11], v[32:35], v[160:163]
    ds_read_b128 v[20:23], v2 offset:9216
    v_mfma_f32_16x16x32_bf16 v[160:163], v[12:15], v[48:51], v[160:163]
    ds_read_b128 v[24:27], v2 offset:10240
    v_mfma_f32_16x16x32_bf16 v[160:163], v[16:19], v[64:67], v[160:163]
    s_lshl_b32 s69, s3, 13
    v_mfma_f32_16x16x32_bf16 v[168:171], v[16:19], v[68:71], v[168:171]
    ds_read_b128 v[28:31], v2 offset:11264
    v_mfma_f32_16x16x32_bf16 v[168:171], v[12:15], v[52:55], v[168:171]
    s_add_u32 s69, s69, 131072
    v_mfma_f32_16x16x32_bf16 v[168:171], v[8:11], v[36:39], v[168:171]
    s_waitcnt lgkmcnt(7)
    v_mfma_f32_16x16x32_bf16 v[176:179], v[8:11], v[40:43], v[176:179]
    s_add_u32 s4, s55, 0
    v_mfma_f32_16x16x32_bf16 v[176:179], v[12:15], v[56:59], v[176:179]
    s_add_u32 s5, s55, 6144
    v_mfma_f32_16x16x32_bf16 v[176:179], v[16:19], v[72:75], v[176:179]
    buffer_load_dwordx4 v1, s[28:31], s59 offen offset:2048 sc1 lds
    v_mfma_f32_16x16x32_bf16 v[184:187], v[16:19], v[76:79], v[184:187]
    s_add_u32 s59, s59, 9216
    v_mfma_f32_16x16x32_bf16 v[184:187], v[12:15], v[60:63], v[184:187]
    s_add_u32 s6, s55, 12288
    v_mfma_f32_16x16x32_bf16 v[184:187], v[8:11], v[44:47], v[184:187]
    s_waitcnt lgkmcnt(0)
    v_mfma_f32_16x16x32_bf16 v[188:191], v[20:23], v[44:47], v[188:191]
    ds_read_b128 v[8:11], v2 offset:12288
    v_mfma_f32_16x16x32_bf16 v[188:191], v[24:27], v[60:63], v[188:191]
    ds_read_b128 v[12:15], v2 offset:13312
    v_mfma_f32_16x16x32_bf16 v[188:191], v[28:31], v[76:79], v[188:191]
    s_add_u32 s7, s55, 18432
    v_mfma_f32_16x16x32_bf16 v[180:183], v[28:31], v[72:75], v[180:183]
    ds_read_b128 v[16:19], v2 offset:14336
    v_mfma_f32_16x16x32_bf16 v[180:183], v[24:27], v[56:59], v[180:183]
    s_waitcnt vmcnt(16)
    v_mfma_f32_16x16x32_bf16 v[180:183], v[20:23], v[40:43], v[180:183]
    s_waitcnt lgkmcnt(3)
    v_mfma_f32_16x16x32_bf16 v[172:175], v[20:23], v[36:39], v[172:175]
    ds_read_b64_tr_b16 v[96:97], v3 offset:16384
    v_mfma_f32_16x16x32_bf16 v[172:175], v[24:27], v[52:55], v[172:175]
    ds_read_b64_tr_b16 v[98:99], v4 offset:16384
    v_mfma_f32_16x16x32_bf16 v[172:175], v[28:31], v[68:71], v[172:175]
    ds_read_b64_tr_b16 v[100:101], v4 offset:17408
    v_mfma_f32_16x16x32_bf16 v[164:167], v[28:31], v[64:67], v[164:167]
    ds_read_b64_tr_b16 v[102:103], v3 offset:17408
    v_mfma_f32_16x16x32_bf16 v[164:167], v[24:27], v[48:51], v[164:167]
    ds_read_b64_tr_b16 v[104:105], v3 offset:18432
    v_mfma_f32_16x16x32_bf16 v[164:167], v[20:23], v[32:35], v[164:167]
    s_waitcnt lgkmcnt(5)
    v_mfma_f32_16x16x32_bf16 v[192:195], v[8:11], v[32:35], v[192:195]
    ds_read_b128 v[20:23], v2 offset:15360
    v_mfma_f32_16x16x32_bf16 v[192:195], v[12:15], v[48:51], v[192:195]
    ds_read_b128 v[24:27], v2 offset:16384
    v_mfma_f32_16x16x32_bf16 v[192:195], v[16:19], v[64:67], v[192:195]
    ds_read_b64_tr_b16 v[106:107], v4 offset:18432
    v_mfma_f32_16x16x32_bf16 v[200:203], v[16:19], v[68:71], v[200:203]
    ds_read_b128 v[28:31], v2 offset:17408
    v_mfma_f32_16x16x32_bf16 v[200:203], v[12:15], v[52:55], v[200:203]
    ds_read_b64_tr_b16 v[108:109], v4 offset:19456
    v_mfma_f32_16x16x32_bf16 v[200:203], v[8:11], v[36:39], v[200:203]
    s_waitcnt lgkmcnt(10)
    v_mfma_f32_16x16x32_bf16 v[208:211], v[8:11], v[40:43], v[208:211]
    ds_read_b64_tr_b16 v[110:111], v3 offset:19456
    v_mfma_f32_16x16x32_bf16 v[208:211], v[12:15], v[56:59], v[208:211]
    s_add_u32 s8, s55, 24576
    v_mfma_f32_16x16x32_bf16 v[208:211], v[16:19], v[72:75], v[208:211]
    s_add_u32 s9, s55, 30720
    v_mfma_f32_16x16x32_bf16 v[216:219], v[16:19], v[76:79], v[216:219]
    s_add_u32 s10, s55, 36864
    v_mfma_f32_16x16x32_bf16 v[216:219], v[12:15], v[60:63], v[216:219]
    s_add_u32 s11, s55, 43008
    v_mfma_f32_16x16x32_bf16 v[216:219], v[8:11], v[44:47], v[216:219]
    s_waitcnt lgkmcnt(2)
    v_mfma_f32_16x16x32_bf16 v[220:223], v[20:23], v[44:47], v[220:223]
    ds_read_b128 v[8:11], v2 offset:18432
    v_mfma_f32_16x16x32_bf16 v[220:223], v[24:27], v[60:63], v[220:223]
    ds_read_b128 v[12:15], v2 offset:19456
    v_mfma_f32_16x16x32_bf16 v[220:223], v[28:31], v[76:79], v[220:223]
    v_mfma_f32_16x16x32_bf16 v[212:215], v[28:31], v[72:75], v[212:215]
    ds_read_b128 v[16:19], v2 offset:20480
    v_mfma_f32_16x16x32_bf16 v[212:215], v[24:27], v[56:59], v[212:215]
    s_waitcnt vmcnt(6)
    v_mfma_f32_16x16x32_bf16 v[212:215], v[20:23], v[40:43], v[212:215]
    s_waitcnt lgkmcnt(5)
    v_mfma_f32_16x16x32_bf16 v[204:207], v[20:23], v[36:39], v[204:207]
    ds_read_b64_tr_b16 v[112:113], v3 offset:32768
    v_mfma_f32_16x16x32_bf16 v[204:207], v[24:27], v[52:55], v[204:207]
    ds_read_b64_tr_b16 v[114:115], v4 offset:32768
    v_mfma_f32_16x16x32_bf16 v[204:207], v[28:31], v[68:71], v[204:207]
    ds_read_b64_tr_b16 v[116:117], v4 offset:33792
    v_mfma_f32_16x16x32_bf16 v[196:199], v[28:31], v[64:67], v[196:199]
    ds_read_b64_tr_b16 v[118:119], v3 offset:33792
    v_mfma_f32_16x16x32_bf16 v[196:199], v[24:27], v[48:51], v[196:199]
    ds_read_b64_tr_b16 v[120:121], v3 offset:34816
    v_mfma_f32_16x16x32_bf16 v[196:199], v[20:23], v[32:35], v[196:199]
    s_waitcnt lgkmcnt(5)
    v_mfma_f32_16x16x32_bf16 v[224:227], v[8:11], v[32:35], v[224:227]
    ds_read_b128 v[20:23], v2 offset:21504
    v_mfma_f32_16x16x32_bf16 v[224:227], v[12:15], v[48:51], v[224:227]
    ds_read_b128 v[24:27], v2 offset:22528
    v_mfma_f32_16x16x32_bf16 v[224:227], v[16:19], v[64:67], v[224:227]
    ds_read_b64_tr_b16 v[122:123], v4 offset:34816
    v_mfma_f32_16x16x32_bf16 v[232:235], v[16:19], v[68:71], v[232:235]
    ds_read_b128 v[28:31], v2 offset:23552
    v_mfma_f32_16x16x32_bf16 v[232:235], v[12:15], v[52:55], v[232:235]
    ds_read_b64_tr_b16 v[124:125], v4 offset:35840
    v_mfma_f32_16x16x32_bf16 v[232:235], v[8:11], v[36:39], v[232:235]
    s_waitcnt lgkmcnt(10)
    v_mfma_f32_16x16x32_bf16 v[240:243], v[8:11], v[40:43], v[240:243]
    ds_read_b64_tr_b16 v[126:127], v3 offset:35840
    v_mfma_f32_16x16x32_bf16 v[240:243], v[12:15], v[56:59], v[240:243]
    v_mfma_f32_16x16x32_bf16 v[240:243], v[16:19], v[72:75], v[240:243]
    v_mfma_f32_16x16x32_bf16 v[248:251], v[16:19], v[76:79], v[248:251]
    v_mfma_f32_16x16x32_bf16 v[248:251], v[12:15], v[60:63], v[248:251]
    v_mfma_f32_16x16x32_bf16 v[248:251], v[8:11], v[44:47], v[248:251]
    s_waitcnt vmcnt(10) lgkmcnt(0)
    s_barrier
    v_mfma_f32_16x16x32_bf16 v[252:255], v[20:23], v[44:47], v[252:255]
    ds_read_b128 v[8:11], v2 offset:24576
    v_bfe_u32 v6, v0, 4, 2
    v_mfma_f32_16x16x32_bf16 v[252:255], v[24:27], v[60:63], v[252:255]
    ds_read_b128 v[12:15], v2 offset:25600
    v_mfma_f32_16x16x32_bf16 v[252:255], v[28:31], v[76:79], v[252:255]
    s_add_u32 m0, s66, 49152
    v_and_b32 v7, 7, v0
    v_mfma_f32_16x16x32_bf16 v[244:247], v[28:31], v[72:75], v[244:247]
    ds_read_b128 v[16:19], v2 offset:26624
    v_xor_b32_e64 v6, v6, v7
    v_mfma_f32_16x16x32_bf16 v[244:247], v[24:27], v[56:59], v[244:247]
    buffer_load_dwordx4 v1, s[28:31], s59 offen offset:0 sc1 lds
    v_mfma_f32_16x16x32_bf16 v[244:247], v[20:23], v[40:43], v[244:247]
    v_mfma_f32_16x16x32_bf16 v[236:239], v[20:23], v[36:39], v[236:239]
    v_lshlrev_b32_e64 v6, 4, v6
    v_mfma_f32_16x16x32_bf16 v[236:239], v[24:27], v[52:55], v[236:239]
    v_and_b32_e64 v3, 15, v0
    v_mfma_f32_16x16x32_bf16 v[236:239], v[28:31], v[68:71], v[236:239]
    buffer_load_dwordx4 v1, s[28:31], s59 offen offset:1024 sc1 lds
    v_mfma_f32_16x16x32_bf16 v[228:231], v[28:31], v[64:67], v[228:231]
    v_lshl_add_u32 v6, v3, 7, v6
    v_mfma_f32_16x16x32_bf16 v[228:231], v[24:27], v[48:51], v[228:231]
    v_bfe_u32 v4, v0, 3, 3
    v_mfma_f32_16x16x32_bf16 v[228:231], v[20:23], v[32:35], v[228:231]
    s_waitcnt lgkmcnt(0)
    v_xor_b32 v3, v4, v7
    v_mfma_f32_16x16x32_bf16 v[128:131], v[8:11], v[80:83], v[128:131]
    ds_read_b128 v[20:23], v2 offset:27648
    v_mfma_f32_16x16x32_bf16 v[128:131], v[12:15], v[96:99], v[128:131]
    ds_read_b128 v[24:27], v2 offset:28672
    v_mfma_f32_16x16x32_bf16 v[128:131], v[16:19], v[112:115], v[128:131]
    buffer_load_dwordx4 v1, s[28:31], s59 offen offset:2048 sc1 lds
    v_mfma_f32_16x16x32_bf16 v[136:139], v[16:19], v[116:119], v[136:139]
    ds_read_b128 v[28:31], v2 offset:29696
    v_lshlrev_b32_e64 v3, 4, v3
    v_mfma_f32_16x16x32_bf16 v[136:139], v[12:15], v[100:103], v[136:139]
    s_add_u32 s59, s59, 3072
    v_lshl_add_u32 v3, v4, 7, v3
    v_mfma_f32_16x16x32_bf16 v[136:139], v[8:11], v[84:87], v[136:139]
    s_waitcnt lgkmcnt(3)
    v_mfma_f32_16x16x32_bf16 v[144:147], v[8:11], v[88:91], v[144:147]
    s_add_u32 m0, s66, 52224
    v_mul_u32_u24 v4, 768, v4
    v_mfma_f32_16x16x32_bf16 v[144:147], v[12:15], v[104:107], v[144:147]
    buffer_load_dwordx4 v1, s[28:31], s59 offen offset:0 sc1 lds
    v_mfma_f32_16x16x32_bf16 v[144:147], v[16:19], v[120:123], v[144:147]
    v_lshl_add_u32 v4, v7, 4, v4
    v_mfma_f32_16x16x32_bf16 v[152:155], v[16:19], v[124:127], v[152:155]
    v_add_u32 v6, s69, v6
    v_cvt_pk_bf16_f32 v128, v128, v129
    v_mfma_f32_16x16x32_bf16 v[152:155], v[12:15], v[108:111], v[152:155]
    v_add_u32_e64 v3, s69, v3
    v_cvt_pk_bf16_f32 v129, v130, v131
    v_mfma_f32_16x16x32_bf16 v[152:155], v[8:11], v[92:95], v[152:155]
    s_waitcnt lgkmcnt(0)
    v_xor_b32 v7, 64, v6
    v_mfma_f32_16x16x32_bf16 v[156:159], v[20:23], v[92:95], v[156:159]
    ds_read_b128 v[8:11], v2 offset:30720
    v_cvt_pk_bf16_f32 v136, v136, v137
    v_mfma_f32_16x16x32_bf16 v[156:159], v[24:27], v[108:111], v[156:159]
    ds_read_b128 v[12:15], v2 offset:31744
    v_cvt_pk_bf16_f32 v137, v138, v139
    v_mfma_f32_16x16x32_bf16 v[156:159], v[28:31], v[124:127], v[156:159]
    buffer_load_dwordx4 v1, s[28:31], s59 offen offset:1024 sc1 lds
    v_mfma_f32_16x16x32_bf16 v[148:151], v[28:31], v[120:123], v[148:151]
    ds_read_b128 v[16:19], v2 offset:32768
    v_cvt_pk_bf16_f32 v144, v144, v145
    v_mfma_f32_16x16x32_bf16 v[148:151], v[24:27], v[104:107], v[148:151]
    v_cvt_pk_bf16_f32 v145, v146, v147
    v_mfma_f32_16x16x32_bf16 v[148:151], v[20:23], v[88:91], v[148:151]
    s_waitcnt lgkmcnt(3)
    v_mfma_f32_16x16x32_bf16 v[140:143], v[20:23], v[84:87], v[140:143]
    buffer_load_dwordx4 v1, s[28:31], s59 offen offset:2048 sc1 lds
    v_mfma_f32_16x16x32_bf16 v[140:143], v[24:27], v[100:103], v[140:143]
    s_add_u32 s59, s59, 9216
    v_cvt_pk_bf16_f32 v152, v152, v153
    v_cvt_pk_bf16_f32 v153, v154, v155
    v_mfma_f32_16x16x32_bf16 v[140:143], v[28:31], v[116:119], v[140:143]
    s_add_u32 m0, s66, 0
    v_mfma_f32_16x16x32_bf16 v[132:135], v[28:31], v[112:115], v[132:135]
    buffer_load_dwordx4 v1, s[28:31], s59 offen offset:0 sc1 lds
    v_mfma_f32_16x16x32_bf16 v[132:135], v[24:27], v[96:99], v[132:135]
    v_cvt_pk_bf16_f32 v154, v156, v157
    v_cvt_pk_bf16_f32 v155, v158, v159
    v_mfma_f32_16x16x32_bf16 v[132:135], v[20:23], v[80:83], v[132:135]
    s_waitcnt lgkmcnt(0)
    ds_write_b128 v6, v[152:155] offset:6144
    v_mfma_f32_16x16x32_bf16 v[160:163], v[8:11], v[80:83], v[160:163]
    ds_read_b128 v[20:23], v2 offset:33792
    v_cvt_pk_bf16_f32 v146, v148, v149
    v_mfma_f32_16x16x32_bf16 v[160:163], v[12:15], v[96:99], v[160:163]
    ds_read_b128 v[24:27], v2 offset:34816
    v_cvt_pk_bf16_f32 v147, v150, v151
    v_mfma_f32_16x16x32_bf16 v[160:163], v[16:19], v[112:115], v[160:163]
    buffer_load_dwordx4 v1, s[28:31], s59 offen offset:1024 sc1 lds
    v_mfma_f32_16x16x32_bf16 v[168:171], v[16:19], v[116:119], v[168:171]
    ds_read_b128 v[28:31], v2 offset:35840
    v_cvt_pk_bf16_f32 v138, v140, v141
    v_mfma_f32_16x16x32_bf16 v[168:171], v[12:15], v[100:103], v[168:171]
    v_cvt_pk_bf16_f32 v139, v142, v143
    v_mfma_f32_16x16x32_bf16 v[168:171], v[8:11], v[84:87], v[168:171]
    s_waitcnt lgkmcnt(4)
    ds_write_b128 v6, v[144:147] offset:4096
    ds_write_b128 v6, v[136:139] offset:2048
    v_mfma_f32_16x16x32_bf16 v[176:179], v[8:11], v[88:91], v[176:179]
    buffer_load_dwordx4 v1, s[28:31], s59 offen offset:2048 sc1 lds
    v_mfma_f32_16x16x32_bf16 v[176:179], v[12:15], v[104:107], v[176:179]
    s_add_u32 s59, s59, 3072
    v_cvt_pk_bf16_f32 v130, v132, v133
    v_cvt_pk_bf16_f32 v131, v134, v135
    v_mfma_f32_16x16x32_bf16 v[176:179], v[16:19], v[120:123], v[176:179]
    s_add_u32 m0, s66, 3072
    ds_write_b128 v6, v[128:131] offset:0
    v_mfma_f32_16x16x32_bf16 v[184:187], v[16:19], v[124:127], v[184:187]
    buffer_load_dwordx4 v1, s[28:31], s59 offen offset:0 sc1 lds
    v_mfma_f32_16x16x32_bf16 v[184:187], v[12:15], v[108:111], v[184:187]
    v_cvt_pk_bf16_f32 v160, v160, v161
    v_cvt_pk_bf16_f32 v161, v162, v163
    v_mfma_f32_16x16x32_bf16 v[184:187], v[8:11], v[92:95], v[184:187]
    s_waitcnt lgkmcnt(3)
    v_mfma_f32_16x16x32_bf16 v[188:191], v[20:23], v[92:95], v[188:191]
    ds_read_b128 v[8:11], v2 offset:36864
    v_cvt_pk_bf16_f32 v168, v168, v169
    v_mfma_f32_16x16x32_bf16 v[188:191], v[24:27], v[108:111], v[188:191]
    ds_read_b128 v[12:15], v2 offset:37888
    v_cvt_pk_bf16_f32 v169, v170, v171
    v_mfma_f32_16x16x32_bf16 v[188:191], v[28:31], v[124:127], v[188:191]
    buffer_load_dwordx4 v1, s[28:31], s59 offen offset:1024 sc1 lds
    v_mfma_f32_16x16x32_bf16 v[180:183], v[28:31], v[120:123], v[180:183]
    ds_read_b128 v[16:19], v2 offset:38912
    v_cvt_pk_bf16_f32 v176, v176, v177
    v_mfma_f32_16x16x32_bf16 v[180:183], v[24:27], v[104:107], v[180:183]
    v_cvt_pk_bf16_f32 v177, v178, v179
    v_mfma_f32_16x16x32_bf16 v[180:183], v[20:23], v[88:91], v[180:183]
    s_waitcnt lgkmcnt(6)
    v_mfma_f32_16x16x32_bf16 v[172:175], v[20:23], v[84:87], v[172:175]
    buffer_load_dwordx4 v1, s[28:31], s59 offen offset:2048 sc1 lds
    v_mfma_f32_16x16x32_bf16 v[172:175], v[24:27], v[100:103], v[172:175]
    s_add_u32 s59, s59, 9216
    v_cvt_pk_bf16_f32 v184, v184, v185
    v_cvt_pk_bf16_f32 v185, v186, v187
    v_mfma_f32_16x16x32_bf16 v[172:175], v[28:31], v[116:119], v[172:175]
    s_add_u32 m0, s66, 24576
    v_mfma_f32_16x16x32_bf16 v[164:167], v[28:31], v[112:115], v[164:167]
    buffer_load_dwordx4 v1, s[28:31], s59 offen offset:0 sc1 lds
    v_mfma_f32_16x16x32_bf16 v[164:167], v[24:27], v[96:99], v[164:167]
    v_cvt_pk_bf16_f32 v186, v188, v189
    v_cvt_pk_bf16_f32 v187, v190, v191
    v_mfma_f32_16x16x32_bf16 v[164:167], v[20:23], v[80:83], v[164:167]
    s_waitcnt lgkmcnt(0)
    ds_write_b128 v7, v[184:187] offset:6144
    ds_read_b128 v[156:159], v3 offset:6144
    v_mfma_f32_16x16x32_bf16 v[192:195], v[8:11], v[80:83], v[192:195]
    ds_read_b128 v[20:23], v2 offset:39936
    ds_read_b128 v[188:191], v3 offset:7168
    v_mfma_f32_16x16x32_bf16 v[192:195], v[12:15], v[96:99], v[192:195]
    ds_read_b128 v[24:27], v2 offset:40960
    v_cvt_pk_bf16_f32 v178, v180, v181
    v_mfma_f32_16x16x32_bf16 v[192:195], v[16:19], v[112:115], v[192:195]
    buffer_load_dwordx4 v1, s[28:31], s59 offen offset:1024 sc1 lds
    v_mfma_f32_16x16x32_bf16 v[200:203], v[16:19], v[116:119], v[200:203]
    ds_read_b128 v[28:31], v2 offset:41984
    v_cvt_pk_bf16_f32 v179, v182, v183
    v_mfma_f32_16x16x32_bf16 v[200:203], v[12:15], v[100:103], v[200:203]
    v_cvt_pk_bf16_f32 v170, v172, v173
    v_cvt_pk_bf16_f32 v171, v174, v175
    v_mfma_f32_16x16x32_bf16 v[200:203], v[8:11], v[84:87], v[200:203]
    s_waitcnt lgkmcnt(6)
    ds_write_b128 v7, v[176:179] offset:4096
    ds_read_b128 v[148:151], v3 offset:4096
    v_mfma_f32_16x16x32_bf16 v[208:211], v[8:11], v[88:91], v[208:211]
    buffer_load_dwordx4 v1, s[28:31], s59 offen offset:2048 sc1 lds
    v_mfma_f32_16x16x32_bf16 v[208:211], v[12:15], v[104:107], v[208:211]
    s_add_u32 s59, s59, 3072
    ds_read_b128 v[180:183], v3 offset:5120
    v_cvt_pk_bf16_f32 v162, v164, v165
    v_mfma_f32_16x16x32_bf16 v[208:211], v[16:19], v[120:123], v[208:211]
    s_add_u32 m0, s66, 27648
    ds_write_b128 v7, v[168:171] offset:2048
    ds_read_b128 v[140:143], v3 offset:2048
    v_mfma_f32_16x16x32_bf16 v[216:219], v[16:19], v[124:127], v[216:219]
    buffer_load_dwordx4 v1, s[28:31], s59 offen offset:0 sc1 lds
    v_mfma_f32_16x16x32_bf16 v[216:219], v[12:15], v[108:111], v[216:219]
    ds_read_b128 v[172:175], v3 offset:3072
    v_cvt_pk_bf16_f32 v163, v166, v167
    v_mfma_f32_16x16x32_bf16 v[216:219], v[8:11], v[92:95], v[216:219]
    s_waitcnt lgkmcnt(6)
    buffer_store_dwordx4 v[156:159], v4, s[24:27], s10 offen offset:0 sc1
    ds_write_b128 v7, v[160:163] offset:0
    v_cvt_pk_bf16_f32 v192, v192, v193
    v_cvt_pk_bf16_f32 v193, v194, v195
    v_mfma_f32_16x16x32_bf16 v[220:223], v[20:23], v[92:95], v[220:223]
    ds_read_b128 v[8:11], v2 offset:43008
    ds_read_b128 v[132:135], v3 offset:0
    v_mfma_f32_16x16x32_bf16 v[220:223], v[24:27], v[108:111], v[220:223]
    ds_read_b128 v[12:15], v2 offset:44032
    ds_read_b128 v[164:167], v3 offset:1024
    v_mfma_f32_16x16x32_bf16 v[220:223], v[28:31], v[124:127], v[220:223]
    buffer_load_dwordx4 v1, s[28:31], s59 offen offset:1024 sc1 lds
    v_mfma_f32_16x16x32_bf16 v[212:215], v[28:31], v[120:123], v[212:215]
    ds_read_b128 v[16:19], v2 offset:45056
    v_cvt_pk_bf16_f32 v200, v200, v201
    v_mfma_f32_16x16x32_bf16 v[212:215], v[24:27], v[104:107], v[212:215]
    v_cvt_pk_bf16_f32 v201, v202, v203
    v_cvt_pk_bf16_f32 v208, v208, v209
    v_mfma_f32_16x16x32_bf16 v[212:215], v[20:23], v[88:91], v[212:215]
    s_waitcnt lgkmcnt(12)
    buffer_store_dwordx4 v[188:191], v4, s[24:27], s11 offen offset:0 sc1
    v_cvt_pk_bf16_f32 v209, v210, v211
    v_mfma_f32_16x16x32_bf16 v[204:207], v[20:23], v[84:87], v[204:207]
    buffer_load_dwordx4 v1, s[28:31], s59 offen offset:2048 sc1 lds
    v_mfma_f32_16x16x32_bf16 v[204:207], v[24:27], v[100:103], v[204:207]
    s_add_u32 s59, s59, 9216
    v_cvt_pk_bf16_f32 v216, v216, v217
    v_cvt_pk_bf16_f32 v217, v218, v219
    v_mfma_f32_16x16x32_bf16 v[204:207], v[28:31], v[116:119], v[204:207]
    v_mfma_f32_16x16x32_bf16 v[196:199], v[28:31], v[112:115], v[196:199]
    v_cvt_pk_bf16_f32 v218, v220, v221
    v_cvt_pk_bf16_f32 v219, v222, v223
    v_mfma_f32_16x16x32_bf16 v[196:199], v[24:27], v[96:99], v[196:199]
    v_mfma_f32_16x16x32_bf16 v[196:199], v[20:23], v[80:83], v[196:199]
    s_waitcnt lgkmcnt(0)
    buffer_store_dwordx4 v[148:151], v4, s[24:27], s8 offen offset:0 sc1
    ds_write_b128 v6, v[216:219] offset:6144
    v_mfma_f32_16x16x32_bf16 v[224:227], v[8:11], v[80:83], v[224:227]
    ds_read_b128 v[20:23], v2 offset:46080
    v_cvt_pk_bf16_f32 v210, v212, v213
    v_mfma_f32_16x16x32_bf16 v[224:227], v[12:15], v[96:99], v[224:227]
    ds_read_b128 v[24:27], v2 offset:47104
    v_cvt_pk_bf16_f32 v211, v214, v215
    v_mfma_f32_16x16x32_bf16 v[224:227], v[16:19], v[112:115], v[224:227]
    ds_write_b128 v6, v[208:211] offset:4096
    v_mfma_f32_16x16x32_bf16 v[232:235], v[16:19], v[116:119], v[232:235]
    ds_read_b128 v[28:31], v2 offset:48128
    v_cvt_pk_bf16_f32 v202, v204, v205
    v_mfma_f32_16x16x32_bf16 v[232:235], v[12:15], v[100:103], v[232:235]
    v_cvt_pk_bf16_f32 v203, v206, v207
    v_mfma_f32_16x16x32_bf16 v[232:235], v[8:11], v[84:87], v[232:235]
    s_waitcnt lgkmcnt(5)
    buffer_store_dwordx4 v[180:183], v4, s[24:27], s9 offen offset:0 sc1
    ds_write_b128 v6, v[200:203] offset:2048
    v_mfma_f32_16x16x32_bf16 v[240:243], v[8:11], v[88:91], v[240:243]
    v_cvt_pk_bf16_f32 v194, v196, v197
    v_cvt_pk_bf16_f32 v195, v198, v199
    v_mfma_f32_16x16x32_bf16 v[240:243], v[12:15], v[104:107], v[240:243]
    v_mfma_f32_16x16x32_bf16 v[240:243], v[16:19], v[120:123], v[240:243]
    ds_write_b128 v6, v[192:195] offset:0
    v_mfma_f32_16x16x32_bf16 v[248:251], v[16:19], v[124:127], v[248:251]
    v_cvt_pk_bf16_f32 v224, v224, v225
    v_cvt_pk_bf16_f32 v225, v226, v227
    v_mfma_f32_16x16x32_bf16 v[248:251], v[12:15], v[108:111], v[248:251]
    v_mfma_f32_16x16x32_bf16 v[248:251], v[8:11], v[92:95], v[248:251]
    s_waitcnt vmcnt(22) lgkmcnt(0)
    s_barrier
    v_mfma_f32_16x16x32_bf16 v[252:255], v[20:23], v[92:95], v[252:255]
    ds_read_b128 v[8:11], v5 offset:0
    v_cvt_pk_bf16_f32 v232, v232, v233
    v_mfma_f32_16x16x32_bf16 v[252:255], v[24:27], v[108:111], v[252:255]
    ds_read_b128 v[12:15], v5 offset:1024
    v_cvt_pk_bf16_f32 v233, v234, v235
    v_mfma_f32_16x16x32_bf16 v[252:255], v[28:31], v[124:127], v[252:255]
    buffer_store_dwordx4 v[140:143], v4, s[24:27], s6 offen offset:0 sc1
    v_mfma_f32_16x16x32_bf16 v[244:247], v[28:31], v[120:123], v[244:247]
    ds_read_b128 v[16:19], v5 offset:2048
    v_cvt_pk_bf16_f32 v240, v240, v241
    v_mfma_f32_16x16x32_bf16 v[244:247], v[24:27], v[104:107], v[244:247]
    v_cvt_pk_bf16_f32 v241, v242, v243
    v_mfma_f32_16x16x32_bf16 v[244:247], v[20:23], v[88:91], v[244:247]
    v_mfma_f32_16x16x32_bf16 v[236:239], v[20:23], v[84:87], v[236:239]
    v_cvt_pk_bf16_f32 v248, v248, v249
    v_cvt_pk_bf16_f32 v249, v250, v251
    v_mfma_f32_16x16x32_bf16 v[236:239], v[24:27], v[100:103], v[236:239]
    v_mfma_f32_16x16x32_bf16 v[236:239], v[28:31], v[116:119], v[236:239]
    buffer_store_dwordx4 v[172:175], v4, s[24:27], s7 offen offset:0 sc1
    v_mfma_f32_16x16x32_bf16 v[228:231], v[28:31], v[112:115], v[228:231]
    v_cvt_pk_bf16_f32 v250, v252, v253
    v_cvt_pk_bf16_f32 v251, v254, v255
    v_mfma_f32_16x16x32_bf16 v[228:231], v[24:27], v[96:99], v[228:231]
    v_mfma_f32_16x16x32_bf16 v[228:231], v[20:23], v[80:83], v[228:231]
    s_waitcnt lgkmcnt(0)
    ds_write_b128 v7, v[248:251] offset:6144
    ds_read_b128 v[220:223], v3 offset:6144
    v_mfma_f32_16x16x32_bf16 a[192:195], v[8:11], v[32:35], a[192:195]
    ds_read_b128 v[20:23], v5 offset:12288
    ds_read_b128 v[252:255], v3 offset:7168
    v_mfma_f32_16x16x32_bf16 a[192:195], v[12:15], v[48:51], a[192:195]
    ds_read_b128 v[24:27], v5 offset:13312
    v_cvt_pk_bf16_f32 v242, v244, v245
    v_mfma_f32_16x16x32_bf16 a[192:195], v[16:19], v[64:67], a[192:195]
    buffer_store_dwordx4 v[132:135], v4, s[24:27], s4 offen offset:0 sc1
    v_cvt_pk_bf16_f32 v243, v246, v247
    v_mfma_f32_16x16x32_bf16 a[200:203], v[16:19], v[68:71], a[200:203]
    ds_read_b128 v[28:31], v5 offset:14336
    v_cvt_pk_bf16_f32 v234, v236, v237
    v_mfma_f32_16x16x32_bf16 a[200:203], v[12:15], v[52:55], a[200:203]
    v_cvt_pk_bf16_f32 v235, v238, v239
    v_mfma_f32_16x16x32_bf16 a[200:203], v[8:11], v[36:39], a[200:203]
    s_waitcnt lgkmcnt(6)
    ds_write_b128 v7, v[240:243] offset:4096
    ds_read_b128 v[212:215], v3 offset:4096
    v_mfma_f32_16x16x32_bf16 a[208:211], v[8:11], v[40:43], a[208:211]
    ds_read_b128 v[244:247], v3 offset:5120
    v_cvt_pk_bf16_f32 v226, v228, v229
    v_mfma_f32_16x16x32_bf16 a[208:211], v[12:15], v[56:59], a[208:211]
    v_cvt_pk_bf16_f32 v227, v230, v231
    v_mfma_f32_16x16x32_bf16 a[208:211], v[16:19], v[72:75], a[208:211]
    buffer_store_dwordx4 v[164:167], v4, s[24:27], s5 offen offset:0 sc1
    ds_write_b128 v7, v[232:235] offset:2048
    v_mfma_f32_16x16x32_bf16 a[216:219], v[16:19], v[76:79], a[216:219]
    ds_read_b128 v[204:207], v3 offset:2048
    ds_read_b128 v[236:239], v3 offset:3072
    v_mfma_f32_16x16x32_bf16 a[216:219], v[12:15], v[60:63], a[216:219]
    v_mfma_f32_16x16x32_bf16 a[216:219], v[8:11], v[44:47], a[216:219]
    s_waitcnt lgkmcnt(6)
    ds_write_b128 v7, v[224:227] offset:0
    ds_read_b128 v[196:199], v3 offset:0
    v_mfma_f32_16x16x32_bf16 a[216:219], v[20:23], v[92:95], a[216:219]
    ds_read_b128 v[8:11], v5 offset:3072
    ds_read_b128 v[228:231], v3 offset:1024
    v_mfma_f32_16x16x32_bf16 a[216:219], v[24:27], v[108:111], a[216:219]
    ds_read_b128 v[12:15], v5 offset:4096
    v_mfma_f32_16x16x32_bf16 a[216:219], v[28:31], v[124:127], a[216:219]
    buffer_store_dwordx4 v[220:223], v4, s[24:27], s10 offen offset:128 sc1
    v_mfma_f32_16x16x32_bf16 a[208:211], v[28:31], v[120:123], a[208:211]
    ds_read_b128 v[16:19], v5 offset:5120
    v_mfma_f32_16x16x32_bf16 a[208:211], v[24:27], v[104:107], a[208:211]
    v_mfma_f32_16x16x32_bf16 a[208:211], v[20:23], v[88:91], a[208:211]
    s_waitcnt lgkmcnt(12)
    v_mfma_f32_16x16x32_bf16 a[200:203], v[20:23], v[84:87], a[200:203]
    v_mfma_f32_16x16x32_bf16 a[200:203], v[24:27], v[100:103], a[200:203]
    v_mfma_f32_16x16x32_bf16 a[200:203], v[28:31], v[116:119], a[200:203]
    buffer_store_dwordx4 v[252:255], v4, s[24:27], s11 offen offset:128 sc1
    v_mfma_f32_16x16x32_bf16 a[192:195], v[28:31], v[112:115], a[192:195]
    v_accvgpr_read_b32 v152, a216
    v_accvgpr_read_b32 v153, a217
    v_mfma_f32_16x16x32_bf16 a[192:195], v[24:27], v[96:99], a[192:195]
    v_accvgpr_read_b32 v154, a218
    v_accvgpr_read_b32 v155, a219
    v_mfma_f32_16x16x32_bf16 a[192:195], v[20:23], v[80:83], a[192:195]
    s_waitcnt lgkmcnt(0)
    v_cvt_pk_bf16_f32 v152, v152, v153
    v_cvt_pk_bf16_f32 v153, v154, v155
    v_mfma_f32_16x16x32_bf16 a[196:199], v[8:11], v[32:35], a[196:199]
    ds_read_b128 v[20:23], v5 offset:15360
    v_accvgpr_read_b32 v144, a208
    v_mfma_f32_16x16x32_bf16 a[196:199], v[12:15], v[48:51], a[196:199]
    ds_read_b128 v[24:27], v5 offset:16384
    v_accvgpr_read_b32 v145, a209
    v_mfma_f32_16x16x32_bf16 a[196:199], v[16:19], v[64:67], a[196:199]
    buffer_store_dwordx4 v[212:215], v4, s[24:27], s8 offen offset:128 sc1
    v_accvgpr_read_b32 v146, a210
    v_accvgpr_read_b32 v147, a211
    v_cvt_pk_bf16_f32 v144, v144, v145
    v_mfma_f32_16x16x32_bf16 a[204:207], v[16:19], v[68:71], a[204:207]
    ds_read_b128 v[28:31], v5 offset:17408
    v_cvt_pk_bf16_f32 v145, v146, v147
    v_mfma_f32_16x16x32_bf16 a[204:207], v[12:15], v[52:55], a[204:207]
    v_accvgpr_read_b32 v136, a200
    v_accvgpr_read_b32 v137, a201
    v_mfma_f32_16x16x32_bf16 a[204:207], v[8:11], v[36:39], a[204:207]
    s_waitcnt lgkmcnt(3)
    v_accvgpr_read_b32 v138, a202
    v_accvgpr_read_b32 v139, a203
    v_mfma_f32_16x16x32_bf16 a[212:215], v[8:11], v[40:43], a[212:215]
    v_cvt_pk_bf16_f32 v136, v136, v137
    v_cvt_pk_bf16_f32 v137, v138, v139
    v_mfma_f32_16x16x32_bf16 a[212:215], v[12:15], v[56:59], a[212:215]
    v_accvgpr_read_b32 v128, a192
    v_accvgpr_read_b32 v129, a193
    v_mfma_f32_16x16x32_bf16 a[212:215], v[16:19], v[72:75], a[212:215]
    buffer_store_dwordx4 v[244:247], v4, s[24:27], s9 offen offset:128 sc1
    v_accvgpr_read_b32 v130, a194
    v_accvgpr_read_b32 v131, a195
    v_cvt_pk_bf16_f32 v128, v128, v129
    v_mfma_f32_16x16x32_bf16 a[220:223], v[16:19], v[76:79], a[220:223]
    v_cvt_pk_bf16_f32 v129, v130, v131
    v_mfma_f32_16x16x32_bf16 a[220:223], v[12:15], v[60:63], a[220:223]
    v_mfma_f32_16x16x32_bf16 a[220:223], v[8:11], v[44:47], a[220:223]
    s_waitcnt lgkmcnt(0)
    v_mfma_f32_16x16x32_bf16 a[220:223], v[20:23], v[92:95], a[220:223]
    ds_read_b128 v[8:11], v5 offset:6144
    v_mfma_f32_16x16x32_bf16 a[220:223], v[24:27], v[108:111], a[220:223]
    ds_read_b128 v[12:15], v5 offset:7168
    v_mfma_f32_16x16x32_bf16 a[220:223], v[28:31], v[124:127], a[220:223]
    buffer_store_dwordx4 v[204:207], v4, s[24:27], s6 offen offset:128 sc1
    v_mfma_f32_16x16x32_bf16 a[212:215], v[28:31], v[120:123], a[212:215]
    ds_read_b128 v[16:19], v5 offset:8192
    v_mfma_f32_16x16x32_bf16 a[212:215], v[24:27], v[104:107], a[212:215]
    v_mfma_f32_16x16x32_bf16 a[212:215], v[20:23], v[88:91], a[212:215]
    s_waitcnt lgkmcnt(3)
    v_mfma_f32_16x16x32_bf16 a[204:207], v[20:23], v[84:87], a[204:207]
    v_mfma_f32_16x16x32_bf16 a[204:207], v[24:27], v[100:103], a[204:207]
    v_mfma_f32_16x16x32_bf16 a[204:207], v[28:31], v[116:119], a[204:207]
    buffer_store_dwordx4 v[236:239], v4, s[24:27], s7 offen offset:128 sc1
    v_mfma_f32_16x16x32_bf16 a[196:199], v[28:31], v[112:115], a[196:199]
    v_accvgpr_read_b32 v156, a220
    v_accvgpr_read_b32 v157, a221
    v_mfma_f32_16x16x32_bf16 a[196:199], v[24:27], v[96:99], a[196:199]
    v_accvgpr_read_b32 v158, a222
    v_accvgpr_read_b32 v159, a223
    v_mfma_f32_16x16x32_bf16 a[196:199], v[20:23], v[80:83], a[196:199]
    s_waitcnt lgkmcnt(0)
    v_cvt_pk_bf16_f32 v154, v156, v157
    v_cvt_pk_bf16_f32 v155, v158, v159
    v_mfma_f32_16x16x32_bf16 a[224:227], v[8:11], v[32:35], a[224:227]
    ds_read_b128 v[20:23], v5 offset:18432
    v_accvgpr_read_b32 v148, a212
    v_mfma_f32_16x16x32_bf16 a[224:227], v[12:15], v[48:51], a[224:227]
    ds_read_b128 v[24:27], v5 offset:19456
    v_accvgpr_read_b32 v149, a213
    v_mfma_f32_16x16x32_bf16 a[224:227], v[16:19], v[64:67], a[224:227]
    buffer_store_dwordx4 v[196:199], v4, s[24:27], s4 offen offset:128 sc1
    ds_write_b128 v6, v[152:155] offset:6144
    v_accvgpr_read_b32 v150, a214
    v_accvgpr_read_b32 v151, a215
    v_mfma_f32_16x16x32_bf16 a[232:235], v[16:19], v[68:71], a[232:235]
    ds_read_b128 v[28:31], v5 offset:20480
    v_cvt_pk_bf16_f32 v146, v148, v149
    v_mfma_f32_16x16x32_bf16 a[232:235], v[12:15], v[52:55], a[232:235]
    v_cvt_pk_bf16_f32 v147, v150, v151
    v_accvgpr_read_b32 v140, a204
    v_mfma_f32_16x16x32_bf16 a[232:235], v[8:11], v[36:39], a[232:235]
    s_waitcnt lgkmcnt(4)
    ds_write_b128 v6, v[144:147] offset:4096
    v_accvgpr_read_b32 v141, a205
    v_mfma_f32_16x16x32_bf16 a[240:243], v[8:11], v[40:43], a[240:243]
    v_accvgpr_read_b32 v142, a206
    v_accvgpr_read_b32 v143, a207
    v_mfma_f32_16x16x32_bf16 a[240:243], v[12:15], v[56:59], a[240:243]
    v_cvt_pk_bf16_f32 v138, v140, v141
    v_cvt_pk_bf16_f32 v139, v142, v143
    v_mfma_f32_16x16x32_bf16 a[240:243], v[16:19], v[72:75], a[240:243]
    buffer_store_dwordx4 v[228:231], v4, s[24:27], s5 offen offset:128 sc1
    ds_write_b128 v6, v[136:139] offset:2048
    v_accvgpr_read_b32 v132, a196
    v_accvgpr_read_b32 v133, a197
    v_mfma_f32_16x16x32_bf16 a[248:251], v[16:19], v[76:79], a[248:251]
    v_accvgpr_read_b32 v134, a198
    v_accvgpr_read_b32 v135, a199
    v_mfma_f32_16x16x32_bf16 a[248:251], v[12:15], v[60:63], a[248:251]
    v_cvt_pk_bf16_f32 v130, v132, v133
    v_cvt_pk_bf16_f32 v131, v134, v135
    v_mfma_f32_16x16x32_bf16 a[248:251], v[8:11], v[44:47], a[248:251]
    s_waitcnt lgkmcnt(2)
    ds_write_b128 v6, v[128:131] offset:0
    v_mfma_f32_16x16x32_bf16 a[248:251], v[20:23], v[92:95], a[248:251]
    ds_read_b128 v[8:11], v5 offset:9216
    v_mfma_f32_16x16x32_bf16 a[248:251], v[24:27], v[108:111], a[248:251]
    ds_read_b128 v[12:15], v5 offset:10240
    v_mfma_f32_16x16x32_bf16 a[248:251], v[28:31], v[124:127], a[248:251]
    v_mfma_f32_16x16x32_bf16 a[240:243], v[28:31], v[120:123], a[240:243]
    ds_read_b128 v[16:19], v5 offset:11264
    v_mfma_f32_16x16x32_bf16 a[240:243], v[24:27], v[104:107], a[240:243]
    v_mfma_f32_16x16x32_bf16 a[240:243], v[20:23], v[88:91], a[240:243]
    s_waitcnt lgkmcnt(6)
    v_mfma_f32_16x16x32_bf16 a[232:235], v[20:23], v[84:87], a[232:235]
    v_mfma_f32_16x16x32_bf16 a[232:235], v[24:27], v[100:103], a[232:235]
    v_mfma_f32_16x16x32_bf16 a[232:235], v[28:31], v[116:119], a[232:235]
    v_mfma_f32_16x16x32_bf16 a[224:227], v[28:31], v[112:115], a[224:227]
    v_accvgpr_read_b32 v184, a248
    v_accvgpr_read_b32 v185, a249
    v_mfma_f32_16x16x32_bf16 a[224:227], v[24:27], v[96:99], a[224:227]
    v_accvgpr_read_b32 v186, a250
    v_accvgpr_read_b32 v187, a251
    v_mfma_f32_16x16x32_bf16 a[224:227], v[20:23], v[80:83], a[224:227]
    s_waitcnt lgkmcnt(0)
    v_cvt_pk_bf16_f32 v184, v184, v185
    v_cvt_pk_bf16_f32 v185, v186, v187
    v_mfma_f32_16x16x32_bf16 a[228:231], v[8:11], v[32:35], a[228:231]
    ds_read_b128 v[20:23], v5 offset:21504
    v_accvgpr_read_b32 v176, a240
    v_mfma_f32_16x16x32_bf16 a[228:231], v[12:15], v[48:51], a[228:231]
    ds_read_b128 v[24:27], v5 offset:22528
    v_accvgpr_read_b32 v177, a241
    v_mfma_f32_16x16x32_bf16 a[228:231], v[16:19], v[64:67], a[228:231]
    v_accvgpr_read_b32 v178, a242
    v_accvgpr_read_b32 v179, a243
    v_mfma_f32_16x16x32_bf16 a[236:239], v[16:19], v[68:71], a[236:239]
    ds_read_b128 v[28:31], v5 offset:23552
    v_cvt_pk_bf16_f32 v176, v176, v177
    v_mfma_f32_16x16x32_bf16 a[236:239], v[12:15], v[52:55], a[236:239]
    v_cvt_pk_bf16_f32 v177, v178, v179
    v_accvgpr_read_b32 v168, a232
    v_mfma_f32_16x16x32_bf16 a[236:239], v[8:11], v[36:39], a[236:239]
    s_waitcnt lgkmcnt(3)
    v_accvgpr_read_b32 v169, a233
    v_accvgpr_read_b32 v170, a234
    v_mfma_f32_16x16x32_bf16 a[244:247], v[8:11], v[40:43], a[244:247]
    v_accvgpr_read_b32 v171, a235
    v_cvt_pk_bf16_f32 v168, v168, v169
    v_mfma_f32_16x16x32_bf16 a[244:247], v[12:15], v[56:59], a[244:247]
    v_cvt_pk_bf16_f32 v169, v170, v171
    v_accvgpr_read_b32 v160, a224
    v_mfma_f32_16x16x32_bf16 a[244:247], v[16:19], v[72:75], a[244:247]
    v_accvgpr_read_b32 v161, a225
    v_accvgpr_read_b32 v162, a226
    v_mfma_f32_16x16x32_bf16 a[252:255], v[16:19], v[76:79], a[252:255]
    v_accvgpr_read_b32 v163, a227
    v_cvt_pk_bf16_f32 v160, v160, v161
    v_mfma_f32_16x16x32_bf16 a[252:255], v[12:15], v[60:63], a[252:255]
    v_cvt_pk_bf16_f32 v161, v162, v163
    v_mfma_f32_16x16x32_bf16 a[252:255], v[8:11], v[44:47], a[252:255]
    s_waitcnt vmcnt(14) lgkmcnt(0)
    s_barrier
    v_mfma_f32_16x16x32_bf16 a[252:255], v[20:23], v[92:95], a[252:255]
    ds_read_b128 v[8:11], v2 offset:0
    v_mfma_f32_16x16x32_bf16 a[252:255], v[24:27], v[108:111], a[252:255]
    ds_read_b128 v[12:15], v2 offset:1024
    v_mfma_f32_16x16x32_bf16 a[252:255], v[28:31], v[124:127], a[252:255]
    v_mfma_f32_16x16x32_bf16 a[244:247], v[28:31], v[120:123], a[244:247]
    ds_read_b128 v[16:19], v2 offset:2048
    v_mfma_f32_16x16x32_bf16 a[244:247], v[24:27], v[104:107], a[244:247]
    v_mfma_f32_16x16x32_bf16 a[244:247], v[20:23], v[88:91], a[244:247]
    v_mfma_f32_16x16x32_bf16 a[236:239], v[20:23], v[84:87], a[236:239]
    v_mfma_f32_16x16x32_bf16 a[236:239], v[24:27], v[100:103], a[236:239]
    v_mfma_f32_16x16x32_bf16 a[236:239], v[28:31], v[116:119], a[236:239]
    v_mfma_f32_16x16x32_bf16 a[228:231], v[28:31], v[112:115], a[228:231]
    v_accvgpr_read_b32 v188, a252
    v_accvgpr_read_b32 v189, a253
    v_mfma_f32_16x16x32_bf16 a[228:231], v[24:27], v[96:99], a[228:231]
    v_accvgpr_read_b32 v190, a254
    v_accvgpr_read_b32 v191, a255
    v_mfma_f32_16x16x32_bf16 a[228:231], v[20:23], v[80:83], a[228:231]
    s_waitcnt lgkmcnt(0)
    v_cvt_pk_bf16_f32 v186, v188, v189
    v_cvt_pk_bf16_f32 v187, v190, v191
    v_mfma_f32_16x16x32_bf16 a[188:191], v[8:11], v[32:35], a[188:191]
    ds_read_b128 v[20:23], v2 offset:12288
    v_accvgpr_read_b32 v180, a244
    v_mfma_f32_16x16x32_bf16 a[188:191], v[12:15], v[48:51], a[188:191]
    ds_read_b128 v[24:27], v2 offset:13312
    v_accvgpr_read_b32 v181, a245
    v_mfma_f32_16x16x32_bf16 a[188:191], v[16:19], v[64:67], a[188:191]
    ds_write_b128 v7, v[184:187] offset:6144
    ds_read_b128 v[156:159], v3 offset:6144
    v_mfma_f32_16x16x32_bf16 a[48:51], v[16:19], v[68:71], a[48:51]
    ds_read_b128 v[28:31], v2 offset:14336
    ds_read_b128 v[188:191], v3 offset:7168
    v_mfma_f32_16x16x32_bf16 a[48:51], v[12:15], v[52:55], a[48:51]
    v_accvgpr_read_b32 v182, a246
    v_accvgpr_read_b32 v183, a247
    v_mfma_f32_16x16x32_bf16 a[48:51], v[8:11], v[36:39], a[48:51]
    s_waitcnt lgkmcnt(6)
    v_cvt_pk_bf16_f32 v178, v180, v181
    v_cvt_pk_bf16_f32 v179, v182, v183
    v_mfma_f32_16x16x32_bf16 a[144:147], v[8:11], v[40:43], a[144:147]
    v_accvgpr_read_b32 v172, a236
    v_accvgpr_read_b32 v173, a237
    v_mfma_f32_16x16x32_bf16 a[144:147], v[12:15], v[56:59], a[144:147]
    v_accvgpr_read_b32 v174, a238
    v_accvgpr_read_b32 v175, a239
    v_mfma_f32_16x16x32_bf16 a[144:147], v[16:19], v[72:75], a[144:147]
    ds_write_b128 v7, v[176:179] offset:4096
    ds_read_b128 v[148:151], v3 offset:4096
    v_mfma_f32_16x16x32_bf16 a[52:55], v[16:19], v[76:79], a[52:55]
    ds_read_b128 v[180:183], v3 offset:5120
    v_cvt_pk_bf16_f32 v170, v172, v173
    v_mfma_f32_16x16x32_bf16 a[52:55], v[12:15], v[60:63], a[52:55]
    v_cvt_pk_bf16_f32 v171, v174, v175
    v_accvgpr_read_b32 v164, a228
    v_mfma_f32_16x16x32_bf16 a[52:55], v[8:11], v[44:47], a[52:55]
    s_waitcnt lgkmcnt(4)
    ds_write_b128 v7, v[168:171] offset:2048
    ds_read_b128 v[140:143], v3 offset:2048
    v_mfma_f32_16x16x32_bf16 a[52:55], v[20:23], v[92:95], a[52:55]
    ds_read_b128 v[8:11], v2 offset:3072
    ds_read_b128 v[172:175], v3 offset:3072
    v_mfma_f32_16x16x32_bf16 a[52:55], v[24:27], v[108:111], a[52:55]
    ds_read_b128 v[12:15], v2 offset:4096
    v_accvgpr_read_b32 v165, a229
    v_mfma_f32_16x16x32_bf16 a[52:55], v[28:31], v[124:127], a[52:55]
    buffer_store_dwordx4 v[156:159], v4, s[24:27], s10 offen offset:256 sc1
    v_accvgpr_read_b32 v166, a230
    v_accvgpr_read_b32 v167, a231
    v_cvt_pk_bf16_f32 v162, v164, v165
    v_mfma_f32_16x16x32_bf16 a[144:147], v[28:31], v[120:123], a[144:147]
    ds_read_b128 v[16:19], v2 offset:5120
    v_cvt_pk_bf16_f32 v163, v166, v167
    v_mfma_f32_16x16x32_bf16 a[144:147], v[24:27], v[104:107], a[144:147]
    v_mfma_f32_16x16x32_bf16 a[144:147], v[20:23], v[88:91], a[144:147]
    s_waitcnt lgkmcnt(9)
    ds_write_b128 v7, v[160:163] offset:0
    ds_read_b128 v[132:135], v3 offset:0
    v_mfma_f32_16x16x32_bf16 a[48:51], v[20:23], v[84:87], a[48:51]
    ds_read_b128 v[164:167], v3 offset:1024
    v_mfma_f32_16x16x32_bf16 a[48:51], v[24:27], v[100:103], a[48:51]
    v_mfma_f32_16x16x32_bf16 a[48:51], v[28:31], v[116:119], a[48:51]
    buffer_store_dwordx4 v[188:191], v4, s[24:27], s11 offen offset:256 sc1
    v_mfma_f32_16x16x32_bf16 a[188:191], v[28:31], v[112:115], a[188:191]
    v_accvgpr_read_b32 v216, a52
    v_accvgpr_read_b32 v217, a53
    v_mfma_f32_16x16x32_bf16 a[188:191], v[24:27], v[96:99], a[188:191]
    v_accvgpr_read_b32 v218, a54
    v_accvgpr_read_b32 v219, a55
    v_mfma_f32_16x16x32_bf16 a[188:191], v[20:23], v[80:83], a[188:191]
    s_waitcnt lgkmcnt(3)
    v_cvt_pk_bf16_f32 v216, v216, v217
    v_cvt_pk_bf16_f32 v217, v218, v219
    v_mfma_f32_16x16x32_bf16 a[0:3], v[8:11], v[32:35], a[0:3]
    ds_read_b128 v[20:23], v2 offset:15360
    v_accvgpr_read_b32 v208, a144
    v_mfma_f32_16x16x32_bf16 a[0:3], v[12:15], v[48:51], a[0:3]
    ds_read_b128 v[24:27], v2 offset:16384
    v_accvgpr_read_b32 v209, a145
    v_mfma_f32_16x16x32_bf16 a[0:3], v[16:19], v[64:67], a[0:3]
    buffer_store_dwordx4 v[148:151], v4, s[24:27], s8 offen offset:256 sc1
    v_accvgpr_read_b32 v210, a146
    v_accvgpr_read_b32 v211, a147
    v_cvt_pk_bf16_f32 v208, v208, v209
    v_mfma_f32_16x16x32_bf16 a[96:99], v[16:19], v[68:71], a[96:99]
    ds_read_b128 v[28:31], v2 offset:17408
    v_cvt_pk_bf16_f32 v209, v210, v211
    v_mfma_f32_16x16x32_bf16 a[96:99], v[12:15], v[52:55], a[96:99]
    v_accvgpr_read_b32 v200, a48
    v_accvgpr_read_b32 v201, a49
    v_mfma_f32_16x16x32_bf16 a[96:99], v[8:11], v[36:39], a[96:99]
    s_waitcnt lgkmcnt(6)
    v_accvgpr_read_b32 v202, a50
    v_accvgpr_read_b32 v203, a51
    v_mfma_f32_16x16x32_bf16 a[4:7], v[8:11], v[40:43], a[4:7]
    v_cvt_pk_bf16_f32 v200, v200, v201
    v_cvt_pk_bf16_f32 v201, v202, v203
    v_mfma_f32_16x16x32_bf16 a[4:7], v[12:15], v[56:59], a[4:7]
    v_accvgpr_read_b32 v192, a188
    v_accvgpr_read_b32 v193, a189
    v_mfma_f32_16x16x32_bf16 a[4:7], v[16:19], v[72:75], a[4:7]
    buffer_store_dwordx4 v[180:183], v4, s[24:27], s9 offen offset:256 sc1
    v_accvgpr_read_b32 v194, a190
    v_accvgpr_read_b32 v195, a191
    v_cvt_pk_bf16_f32 v192, v192, v193
    v_mfma_f32_16x16x32_bf16 a[100:103], v[16:19], v[76:79], a[100:103]
    v_cvt_pk_bf16_f32 v193, v194, v195
    v_mfma_f32_16x16x32_bf16 a[100:103], v[12:15], v[60:63], a[100:103]
    v_mfma_f32_16x16x32_bf16 a[100:103], v[8:11], v[44:47], a[100:103]
    s_waitcnt lgkmcnt(0)
    v_mfma_f32_16x16x32_bf16 a[100:103], v[20:23], v[92:95], a[100:103]
    ds_read_b128 v[8:11], v2 offset:6144
    v_mfma_f32_16x16x32_bf16 a[100:103], v[24:27], v[108:111], a[100:103]
    ds_read_b128 v[12:15], v2 offset:7168
    v_mfma_f32_16x16x32_bf16 a[100:103], v[28:31], v[124:127], a[100:103]
    buffer_store_dwordx4 v[140:143], v4, s[24:27], s6 offen offset:256 sc1
    v_mfma_f32_16x16x32_bf16 a[4:7], v[28:31], v[120:123], a[4:7]
    ds_read_b128 v[16:19], v2 offset:8192
    v_mfma_f32_16x16x32_bf16 a[4:7], v[24:27], v[104:107], a[4:7]
    v_mfma_f32_16x16x32_bf16 a[4:7], v[20:23], v[88:91], a[4:7]
    s_waitcnt lgkmcnt(3)
    v_mfma_f32_16x16x32_bf16 a[96:99], v[20:23], v[84:87], a[96:99]
    v_mfma_f32_16x16x32_bf16 a[96:99], v[24:27], v[100:103], a[96:99]
    v_mfma_f32_16x16x32_bf16 a[96:99], v[28:31], v[116:119], a[96:99]
    buffer_store_dwordx4 v[172:175], v4, s[24:27], s7 offen offset:256 sc1
    v_mfma_f32_16x16x32_bf16 a[0:3], v[28:31], v[112:115], a[0:3]
    v_accvgpr_read_b32 v220, a100
    v_accvgpr_read_b32 v221, a101
    v_mfma_f32_16x16x32_bf16 a[0:3], v[24:27], v[96:99], a[0:3]
    v_accvgpr_read_b32 v222, a102
    v_accvgpr_read_b32 v223, a103
    v_mfma_f32_16x16x32_bf16 a[0:3], v[20:23], v[80:83], a[0:3]
    s_waitcnt lgkmcnt(0)
    v_cvt_pk_bf16_f32 v218, v220, v221
    v_cvt_pk_bf16_f32 v219, v222, v223
    v_mfma_f32_16x16x32_bf16 a[148:151], v[8:11], v[32:35], a[148:151]
    ds_read_b128 v[20:23], v2 offset:18432
    v_accvgpr_read_b32 v212, a4
    v_mfma_f32_16x16x32_bf16 a[148:151], v[12:15], v[48:51], a[148:151]
    ds_read_b128 v[24:27], v2 offset:19456
    v_accvgpr_read_b32 v213, a5
    v_mfma_f32_16x16x32_bf16 a[148:151], v[16:19], v[64:67], a[148:151]
    buffer_store_dwordx4 v[132:135], v4, s[24:27], s4 offen offset:256 sc1
    ds_write_b128 v6, v[216:219] offset:6144
    v_accvgpr_read_b32 v214, a6
    v_accvgpr_read_b32 v215, a7
    v_mfma_f32_16x16x32_bf16 a[56:59], v[16:19], v[68:71], a[56:59]
    ds_read_b128 v[28:31], v2 offset:20480
    v_cvt_pk_bf16_f32 v210, v212, v213
    v_mfma_f32_16x16x32_bf16 a[56:59], v[12:15], v[52:55], a[56:59]
    v_cvt_pk_bf16_f32 v211, v214, v215
    v_accvgpr_read_b32 v204, a96
    v_mfma_f32_16x16x32_bf16 a[56:59], v[8:11], v[36:39], a[56:59]
    s_waitcnt lgkmcnt(4)
    ds_write_b128 v6, v[208:211] offset:4096
    v_accvgpr_read_b32 v205, a97
    v_mfma_f32_16x16x32_bf16 a[152:155], v[8:11], v[40:43], a[152:155]
    v_accvgpr_read_b32 v206, a98
    v_accvgpr_read_b32 v207, a99
    v_mfma_f32_16x16x32_bf16 a[152:155], v[12:15], v[56:59], a[152:155]
    v_cvt_pk_bf16_f32 v202, v204, v205
    v_cvt_pk_bf16_f32 v203, v206, v207
    v_mfma_f32_16x16x32_bf16 a[152:155], v[16:19], v[72:75], a[152:155]
    buffer_store_dwordx4 v[164:167], v4, s[24:27], s5 offen offset:256 sc1
    ds_write_b128 v6, v[200:203] offset:2048
    v_accvgpr_read_b32 v196, a0
    v_accvgpr_read_b32 v197, a1
    v_mfma_f32_16x16x32_bf16 a[60:63], v[16:19], v[76:79], a[60:63]
    v_accvgpr_read_b32 v198, a2
    v_accvgpr_read_b32 v199, a3
    v_mfma_f32_16x16x32_bf16 a[60:63], v[12:15], v[60:63], a[60:63]
    v_cvt_pk_bf16_f32 v194, v196, v197
    v_cvt_pk_bf16_f32 v195, v198, v199
    v_mfma_f32_16x16x32_bf16 a[60:63], v[8:11], v[44:47], a[60:63]
    s_waitcnt lgkmcnt(2)
    ds_write_b128 v6, v[192:195] offset:0
    v_mfma_f32_16x16x32_bf16 a[60:63], v[20:23], v[92:95], a[60:63]
    ds_read_b128 v[8:11], v2 offset:9216
    v_mfma_f32_16x16x32_bf16 a[60:63], v[24:27], v[108:111], a[60:63]
    ds_read_b128 v[12:15], v2 offset:10240
    v_mfma_f32_16x16x32_bf16 a[60:63], v[28:31], v[124:127], a[60:63]
    v_mfma_f32_16x16x32_bf16 a[152:155], v[28:31], v[120:123], a[152:155]
    ds_read_b128 v[16:19], v2 offset:11264
    v_mfma_f32_16x16x32_bf16 a[152:155], v[24:27], v[104:107], a[152:155]
    v_mfma_f32_16x16x32_bf16 a[152:155], v[20:23], v[88:91], a[152:155]
    s_waitcnt lgkmcnt(6)
    v_mfma_f32_16x16x32_bf16 a[56:59], v[20:23], v[84:87], a[56:59]
    v_mfma_f32_16x16x32_bf16 a[56:59], v[24:27], v[100:103], a[56:59]
    v_mfma_f32_16x16x32_bf16 a[56:59], v[28:31], v[116:119], a[56:59]
    v_mfma_f32_16x16x32_bf16 a[148:151], v[28:31], v[112:115], a[148:151]
    v_accvgpr_read_b32 v248, a60
    v_accvgpr_read_b32 v249, a61
    v_mfma_f32_16x16x32_bf16 a[148:151], v[24:27], v[96:99], a[148:151]
    v_accvgpr_read_b32 v250, a62
    v_accvgpr_read_b32 v251, a63
    v_mfma_f32_16x16x32_bf16 a[148:151], v[20:23], v[80:83], a[148:151]
    s_waitcnt lgkmcnt(0)
    v_cvt_pk_bf16_f32 v248, v248, v249
    v_cvt_pk_bf16_f32 v249, v250, v251
    v_mfma_f32_16x16x32_bf16 a[8:11], v[8:11], v[32:35], a[8:11]
    ds_read_b128 v[20:23], v2 offset:21504
    v_accvgpr_read_b32 v240, a152
    v_mfma_f32_16x16x32_bf16 a[8:11], v[12:15], v[48:51], a[8:11]
    ds_read_b128 v[24:27], v2 offset:22528
    v_accvgpr_read_b32 v241, a153
    v_mfma_f32_16x16x32_bf16 a[8:11], v[16:19], v[64:67], a[8:11]
    v_accvgpr_read_b32 v242, a154
    v_accvgpr_read_b32 v243, a155
    v_mfma_f32_16x16x32_bf16 a[104:107], v[16:19], v[68:71], a[104:107]
    ds_read_b128 v[28:31], v2 offset:23552
    v_cvt_pk_bf16_f32 v240, v240, v241
    v_mfma_f32_16x16x32_bf16 a[104:107], v[12:15], v[52:55], a[104:107]
    v_cvt_pk_bf16_f32 v241, v242, v243
    v_accvgpr_read_b32 v232, a56
    v_mfma_f32_16x16x32_bf16 a[104:107], v[8:11], v[36:39], a[104:107]
    s_waitcnt lgkmcnt(3)
    v_accvgpr_read_b32 v233, a57
    v_accvgpr_read_b32 v234, a58
    v_mfma_f32_16x16x32_bf16 a[12:15], v[8:11], v[40:43], a[12:15]
    v_accvgpr_read_b32 v235, a59
    v_cvt_pk_bf16_f32 v232, v232, v233
    v_mfma_f32_16x16x32_bf16 a[12:15], v[12:15], v[56:59], a[12:15]
    v_cvt_pk_bf16_f32 v233, v234, v235
    v_accvgpr_read_b32 v224, a148
    v_mfma_f32_16x16x32_bf16 a[12:15], v[16:19], v[72:75], a[12:15]
    v_accvgpr_read_b32 v225, a149
    v_accvgpr_read_b32 v226, a150
    v_mfma_f32_16x16x32_bf16 a[108:111], v[16:19], v[76:79], a[108:111]
    v_accvgpr_read_b32 v227, a151
    v_cvt_pk_bf16_f32 v224, v224, v225
    v_mfma_f32_16x16x32_bf16 a[108:111], v[12:15], v[60:63], a[108:111]
    v_cvt_pk_bf16_f32 v225, v226, v227
    v_mfma_f32_16x16x32_bf16 a[108:111], v[8:11], v[44:47], a[108:111]
    s_waitcnt lgkmcnt(0)
    v_mfma_f32_16x16x32_bf16 a[108:111], v[20:23], v[92:95], a[108:111]
    ds_read_b128 v[8:11], v1 offset:0
    v_mfma_f32_16x16x32_bf16 a[108:111], v[24:27], v[108:111], a[108:111]
    ds_read_b128 v[12:15], v1 offset:1024
    v_mfma_f32_16x16x32_bf16 a[108:111], v[28:31], v[124:127], a[108:111]
    v_mfma_f32_16x16x32_bf16 a[12:15], v[28:31], v[120:123], a[12:15]
    ds_read_b128 v[16:19], v1 offset:2048
    v_mfma_f32_16x16x32_bf16 a[12:15], v[24:27], v[104:107], a[12:15]
    v_mfma_f32_16x16x32_bf16 a[12:15], v[20:23], v[88:91], a[12:15]
    s_waitcnt lgkmcnt(3)
    v_mfma_f32_16x16x32_bf16 a[104:107], v[20:23], v[84:87], a[104:107]
    v_mfma_f32_16x16x32_bf16 a[104:107], v[24:27], v[100:103], a[104:107]
    v_mfma_f32_16x16x32_bf16 a[104:107], v[28:31], v[116:119], a[104:107]
    v_mfma_f32_16x16x32_bf16 a[8:11], v[28:31], v[112:115], a[8:11]
    v_accvgpr_read_b32 v252, a108
    v_accvgpr_read_b32 v253, a109
    v_mfma_f32_16x16x32_bf16 a[8:11], v[24:27], v[96:99], a[8:11]
    v_accvgpr_read_b32 v254, a110
    v_accvgpr_read_b32 v255, a111
    v_mfma_f32_16x16x32_bf16 a[8:11], v[20:23], v[80:83], a[8:11]
    s_waitcnt lgkmcnt(0)
    v_cvt_pk_bf16_f32 v250, v252, v253
    v_cvt_pk_bf16_f32 v251, v254, v255
    v_mfma_f32_16x16x32_bf16 a[156:159], v[8:11], v[32:35], a[156:159]
    ds_read_b128 v[20:23], v1 offset:12288
    v_accvgpr_read_b32 v244, a12
    v_mfma_f32_16x16x32_bf16 a[156:159], v[12:15], v[48:51], a[156:159]
    ds_read_b128 v[24:27], v1 offset:13312
    v_accvgpr_read_b32 v245, a13
    v_mfma_f32_16x16x32_bf16 a[156:159], v[16:19], v[64:67], a[156:159]
    ds_write_b128 v7, v[248:251] offset:6144
    ds_read_b128 v[220:223], v3 offset:6144
    v_mfma_f32_16x16x32_bf16 a[64:67], v[16:19], v[68:71], a[64:67]
    ds_read_b128 v[28:31], v1 offset:14336
    ds_read_b128 v[252:255], v3 offset:7168
    v_mfma_f32_16x16x32_bf16 a[64:67], v[12:15], v[52:55], a[64:67]
    v_accvgpr_read_b32 v246, a14
    v_accvgpr_read_b32 v247, a15
    v_mfma_f32_16x16x32_bf16 a[64:67], v[8:11], v[36:39], a[64:67]
    s_waitcnt lgkmcnt(6)
    v_cvt_pk_bf16_f32 v242, v244, v245
    v_cvt_pk_bf16_f32 v243, v246, v247
    v_mfma_f32_16x16x32_bf16 a[160:163], v[8:11], v[40:43], a[160:163]
    v_accvgpr_read_b32 v236, a104
    v_accvgpr_read_b32 v237, a105
    v_mfma_f32_16x16x32_bf16 a[160:163], v[12:15], v[56:59], a[160:163]
    v_accvgpr_read_b32 v238, a106
    v_accvgpr_read_b32 v239, a107
    v_mfma_f32_16x16x32_bf16 a[160:163], v[16:19], v[72:75], a[160:163]
    ds_write_b128 v7, v[240:243] offset:4096
    ds_read_b128 v[212:215], v3 offset:4096
    v_mfma_f32_16x16x32_bf16 a[68:71], v[16:19], v[76:79], a[68:71]
    ds_read_b128 v[244:247], v3 offset:5120
    v_cvt_pk_bf16_f32 v234, v236, v237
    v_mfma_f32_16x16x32_bf16 a[68:71], v[12:15], v[60:63], a[68:71]
    v_cvt_pk_bf16_f32 v235, v238, v239
    v_accvgpr_read_b32 v228, a8
    v_mfma_f32_16x16x32_bf16 a[68:71], v[8:11], v[44:47], a[68:71]
    s_waitcnt lgkmcnt(4)
    ds_write_b128 v7, v[232:235] offset:2048
    ds_read_b128 v[204:207], v3 offset:2048
    v_mfma_f32_16x16x32_bf16 a[68:71], v[20:23], v[92:95], a[68:71]
    ds_read_b128 v[8:11], v1 offset:3072
    ds_read_b128 v[236:239], v3 offset:3072
    v_mfma_f32_16x16x32_bf16 a[68:71], v[24:27], v[108:111], a[68:71]
    ds_read_b128 v[12:15], v1 offset:4096
    v_accvgpr_read_b32 v229, a9
    v_mfma_f32_16x16x32_bf16 a[68:71], v[28:31], v[124:127], a[68:71]
    buffer_store_dwordx4 v[220:223], v4, s[24:27], s10 offen offset:384 sc1
    v_accvgpr_read_b32 v230, a10
    v_accvgpr_read_b32 v231, a11
    v_cvt_pk_bf16_f32 v226, v228, v229
    v_mfma_f32_16x16x32_bf16 a[160:163], v[28:31], v[120:123], a[160:163]
    ds_read_b128 v[16:19], v1 offset:5120
    v_cvt_pk_bf16_f32 v227, v230, v231
    v_mfma_f32_16x16x32_bf16 a[160:163], v[24:27], v[104:107], a[160:163]
    v_mfma_f32_16x16x32_bf16 a[160:163], v[20:23], v[88:91], a[160:163]
    s_waitcnt lgkmcnt(9)
    ds_write_b128 v7, v[224:227] offset:0
    ds_read_b128 v[196:199], v3 offset:0
    v_mfma_f32_16x16x32_bf16 a[64:67], v[20:23], v[84:87], a[64:67]
    ds_read_b128 v[228:231], v3 offset:1024
    v_mfma_f32_16x16x32_bf16 a[64:67], v[24:27], v[100:103], a[64:67]
    v_mfma_f32_16x16x32_bf16 a[64:67], v[28:31], v[116:119], a[64:67]
    buffer_store_dwordx4 v[252:255], v4, s[24:27], s11 offen offset:384 sc1
    v_mfma_f32_16x16x32_bf16 a[156:159], v[28:31], v[112:115], a[156:159]
    v_accvgpr_read_b32 v152, a68
    v_accvgpr_read_b32 v153, a69
    v_mfma_f32_16x16x32_bf16 a[156:159], v[24:27], v[96:99], a[156:159]
    v_accvgpr_read_b32 v154, a70
    v_accvgpr_read_b32 v155, a71
    v_mfma_f32_16x16x32_bf16 a[156:159], v[20:23], v[80:83], a[156:159]
    s_waitcnt lgkmcnt(3)
    v_cvt_pk_bf16_f32 v152, v152, v153
    v_cvt_pk_bf16_f32 v153, v154, v155
    v_mfma_f32_16x16x32_bf16 a[16:19], v[8:11], v[32:35], a[16:19]
    ds_read_b128 v[20:23], v1 offset:15360
    v_accvgpr_read_b32 v144, a160
    v_mfma_f32_16x16x32_bf16 a[16:19], v[12:15], v[48:51], a[16:19]
    ds_read_b128 v[24:27], v1 offset:16384
    v_accvgpr_read_b32 v145, a161
    v_mfma_f32_16x16x32_bf16 a[16:19], v[16:19], v[64:67], a[16:19]
    buffer_store_dwordx4 v[212:215], v4, s[24:27], s8 offen offset:384 sc1
    v_accvgpr_read_b32 v146, a162
    v_accvgpr_read_b32 v147, a163
    v_cvt_pk_bf16_f32 v144, v144, v145
    v_mfma_f32_16x16x32_bf16 a[112:115], v[16:19], v[68:71], a[112:115]
    ds_read_b128 v[28:31], v1 offset:17408
    v_cvt_pk_bf16_f32 v145, v146, v147
    v_mfma_f32_16x16x32_bf16 a[112:115], v[12:15], v[52:55], a[112:115]
    v_accvgpr_read_b32 v136, a64
    v_accvgpr_read_b32 v137, a65
    v_mfma_f32_16x16x32_bf16 a[112:115], v[8:11], v[36:39], a[112:115]
    s_waitcnt lgkmcnt(6)
    v_accvgpr_read_b32 v138, a66
    v_accvgpr_read_b32 v139, a67
    v_mfma_f32_16x16x32_bf16 a[20:23], v[8:11], v[40:43], a[20:23]
    v_cvt_pk_bf16_f32 v136, v136, v137
    v_cvt_pk_bf16_f32 v137, v138, v139
    v_mfma_f32_16x16x32_bf16 a[20:23], v[12:15], v[56:59], a[20:23]
    v_accvgpr_read_b32 v128, a156
    v_accvgpr_read_b32 v129, a157
    v_mfma_f32_16x16x32_bf16 a[20:23], v[16:19], v[72:75], a[20:23]
    buffer_store_dwordx4 v[244:247], v4, s[24:27], s9 offen offset:384 sc1
    v_accvgpr_read_b32 v130, a158
    v_accvgpr_read_b32 v131, a159
    v_cvt_pk_bf16_f32 v128, v128, v129
    v_mfma_f32_16x16x32_bf16 a[116:119], v[16:19], v[76:79], a[116:119]
    v_cvt_pk_bf16_f32 v129, v130, v131
    v_mfma_f32_16x16x32_bf16 a[116:119], v[12:15], v[60:63], a[116:119]
    v_mfma_f32_16x16x32_bf16 a[116:119], v[8:11], v[44:47], a[116:119]
    s_waitcnt lgkmcnt(0)
    v_mfma_f32_16x16x32_bf16 a[116:119], v[20:23], v[92:95], a[116:119]
    ds_read_b128 v[8:11], v1 offset:6144
    v_mfma_f32_16x16x32_bf16 a[116:119], v[24:27], v[108:111], a[116:119]
    ds_read_b128 v[12:15], v1 offset:7168
    v_mfma_f32_16x16x32_bf16 a[116:119], v[28:31], v[124:127], a[116:119]
    buffer_store_dwordx4 v[204:207], v4, s[24:27], s6 offen offset:384 sc1
    v_mfma_f32_16x16x32_bf16 a[20:23], v[28:31], v[120:123], a[20:23]
    ds_read_b128 v[16:19], v1 offset:8192
    v_mfma_f32_16x16x32_bf16 a[20:23], v[24:27], v[104:107], a[20:23]
    v_mfma_f32_16x16x32_bf16 a[20:23], v[20:23], v[88:91], a[20:23]
    s_waitcnt lgkmcnt(3)
    v_mfma_f32_16x16x32_bf16 a[112:115], v[20:23], v[84:87], a[112:115]
    v_mfma_f32_16x16x32_bf16 a[112:115], v[24:27], v[100:103], a[112:115]
    v_mfma_f32_16x16x32_bf16 a[112:115], v[28:31], v[116:119], a[112:115]
    buffer_store_dwordx4 v[236:239], v4, s[24:27], s7 offen offset:384 sc1
    v_mfma_f32_16x16x32_bf16 a[16:19], v[28:31], v[112:115], a[16:19]
    v_accvgpr_read_b32 v156, a116
    v_accvgpr_read_b32 v157, a117
    v_mfma_f32_16x16x32_bf16 a[16:19], v[24:27], v[96:99], a[16:19]
    v_accvgpr_read_b32 v158, a118
    v_accvgpr_read_b32 v159, a119
    v_mfma_f32_16x16x32_bf16 a[16:19], v[20:23], v[80:83], a[16:19]
    s_waitcnt lgkmcnt(0)
    v_cvt_pk_bf16_f32 v154, v156, v157
    v_cvt_pk_bf16_f32 v155, v158, v159
    v_mfma_f32_16x16x32_bf16 a[164:167], v[8:11], v[32:35], a[164:167]
    ds_read_b128 v[20:23], v1 offset:18432
    v_accvgpr_read_b32 v148, a20
    v_mfma_f32_16x16x32_bf16 a[164:167], v[12:15], v[48:51], a[164:167]
    ds_read_b128 v[24:27], v1 offset:19456
    v_accvgpr_read_b32 v149, a21
    v_mfma_f32_16x16x32_bf16 a[164:167], v[16:19], v[64:67], a[164:167]
    buffer_store_dwordx4 v[196:199], v4, s[24:27], s4 offen offset:384 sc1
    ds_write_b128 v6, v[152:155] offset:6144
    v_accvgpr_read_b32 v150, a22
    v_accvgpr_read_b32 v151, a23
    v_mfma_f32_16x16x32_bf16 a[72:75], v[16:19], v[68:71], a[72:75]
    ds_read_b128 v[28:31], v1 offset:20480
    v_cvt_pk_bf16_f32 v146, v148, v149
    v_mfma_f32_16x16x32_bf16 a[72:75], v[12:15], v[52:55], a[72:75]
    v_cvt_pk_bf16_f32 v147, v150, v151
    v_accvgpr_read_b32 v140, a112
    v_mfma_f32_16x16x32_bf16 a[72:75], v[8:11], v[36:39], a[72:75]
    s_waitcnt lgkmcnt(4)
    ds_write_b128 v6, v[144:147] offset:4096
    v_accvgpr_read_b32 v141, a113
    v_mfma_f32_16x16x32_bf16 a[168:171], v[8:11], v[40:43], a[168:171]
    v_accvgpr_read_b32 v142, a114
    v_accvgpr_read_b32 v143, a115
    v_mfma_f32_16x16x32_bf16 a[168:171], v[12:15], v[56:59], a[168:171]
    v_cvt_pk_bf16_f32 v138, v140, v141
    v_cvt_pk_bf16_f32 v139, v142, v143
    v_mfma_f32_16x16x32_bf16 a[168:171], v[16:19], v[72:75], a[168:171]
    buffer_store_dwordx4 v[228:231], v4, s[24:27], s5 offen offset:384 sc1
    ds_write_b128 v6, v[136:139] offset:2048
    v_accvgpr_read_b32 v132, a16
    v_accvgpr_read_b32 v133, a17
    v_mfma_f32_16x16x32_bf16 a[76:79], v[16:19], v[76:79], a[76:79]
    v_accvgpr_read_b32 v134, a18
    v_accvgpr_read_b32 v135, a19
    v_mfma_f32_16x16x32_bf16 a[76:79], v[12:15], v[60:63], a[76:79]
    v_cvt_pk_bf16_f32 v130, v132, v133
    v_cvt_pk_bf16_f32 v131, v134, v135
    v_mfma_f32_16x16x32_bf16 a[76:79], v[8:11], v[44:47], a[76:79]
    s_waitcnt lgkmcnt(2)
    ds_write_b128 v6, v[128:131] offset:0
    v_mfma_f32_16x16x32_bf16 a[76:79], v[20:23], v[92:95], a[76:79]
    ds_read_b128 v[8:11], v1 offset:9216
    v_mfma_f32_16x16x32_bf16 a[76:79], v[24:27], v[108:111], a[76:79]
    ds_read_b128 v[12:15], v1 offset:10240
    v_mfma_f32_16x16x32_bf16 a[76:79], v[28:31], v[124:127], a[76:79]
    v_mfma_f32_16x16x32_bf16 a[168:171], v[28:31], v[120:123], a[168:171]
    ds_read_b128 v[16:19], v1 offset:11264
    v_mfma_f32_16x16x32_bf16 a[168:171], v[24:27], v[104:107], a[168:171]
    v_mfma_f32_16x16x32_bf16 a[168:171], v[20:23], v[88:91], a[168:171]
    s_waitcnt lgkmcnt(6)
    v_mfma_f32_16x16x32_bf16 a[72:75], v[20:23], v[84:87], a[72:75]
    v_mfma_f32_16x16x32_bf16 a[72:75], v[24:27], v[100:103], a[72:75]
    v_mfma_f32_16x16x32_bf16 a[72:75], v[28:31], v[116:119], a[72:75]
    v_mfma_f32_16x16x32_bf16 a[164:167], v[28:31], v[112:115], a[164:167]
    v_accvgpr_read_b32 v184, a76
    v_accvgpr_read_b32 v185, a77
    v_mfma_f32_16x16x32_bf16 a[164:167], v[24:27], v[96:99], a[164:167]
    v_accvgpr_read_b32 v186, a78
    v_accvgpr_read_b32 v187, a79
    v_mfma_f32_16x16x32_bf16 a[164:167], v[20:23], v[80:83], a[164:167]
    s_waitcnt lgkmcnt(0)
    v_cvt_pk_bf16_f32 v184, v184, v185
    v_cvt_pk_bf16_f32 v185, v186, v187
    v_mfma_f32_16x16x32_bf16 a[24:27], v[8:11], v[32:35], a[24:27]
    ds_read_b128 v[20:23], v1 offset:21504
    v_accvgpr_read_b32 v176, a168
    v_mfma_f32_16x16x32_bf16 a[24:27], v[12:15], v[48:51], a[24:27]
    ds_read_b128 v[24:27], v1 offset:22528
    v_accvgpr_read_b32 v177, a169
    v_mfma_f32_16x16x32_bf16 a[24:27], v[16:19], v[64:67], a[24:27]
    v_accvgpr_read_b32 v178, a170
    v_accvgpr_read_b32 v179, a171
    v_mfma_f32_16x16x32_bf16 a[120:123], v[16:19], v[68:71], a[120:123]
    ds_read_b128 v[28:31], v1 offset:23552
    v_cvt_pk_bf16_f32 v176, v176, v177
    v_mfma_f32_16x16x32_bf16 a[120:123], v[12:15], v[52:55], a[120:123]
    v_cvt_pk_bf16_f32 v177, v178, v179
    v_accvgpr_read_b32 v168, a72
    v_mfma_f32_16x16x32_bf16 a[120:123], v[8:11], v[36:39], a[120:123]
    s_waitcnt lgkmcnt(3)
    v_accvgpr_read_b32 v169, a73
    v_accvgpr_read_b32 v170, a74
    v_mfma_f32_16x16x32_bf16 a[28:31], v[8:11], v[40:43], a[28:31]
    v_accvgpr_read_b32 v171, a75
    v_cvt_pk_bf16_f32 v168, v168, v169
    v_mfma_f32_16x16x32_bf16 a[28:31], v[12:15], v[56:59], a[28:31]
    v_cvt_pk_bf16_f32 v169, v170, v171
    v_accvgpr_read_b32 v160, a164
    v_mfma_f32_16x16x32_bf16 a[28:31], v[16:19], v[72:75], a[28:31]
    v_accvgpr_read_b32 v161, a165
    v_accvgpr_read_b32 v162, a166
    v_mfma_f32_16x16x32_bf16 a[124:127], v[16:19], v[76:79], a[124:127]
    v_accvgpr_read_b32 v163, a167
    v_cvt_pk_bf16_f32 v160, v160, v161
    v_mfma_f32_16x16x32_bf16 a[124:127], v[12:15], v[60:63], a[124:127]
    v_cvt_pk_bf16_f32 v161, v162, v163
    v_mfma_f32_16x16x32_bf16 a[124:127], v[8:11], v[44:47], a[124:127]
    s_waitcnt lgkmcnt(0)
    v_mfma_f32_16x16x32_bf16 a[124:127], v[20:23], v[92:95], a[124:127]
    ds_read_b128 v[8:11], v1 offset:24576
    v_mfma_f32_16x16x32_bf16 a[124:127], v[24:27], v[108:111], a[124:127]
    ds_read_b128 v[12:15], v1 offset:25600
    v_mfma_f32_16x16x32_bf16 a[124:127], v[28:31], v[124:127], a[124:127]
    v_mfma_f32_16x16x32_bf16 a[28:31], v[28:31], v[120:123], a[28:31]
    ds_read_b128 v[16:19], v1 offset:26624
    v_mfma_f32_16x16x32_bf16 a[28:31], v[24:27], v[104:107], a[28:31]
    v_mfma_f32_16x16x32_bf16 a[28:31], v[20:23], v[88:91], a[28:31]
    s_waitcnt lgkmcnt(3)
    v_mfma_f32_16x16x32_bf16 a[120:123], v[20:23], v[84:87], a[120:123]
    v_mfma_f32_16x16x32_bf16 a[120:123], v[24:27], v[100:103], a[120:123]
    v_mfma_f32_16x16x32_bf16 a[120:123], v[28:31], v[116:119], a[120:123]
    v_mfma_f32_16x16x32_bf16 a[24:27], v[28:31], v[112:115], a[24:27]
    v_accvgpr_read_b32 v188, a124
    v_accvgpr_read_b32 v189, a125
    v_mfma_f32_16x16x32_bf16 a[24:27], v[24:27], v[96:99], a[24:27]
    v_accvgpr_read_b32 v190, a126
    v_accvgpr_read_b32 v191, a127
    v_mfma_f32_16x16x32_bf16 a[24:27], v[20:23], v[80:83], a[24:27]
    s_waitcnt lgkmcnt(0)
    v_cvt_pk_bf16_f32 v186, v188, v189
    v_cvt_pk_bf16_f32 v187, v190, v191
    v_mfma_f32_16x16x32_bf16 a[172:175], v[8:11], v[32:35], a[172:175]
    ds_read_b128 v[20:23], v1 offset:36864
    v_accvgpr_read_b32 v180, a28
    v_mfma_f32_16x16x32_bf16 a[172:175], v[12:15], v[48:51], a[172:175]
    ds_read_b128 v[24:27], v1 offset:37888
    v_accvgpr_read_b32 v181, a29
    v_mfma_f32_16x16x32_bf16 a[172:175], v[16:19], v[64:67], a[172:175]
    ds_write_b128 v7, v[184:187] offset:6144
    ds_read_b128 v[156:159], v3 offset:6144
    v_mfma_f32_16x16x32_bf16 a[80:83], v[16:19], v[68:71], a[80:83]
    ds_read_b128 v[28:31], v1 offset:38912
    ds_read_b128 v[188:191], v3 offset:7168
    v_mfma_f32_16x16x32_bf16 a[80:83], v[12:15], v[52:55], a[80:83]
    v_accvgpr_read_b32 v182, a30
    v_accvgpr_read_b32 v183, a31
    v_mfma_f32_16x16x32_bf16 a[80:83], v[8:11], v[36:39], a[80:83]
    s_waitcnt lgkmcnt(6)
    v_cvt_pk_bf16_f32 v178, v180, v181
    v_cvt_pk_bf16_f32 v179, v182, v183
    v_mfma_f32_16x16x32_bf16 a[176:179], v[8:11], v[40:43], a[176:179]
    v_accvgpr_read_b32 v172, a120
    v_accvgpr_read_b32 v173, a121
    v_mfma_f32_16x16x32_bf16 a[176:179], v[12:15], v[56:59], a[176:179]
    v_accvgpr_read_b32 v174, a122
    v_accvgpr_read_b32 v175, a123
    v_mfma_f32_16x16x32_bf16 a[176:179], v[16:19], v[72:75], a[176:179]
    ds_write_b128 v7, v[176:179] offset:4096
    ds_read_b128 v[148:151], v3 offset:4096
    v_mfma_f32_16x16x32_bf16 a[84:87], v[16:19], v[76:79], a[84:87]
    ds_read_b128 v[180:183], v3 offset:5120
    v_cvt_pk_bf16_f32 v170, v172, v173
    v_mfma_f32_16x16x32_bf16 a[84:87], v[12:15], v[60:63], a[84:87]
    v_cvt_pk_bf16_f32 v171, v174, v175
    v_accvgpr_read_b32 v164, a24
    v_mfma_f32_16x16x32_bf16 a[84:87], v[8:11], v[44:47], a[84:87]
    s_waitcnt lgkmcnt(4)
    ds_write_b128 v7, v[168:171] offset:2048
    ds_read_b128 v[140:143], v3 offset:2048
    v_mfma_f32_16x16x32_bf16 a[84:87], v[20:23], v[92:95], a[84:87]
    ds_read_b128 v[8:11], v1 offset:27648
    ds_read_b128 v[172:175], v3 offset:3072
    v_mfma_f32_16x16x32_bf16 a[84:87], v[24:27], v[108:111], a[84:87]
    ds_read_b128 v[12:15], v1 offset:28672
    v_accvgpr_read_b32 v165, a25
    v_mfma_f32_16x16x32_bf16 a[84:87], v[28:31], v[124:127], a[84:87]
    buffer_store_dwordx4 v[156:159], v4, s[24:27], s10 offen offset:512 sc1
    v_accvgpr_read_b32 v166, a26
    v_accvgpr_read_b32 v167, a27
    v_cvt_pk_bf16_f32 v162, v164, v165
    v_mfma_f32_16x16x32_bf16 a[176:179], v[28:31], v[120:123], a[176:179]
    ds_read_b128 v[16:19], v1 offset:29696
    v_cvt_pk_bf16_f32 v163, v166, v167
    v_mfma_f32_16x16x32_bf16 a[176:179], v[24:27], v[104:107], a[176:179]
    v_mfma_f32_16x16x32_bf16 a[176:179], v[20:23], v[88:91], a[176:179]
    s_waitcnt lgkmcnt(9)
    ds_write_b128 v7, v[160:163] offset:0
    ds_read_b128 v[132:135], v3 offset:0
    v_mfma_f32_16x16x32_bf16 a[80:83], v[20:23], v[84:87], a[80:83]
    ds_read_b128 v[164:167], v3 offset:1024
    v_mfma_f32_16x16x32_bf16 a[80:83], v[24:27], v[100:103], a[80:83]
    v_mfma_f32_16x16x32_bf16 a[80:83], v[28:31], v[116:119], a[80:83]
    buffer_store_dwordx4 v[188:191], v4, s[24:27], s11 offen offset:512 sc1
    v_mfma_f32_16x16x32_bf16 a[172:175], v[28:31], v[112:115], a[172:175]
    v_accvgpr_read_b32 v216, a84
    v_accvgpr_read_b32 v217, a85
    v_mfma_f32_16x16x32_bf16 a[172:175], v[24:27], v[96:99], a[172:175]
    v_accvgpr_read_b32 v218, a86
    v_accvgpr_read_b32 v219, a87
    v_mfma_f32_16x16x32_bf16 a[172:175], v[20:23], v[80:83], a[172:175]
    s_waitcnt lgkmcnt(3)
    v_cvt_pk_bf16_f32 v216, v216, v217
    v_cvt_pk_bf16_f32 v217, v218, v219
    v_mfma_f32_16x16x32_bf16 a[32:35], v[8:11], v[32:35], a[32:35]
    ds_read_b128 v[20:23], v1 offset:39936
    v_accvgpr_read_b32 v208, a176
    v_mfma_f32_16x16x32_bf16 a[32:35], v[12:15], v[48:51], a[32:35]
    ds_read_b128 v[24:27], v1 offset:40960
    v_accvgpr_read_b32 v209, a177
    v_mfma_f32_16x16x32_bf16 a[32:35], v[16:19], v[64:67], a[32:35]
    buffer_store_dwordx4 v[148:151], v4, s[24:27], s8 offen offset:512 sc1
    v_accvgpr_read_b32 v210, a178
    v_accvgpr_read_b32 v211, a179
    v_cvt_pk_bf16_f32 v208, v208, v209
    v_mfma_f32_16x16x32_bf16 a[128:131], v[16:19], v[68:71], a[128:131]
    ds_read_b128 v[28:31], v1 offset:41984
    v_cvt_pk_bf16_f32 v209, v210, v211
    v_mfma_f32_16x16x32_bf16 a[128:131], v[12:15], v[52:55], a[128:131]
    v_accvgpr_read_b32 v200, a80
    v_accvgpr_read_b32 v201, a81
    v_mfma_f32_16x16x32_bf16 a[128:131], v[8:11], v[36:39], a[128:131]
    s_waitcnt lgkmcnt(6)
    v_accvgpr_read_b32 v202, a82
    v_accvgpr_read_b32 v203, a83
    v_mfma_f32_16x16x32_bf16 a[36:39], v[8:11], v[40:43], a[36:39]
    v_cvt_pk_bf16_f32 v200, v200, v201
    v_cvt_pk_bf16_f32 v201, v202, v203
    v_mfma_f32_16x16x32_bf16 a[36:39], v[12:15], v[56:59], a[36:39]
    v_accvgpr_read_b32 v192, a172
    v_accvgpr_read_b32 v193, a173
    v_mfma_f32_16x16x32_bf16 a[36:39], v[16:19], v[72:75], a[36:39]
    buffer_store_dwordx4 v[180:183], v4, s[24:27], s9 offen offset:512 sc1
    v_accvgpr_read_b32 v194, a174
    v_accvgpr_read_b32 v195, a175
    v_cvt_pk_bf16_f32 v192, v192, v193
    v_mfma_f32_16x16x32_bf16 a[132:135], v[16:19], v[76:79], a[132:135]
    v_cvt_pk_bf16_f32 v193, v194, v195
    v_mfma_f32_16x16x32_bf16 a[132:135], v[12:15], v[60:63], a[132:135]
    v_mfma_f32_16x16x32_bf16 a[132:135], v[8:11], v[44:47], a[132:135]
    s_waitcnt lgkmcnt(0)
    v_mfma_f32_16x16x32_bf16 a[132:135], v[20:23], v[92:95], a[132:135]
    ds_read_b128 v[8:11], v1 offset:30720
    v_mfma_f32_16x16x32_bf16 a[132:135], v[24:27], v[108:111], a[132:135]
    ds_read_b128 v[12:15], v1 offset:31744
    v_mfma_f32_16x16x32_bf16 a[132:135], v[28:31], v[124:127], a[132:135]
    buffer_store_dwordx4 v[140:143], v4, s[24:27], s6 offen offset:512 sc1
    v_mfma_f32_16x16x32_bf16 a[36:39], v[28:31], v[120:123], a[36:39]
    ds_read_b128 v[16:19], v1 offset:32768
    v_mfma_f32_16x16x32_bf16 a[36:39], v[24:27], v[104:107], a[36:39]
    v_mfma_f32_16x16x32_bf16 a[36:39], v[20:23], v[88:91], a[36:39]
    s_waitcnt lgkmcnt(3)
    v_mfma_f32_16x16x32_bf16 a[128:131], v[20:23], v[84:87], a[128:131]
    v_mfma_f32_16x16x32_bf16 a[128:131], v[24:27], v[100:103], a[128:131]
    v_mfma_f32_16x16x32_bf16 a[128:131], v[28:31], v[116:119], a[128:131]
    buffer_store_dwordx4 v[172:175], v4, s[24:27], s7 offen offset:512 sc1
    v_mfma_f32_16x16x32_bf16 a[32:35], v[28:31], v[112:115], a[32:35]
    v_accvgpr_read_b32 v220, a132
    v_accvgpr_read_b32 v221, a133
    v_mfma_f32_16x16x32_bf16 a[32:35], v[24:27], v[96:99], a[32:35]
    v_accvgpr_read_b32 v222, a134
    v_accvgpr_read_b32 v223, a135
    v_mfma_f32_16x16x32_bf16 a[32:35], v[20:23], v[80:83], a[32:35]
    s_waitcnt lgkmcnt(0)
    v_cvt_pk_bf16_f32 v218, v220, v221
    v_cvt_pk_bf16_f32 v219, v222, v223
    v_mfma_f32_16x16x32_bf16 a[180:183], v[8:11], v[32:35], a[180:183]
    ds_read_b128 v[20:23], v1 offset:43008
    v_accvgpr_read_b32 v212, a36
    v_mfma_f32_16x16x32_bf16 a[180:183], v[12:15], v[48:51], a[180:183]
    ds_read_b128 v[24:27], v1 offset:44032
    v_accvgpr_read_b32 v213, a37
    v_mfma_f32_16x16x32_bf16 a[180:183], v[16:19], v[64:67], a[180:183]
    buffer_store_dwordx4 v[132:135], v4, s[24:27], s4 offen offset:512 sc1
    ds_write_b128 v6, v[216:219] offset:6144
    v_accvgpr_read_b32 v214, a38
    v_accvgpr_read_b32 v215, a39
    v_mfma_f32_16x16x32_bf16 a[88:91], v[16:19], v[68:71], a[88:91]
    ds_read_b128 v[28:31], v1 offset:45056
    v_cvt_pk_bf16_f32 v210, v212, v213
    v_mfma_f32_16x16x32_bf16 a[88:91], v[12:15], v[52:55], a[88:91]
    v_cvt_pk_bf16_f32 v211, v214, v215
    v_accvgpr_read_b32 v204, a128
    v_mfma_f32_16x16x32_bf16 a[88:91], v[8:11], v[36:39], a[88:91]
    s_waitcnt lgkmcnt(4)
    ds_write_b128 v6, v[208:211] offset:4096
    v_accvgpr_read_b32 v205, a129
    v_mfma_f32_16x16x32_bf16 a[184:187], v[8:11], v[40:43], a[184:187]
    v_accvgpr_read_b32 v206, a130
    v_accvgpr_read_b32 v207, a131
    v_mfma_f32_16x16x32_bf16 a[184:187], v[12:15], v[56:59], a[184:187]
    v_cvt_pk_bf16_f32 v202, v204, v205
    v_cvt_pk_bf16_f32 v203, v206, v207
    v_mfma_f32_16x16x32_bf16 a[184:187], v[16:19], v[72:75], a[184:187]
    buffer_store_dwordx4 v[164:167], v4, s[24:27], s5 offen offset:512 sc1
    ds_write_b128 v6, v[200:203] offset:2048
    v_accvgpr_read_b32 v196, a32
    v_accvgpr_read_b32 v197, a33
    v_mfma_f32_16x16x32_bf16 a[92:95], v[16:19], v[76:79], a[92:95]
    v_accvgpr_read_b32 v198, a34
    v_accvgpr_read_b32 v199, a35
    v_mfma_f32_16x16x32_bf16 a[92:95], v[12:15], v[60:63], a[92:95]
    v_cvt_pk_bf16_f32 v194, v196, v197
    v_cvt_pk_bf16_f32 v195, v198, v199
    v_mfma_f32_16x16x32_bf16 a[92:95], v[8:11], v[44:47], a[92:95]
    s_waitcnt lgkmcnt(2)
    ds_write_b128 v6, v[192:195] offset:0
    v_mfma_f32_16x16x32_bf16 a[92:95], v[20:23], v[92:95], a[92:95]
    ds_read_b128 v[8:11], v1 offset:33792
    v_mfma_f32_16x16x32_bf16 a[92:95], v[24:27], v[108:111], a[92:95]
    ds_read_b128 v[12:15], v1 offset:34816
    v_mfma_f32_16x16x32_bf16 a[92:95], v[28:31], v[124:127], a[92:95]
    v_mfma_f32_16x16x32_bf16 a[184:187], v[28:31], v[120:123], a[184:187]
    ds_read_b128 v[16:19], v1 offset:35840
    v_mfma_f32_16x16x32_bf16 a[184:187], v[24:27], v[104:107], a[184:187]
    v_mfma_f32_16x16x32_bf16 a[184:187], v[20:23], v[88:91], a[184:187]
    s_waitcnt lgkmcnt(6)
    v_mfma_f32_16x16x32_bf16 a[88:91], v[20:23], v[84:87], a[88:91]
    v_mfma_f32_16x16x32_bf16 a[88:91], v[24:27], v[100:103], a[88:91]
    v_mfma_f32_16x16x32_bf16 a[88:91], v[28:31], v[116:119], a[88:91]
    v_mfma_f32_16x16x32_bf16 a[180:183], v[28:31], v[112:115], a[180:183]
    v_accvgpr_read_b32 v248, a92
    v_accvgpr_read_b32 v249, a93
    v_mfma_f32_16x16x32_bf16 a[180:183], v[24:27], v[96:99], a[180:183]
    v_accvgpr_read_b32 v250, a94
    v_accvgpr_read_b32 v251, a95
    v_mfma_f32_16x16x32_bf16 a[180:183], v[20:23], v[80:83], a[180:183]
    s_waitcnt lgkmcnt(0)
    v_cvt_pk_bf16_f32 v248, v248, v249
    v_cvt_pk_bf16_f32 v249, v250, v251
    v_mfma_f32_16x16x32_bf16 a[40:43], v[8:11], v[32:35], a[40:43]
    ds_read_b128 v[20:23], v1 offset:46080
    v_accvgpr_read_b32 v240, a184
    v_mfma_f32_16x16x32_bf16 a[40:43], v[12:15], v[48:51], a[40:43]
    ds_read_b128 v[24:27], v1 offset:47104
    v_accvgpr_read_b32 v241, a185
    v_mfma_f32_16x16x32_bf16 a[40:43], v[16:19], v[64:67], a[40:43]
    v_accvgpr_read_b32 v242, a186
    v_accvgpr_read_b32 v243, a187
    v_mfma_f32_16x16x32_bf16 a[136:139], v[16:19], v[68:71], a[136:139]
    ds_read_b128 v[28:31], v1 offset:48128
    v_cvt_pk_bf16_f32 v240, v240, v241
    v_mfma_f32_16x16x32_bf16 a[136:139], v[12:15], v[52:55], a[136:139]
    v_cvt_pk_bf16_f32 v241, v242, v243
    v_accvgpr_read_b32 v232, a88
    v_mfma_f32_16x16x32_bf16 a[136:139], v[8:11], v[36:39], a[136:139]
    s_waitcnt lgkmcnt(3)
    v_accvgpr_read_b32 v233, a89
    v_accvgpr_read_b32 v234, a90
    v_mfma_f32_16x16x32_bf16 a[44:47], v[8:11], v[40:43], a[44:47]
    v_accvgpr_read_b32 v235, a91
    v_cvt_pk_bf16_f32 v232, v232, v233
    v_mfma_f32_16x16x32_bf16 a[44:47], v[12:15], v[56:59], a[44:47]
    v_cvt_pk_bf16_f32 v233, v234, v235
    v_accvgpr_read_b32 v224, a180
    v_mfma_f32_16x16x32_bf16 a[44:47], v[16:19], v[72:75], a[44:47]
    v_accvgpr_read_b32 v225, a181
    v_accvgpr_read_b32 v226, a182
    v_mfma_f32_16x16x32_bf16 a[140:143], v[16:19], v[76:79], a[140:143]
    v_accvgpr_read_b32 v227, a183
    v_cvt_pk_bf16_f32 v224, v224, v225
    v_mfma_f32_16x16x32_bf16 a[140:143], v[12:15], v[60:63], a[140:143]
    v_cvt_pk_bf16_f32 v225, v226, v227
    v_mfma_f32_16x16x32_bf16 a[140:143], v[8:11], v[44:47], a[140:143]
    s_waitcnt lgkmcnt(0)
    v_mfma_f32_16x16x32_bf16 a[140:143], v[20:23], v[92:95], a[140:143]
    v_mfma_f32_16x16x32_bf16 a[140:143], v[24:27], v[108:111], a[140:143]
    v_mfma_f32_16x16x32_bf16 a[140:143], v[28:31], v[124:127], a[140:143]
    v_mfma_f32_16x16x32_bf16 a[44:47], v[28:31], v[120:123], a[44:47]
    v_mfma_f32_16x16x32_bf16 a[44:47], v[24:27], v[104:107], a[44:47]
    v_mfma_f32_16x16x32_bf16 a[44:47], v[20:23], v[88:91], a[44:47]
    s_waitcnt lgkmcnt(0)
    v_mfma_f32_16x16x32_bf16 a[136:139], v[20:23], v[84:87], a[136:139]
    v_mfma_f32_16x16x32_bf16 a[136:139], v[24:27], v[100:103], a[136:139]
    v_mfma_f32_16x16x32_bf16 a[136:139], v[28:31], v[116:119], a[136:139]
    v_mfma_f32_16x16x32_bf16 a[40:43], v[28:31], v[112:115], a[40:43]
    v_accvgpr_read_b32 v252, a140
    v_accvgpr_read_b32 v253, a141
    v_mfma_f32_16x16x32_bf16 a[40:43], v[24:27], v[96:99], a[40:43]
    v_accvgpr_read_b32 v254, a142
    v_accvgpr_read_b32 v255, a143
    v_mfma_f32_16x16x32_bf16 a[40:43], v[20:23], v[80:83], a[40:43]
    s_waitcnt lgkmcnt(15)
    v_cvt_pk_bf16_f32 v250, v252, v253
    v_cvt_pk_bf16_f32 v251, v254, v255
    s_waitcnt lgkmcnt(15)
    ds_write_b128 v7, v[248:251] offset:6144
    ds_read_b128 v[220:223], v3 offset:6144
    ds_read_b128 v[252:255], v3 offset:7168
    v_accvgpr_read_b32 v244, a44
    v_accvgpr_read_b32 v245, a45
    v_accvgpr_read_b32 v246, a46
    v_accvgpr_read_b32 v247, a47
    v_cvt_pk_bf16_f32 v242, v244, v245
    v_cvt_pk_bf16_f32 v243, v246, v247
    ds_write_b128 v7, v[240:243] offset:4096
    ds_read_b128 v[212:215], v3 offset:4096
    ds_read_b128 v[244:247], v3 offset:5120
    s_waitcnt lgkmcnt(3)
    buffer_store_dwordx4 v[220:223], v4, s[24:27], s10 offen offset:640 sc1
    buffer_store_dwordx4 v[252:255], v4, s[24:27], s11 offen offset:640 sc1
    v_accvgpr_read_b32 v236, a136
    v_accvgpr_read_b32 v237, a137
    v_accvgpr_read_b32 v238, a138
    v_accvgpr_read_b32 v239, a139
    v_cvt_pk_bf16_f32 v234, v236, v237
    v_cvt_pk_bf16_f32 v235, v238, v239
    ds_write_b128 v7, v[232:235] offset:2048
    ds_read_b128 v[204:207], v3 offset:2048
    ds_read_b128 v[236:239], v3 offset:3072
    s_waitcnt lgkmcnt(3)
    buffer_store_dwordx4 v[212:215], v4, s[24:27], s8 offen offset:640 sc1
    buffer_store_dwordx4 v[244:247], v4, s[24:27], s9 offen offset:640 sc1
    v_accvgpr_read_b32 v228, a40
    v_accvgpr_read_b32 v229, a41
    v_accvgpr_read_b32 v230, a42
    v_accvgpr_read_b32 v231, a43
    v_cvt_pk_bf16_f32 v226, v228, v229
    v_cvt_pk_bf16_f32 v227, v230, v231
    ds_write_b128 v7, v[224:227] offset:0
    ds_read_b128 v[196:199], v3 offset:0
    ds_read_b128 v[228:231], v3 offset:1024
    s_waitcnt lgkmcnt(3)
    buffer_store_dwordx4 v[204:207], v4, s[24:27], s6 offen offset:640 sc1
    buffer_store_dwordx4 v[236:239], v4, s[24:27], s7 offen offset:640 sc1
    s_waitcnt lgkmcnt(0)
    buffer_store_dwordx4 v[196:199], v4, s[24:27], s4 offen offset:640 sc1
    buffer_store_dwordx4 v[228:231], v4, s[24:27], s5 offen offset:640 sc1
L_end:
    s_endpgm
L3_slow:
    s_mov_b32 s22, 0x40000
L3_slow_l:
    buffer_load_dword v48, v49, s[36:39], s67 offen sc1
    s_sub_u32 s22, s22, 1
    s_cmp_eq_u32 s22, 0
    s_waitcnt vmcnt(0)
    s_cbranch_scc1 L3_back
    v_cmp_gt_u32 vcc, 18, v48
    s_nop 4
    s_cbranch_vccnz L3_slow_l
    s_branch L3_back
.fill 256, 4, 0xbf800000
.section .rodata,"a"
.p2align 6
.amdhsa_kernel standalone__modern_conv_block_slak__vision_kernel
  .amdhsa_next_free_vgpr 512
  .amdhsa_next_free_sgpr 102
  .amdhsa_accum_offset 256
  .amdhsa_group_segment_fixed_size 0
  .amdhsa_kernarg_size 72
  .amdhsa_user_sgpr_count 2
  .amdhsa_user_sgpr_kernarg_segment_ptr 1
  .amdhsa_system_sgpr_workgroup_id_x 1
  .amdhsa_float_denorm_mode_32 3
.end_amdhsa_kernel
```
